```python
import torch

def _softmax(x, axis=-1):
    return torch.softmax(x, dim=axis)
def _gelu(x):
    return torch.nn.functional.gelu(x, approximate="tanh")
def _silu(x):
    return torch.nn.functional.silu(x)
def _sigmoid(x):
    return torch.sigmoid(x)
def _layernorm(x, axis=-1, eps=1e-5):
    m = x.mean(dim=axis, keepdim=True)
    v = x.var(dim=axis, keepdim=True, unbiased=False)
    return (x - m) / torch.sqrt(v + eps)
def _scatter_add(tgt, idx, src, axis=0):
    return tgt.clone().index_add_(axis, idx, src)
def _segment_sum(src, seg, n):
    out = torch.zeros((n,) + src.shape[1:], dtype=src.dtype)
    return out.index_add_(0, seg, src)
def _pad(x, pw):
    flat = tuple(v for pair in reversed(pw) for v in pair)
    return torch.nn.functional.pad(x, flat)

kernel_name = 'interleave_layers__sliding_block__swiglu_ffn__prompt'

def setup_inputs():

    _w = (lambda a: (lambda t: t.to(torch.bfloat16) if t.is_floating_point() else t)(torch.as_tensor(a)))
    def _A_setup():
        B, S, D = 1, 2048, 512
        return {
            "x": _w((lambda *s: torch.randn(*s, dtype=torch.bfloat16) * 0.05)(B, S, D)),
            "wqkv": _w((lambda *s: torch.randn(*s, dtype=torch.bfloat16) * 0.05)(D, 3 * D)),
            "wo": _w((lambda *s: torch.randn(*s, dtype=torch.bfloat16) * 0.05)(D, D)),
        }
    _A_in = _A_setup()

    def _B_setup():
        B, S, D, F = 1, 2048, 512, 1792
        return {
            "x": _w((lambda *s: torch.randn(*s, dtype=torch.bfloat16) * 0.05)(B, S, D)),
            "w_gate": _w((lambda *s: torch.randn(*s, dtype=torch.bfloat16) * 0.05)(D, F)),
            "w_up": _w((lambda *s: torch.randn(*s, dtype=torch.bfloat16) * 0.05)(D, F)),
            "w_down": _w((lambda *s: torch.randn(*s, dtype=torch.bfloat16) * 0.05)(F, D)),
        }
    _B_in = _B_setup()

    return {
        "A_x": _A_in["x"],
        "A_wqkv": _A_in["wqkv"],
        "A_wo": _A_in["wo"],
        "B_x": _B_in["x"],
        "B_w_gate": _B_in["w_gate"],
        "B_w_up": _B_in["w_up"],
        "B_w_down": _B_in["w_down"],
    }

def reference(A_x, A_wqkv, A_wo, B_x, B_w_gate, B_w_up, B_w_down):
    def _A_ref(x, wqkv, wo):
        B, S, D = x.shape
        H = 32; Dh = D // H; W = 256
        qkv = (lambda x, *d: x.permute(*d))((x @ wqkv).reshape(B, S, 3, H, Dh), 2, 0, 3, 1, 4)
        q, k, v = qkv[0], qkv[1], qkv[2]
        scores = torch.einsum("bhqd,bhkd->bhqk", q, k) * (Dh ** -0.5)
        idx = torch.arange(S)
        mask = (idx[:, None] - idx[None, :] >= 0) & (idx[:, None] - idx[None, :] < W)
        scores = torch.where(mask[None, None], scores, -1e9)
        p = _softmax(scores, axis=-1)
        o = torch.einsum("bhqk,bhkd->bhqd", p, v)
        return (lambda x, *d: x.permute(*d))(o, 0, 2, 1, 3).reshape(B, S, D) @ wo

    def _B_ref(x, w_gate, w_up, w_down):
        g = _silu(x @ w_gate)
        u = x @ w_up
        return (g * u) @ w_down

    x = A_x
    x = x + _A_ref(_layernorm(x, axis=-1), A_wqkv, A_wo)
    x = x + _B_ref(_layernorm(x, axis=-1), B_w_gate, B_w_up, B_w_down)
    x = x + _A_ref(_layernorm(x, axis=-1), A_wqkv, A_wo)
    x = x + _B_ref(_layernorm(x, axis=-1), B_w_gate, B_w_up, B_w_down)
    return x
```

```asm
; @launch kernel=k0_kernel grid=(672,1,1) block=(256,1,1) lds=16384
; @launch kernel=pk_kernel grid=(256,1,1) block=(256,1,1) lds=163840
.amdgcn_target "amdgcn-amd-amdhsa--gfx950"
.text
.globl k0_kernel
.p2align 8
.type k0_kernel,@function
k0_kernel:
    s_cmp_ge_u32 s2, 672
    s_cbranch_scc1 k0_kernel_end
    s_load_dwordx16 s[4:19], s[0:1], 0
    s_load_dwordx4 s[20:23], s[0:1], 64
    v_and_b32 v1, 63, v0
    v_lshrrev_b32 v2, 6, v0
    v_lshlrev_b32 v4, 4, v1
    v_readfirstlane_b32 s3, v2
    v_and_b32 v5, 31, v1
    v_lshrrev_b32 v6, 5, v1
    s_lshl_b32 s47, s3, 12
    s_waitcnt lgkmcnt(0)
    s_mov_b32 s32, s22
    s_and_b32 s33, s23, 0xffff
    s_mov_b32 s34, 52428800
    s_mov_b32 s35, 0x00020000
    s_cmp_lt_u32 s2, 80
    s_cbranch_scc1 k0_kernel_cs
    s_cmp_ge_u32 s2, 544
    s_cbranch_scc1 k0_kernel_x
    s_sub_u32 s30, s2, 80
    s_cmp_ge_u32 s30, 16
    s_cbranch_scc1 k0_kernel_nocode
    s_getpc_b64 s[36:37]
k0_kernel_pc:
    s_add_u32 s36, s36, pk_kernel-k0_kernel_pc
    s_addc_u32 s37, s37, 0
    s_and_b32 s37, s37, 0xffff
    s_mov_b32 s38, pk_kernel_codeend-pk_kernel
    s_mov_b32 s39, 0x00020000
    s_lshr_b32 s28, s30, 3
    s_lshl_b32 s28, s28, 2
    s_add_u32 s28, s28, s3
    s_lshl_b32 s28, s28, 13
    v_lshlrev_b32 v2, 7, v1
    buffer_load_dword v9, v2, s[36:39], s28 offen
k0_kernel_nocode:
    s_lshl_b32 s30, s30, 2
    s_add_u32 s30, s30, s3
    s_cmp_ge_u32 s30, 896
    s_cbranch_scc1 k0_kernel_single
    s_mul_i32 s48, s30, 2341
    s_lshr_b32 s48, s48, 16
    s_mul_i32 s28, s48, 28
    s_sub_u32 s49, s30, s28
    s_mov_b32 s36, s12
    s_and_b32 s37, s13, 0xffff
    s_mov_b32 s38, 1835008
    s_mov_b32 s39, 0x00020000
    s_mov_b32 s40, s14
    s_and_b32 s41, s15, 0xffff
    s_mov_b32 s42, 1835008
    s_mov_b32 s43, 0x00020000
    s_mov_b32 s46, 3584
    s_mul_i32 s44, s48, 57344
    s_lshl_b32 s28, s49, 7
    s_add_u32 s44, s44, s28
    s_mov_b32 s45, s44
    s_mov_b32 s55, 0
    s_branch k0_kernel_join
k0_kernel_single:
    s_sub_u32 s31, s30, 896
    s_cmp_ge_u32 s31, 576
    s_cbranch_scc1 k0_kernel_wq
    s_cmp_ge_u32 s31, 128
    s_cbranch_scc1 k0_kernel_wd
    s_mov_b32 s36, s8
    s_and_b32 s37, s9, 0xffff
    s_mov_b32 s38, 524288
    s_mov_b32 s39, 0x00020000
    s_mov_b32 s51, 41943040
    s_mov_b32 s50, 32
    s_lshr_b32 s48, s31, 3
    s_and_b32 s49, s31, 7
    s_mov_b32 s46, 1024
    s_mov_b32 s55, 1
    s_branch k0_kernel_c
k0_kernel_wd:
    s_sub_u32 s31, s31, 128
    s_mov_b32 s36, s16
    s_and_b32 s37, s17, 0xffff
    s_mov_b32 s38, 1835008
    s_mov_b32 s39, 0x00020000
    s_mov_b32 s51, 42467328
    s_mov_b32 s50, 112
    s_lshr_b32 s48, s31, 3
    s_and_b32 s49, s31, 7
    s_mov_b32 s46, 1024
    s_mov_b32 s55, 1
    s_branch k0_kernel_c
k0_kernel_wq:
    s_sub_u32 s31, s31, 576
    s_mov_b32 s36, s6
    s_and_b32 s37, s7, 0xffff
    s_mov_b32 s38, 1572864
    s_mov_b32 s39, 0x00020000
    s_mov_b32 s51, 44302336
    s_mov_b32 s50, 0
    s_mul_i32 s48, s31, 2731
    s_lshr_b32 s48, s48, 16
    s_mul_i32 s28, s48, 24
    s_sub_u32 s49, s31, s28
    s_mov_b32 s46, 3072
    s_mov_b32 s55, 2
k0_kernel_c:
    s_mov_b32 s40, s36
    s_mov_b32 s41, s37
    s_mov_b32 s42, s38
    s_mov_b32 s43, 0x00020000
    s_mul_i32 s44, s48, s46
    s_lshl_b32 s44, s44, 5
    s_lshl_b32 s28, s49, 7
    s_add_u32 s44, s44, s28
    s_lshl_b32 s28, s46, 4
    s_add_u32 s45, s44, s28
k0_kernel_join:
    v_lshrrev_b32 v2, 3, v1
    v_mul_lo_u32 v7, v2, s46
    v_and_b32 v2, 7, v1
    v_lshl_add_u32 v7, v2, 4, v7
    s_lshl_b32 s29, s46, 3
    s_add_u32 m0, s47, 0
    s_nop 0
    buffer_load_dwordx4 v7, s[36:39], s44 offen lds
    s_add_u32 m0, s47, 1024
    s_add_u32 s44, s44, s29
    buffer_load_dwordx4 v7, s[36:39], s44 offen lds
    s_add_u32 m0, s47, 2048
    s_nop 0
    buffer_load_dwordx4 v7, s[40:43], s45 offen lds
    s_add_u32 m0, s47, 3072
    s_add_u32 s45, s45, s29
    buffer_load_dwordx4 v7, s[40:43], s45 offen lds
    v_bfe_u32 v2, v1, 2, 2
    v_lshl_add_u32 v2, v6, 3, v2
    v_lshlrev_b32 v8, 7, v2
    v_and_b32 v2, 3, v1
    v_lshl_add_u32 v8, v2, 3, v8
    v_add_u32 v8, s47, v8
    v_bfe_u32 v2, v1, 4, 1
    s_cmp_lg_u32 s55, 0
    s_cbranch_scc1 k0_kernel_p2s
    v_lshl_add_u32 v8, v2, 11, v8
    s_waitcnt vmcnt(0)
    ds_read_b64_tr_b16 v[16:17], v8 offset:0
    ds_read_b64_tr_b16 v[18:19], v8 offset:512
    ds_read_b64_tr_b16 v[20:21], v8 offset:32
    ds_read_b64_tr_b16 v[22:23], v8 offset:544
    ds_read_b64_tr_b16 v[24:25], v8 offset:64
    ds_read_b64_tr_b16 v[26:27], v8 offset:576
    ds_read_b64_tr_b16 v[28:29], v8 offset:96
    ds_read_b64_tr_b16 v[30:31], v8 offset:608
    s_lshl_b32 s52, s49, 2
    s_add_u32 s52, s52, 0
    s_mul_i32 s53, s52, 9363
    s_lshr_b32 s53, s53, 16
    s_mul_i32 s28, s53, 7
    s_sub_u32 s52, s52, s28
    s_mul_i32 s28, s48, 3
    s_add_u32 s28, s28, s52
    s_add_u32 s28, s28, 0
    s_mov_b32 s54, s28
    s_mul_i32 s28, s48, 2
    s_add_u32 s28, s28, s52
    s_add_u32 s28, s28, 97
    s_cmp_ge_u32 s52, 3
    s_cselect_b32 s54, s28, s54
    s_mul_i32 s28, s48, 2
    s_add_u32 s28, s28, s52
    s_add_u32 s28, s28, 163
    s_cmp_ge_u32 s52, 5
    s_cselect_b32 s54, s28, s54
    s_mul_i32 s53, s53, 248
    s_add_u32 s54, s54, s53
    s_lshl_b32 s54, s54, 10
    s_add_u32 s54, s54, 45924352
    s_waitcnt lgkmcnt(0)
    buffer_store_dwordx4 v[16:19], v4, s[32:35], s54 offen
    s_lshl_b32 s52, s49, 2
    s_add_u32 s52, s52, 1
    s_mul_i32 s53, s52, 9363
    s_lshr_b32 s53, s53, 16
    s_mul_i32 s28, s53, 7
    s_sub_u32 s52, s52, s28
    s_mul_i32 s28, s48, 3
    s_add_u32 s28, s28, s52
    s_add_u32 s28, s28, 0
    s_mov_b32 s54, s28
    s_mul_i32 s28, s48, 2
    s_add_u32 s28, s28, s52
    s_add_u32 s28, s28, 97
    s_cmp_ge_u32 s52, 3
    s_cselect_b32 s54, s28, s54
    s_mul_i32 s28, s48, 2
    s_add_u32 s28, s28, s52
    s_add_u32 s28, s28, 163
    s_cmp_ge_u32 s52, 5
    s_cselect_b32 s54, s28, s54
    s_mul_i32 s53, s53, 248
    s_add_u32 s54, s54, s53
    s_lshl_b32 s54, s54, 10
    s_add_u32 s54, s54, 45924352
    buffer_store_dwordx4 v[20:23], v4, s[32:35], s54 offen
    s_lshl_b32 s52, s49, 2
    s_add_u32 s52, s52, 2
    s_mul_i32 s53, s52, 9363
    s_lshr_b32 s53, s53, 16
    s_mul_i32 s28, s53, 7
    s_sub_u32 s52, s52, s28
    s_mul_i32 s28, s48, 3
    s_add_u32 s28, s28, s52
    s_add_u32 s28, s28, 0
    s_mov_b32 s54, s28
    s_mul_i32 s28, s48, 2
    s_add_u32 s28, s28, s52
    s_add_u32 s28, s28, 97
    s_cmp_ge_u32 s52, 3
    s_cselect_b32 s54, s28, s54
    s_mul_i32 s28, s48, 2
    s_add_u32 s28, s28, s52
    s_add_u32 s28, s28, 163
    s_cmp_ge_u32 s52, 5
    s_cselect_b32 s54, s28, s54
    s_mul_i32 s53, s53, 248
    s_add_u32 s54, s54, s53
    s_lshl_b32 s54, s54, 10
    s_add_u32 s54, s54, 45924352
    buffer_store_dwordx4 v[24:27], v4, s[32:35], s54 offen
    s_lshl_b32 s52, s49, 2
    s_add_u32 s52, s52, 3
    s_mul_i32 s53, s52, 9363
    s_lshr_b32 s53, s53, 16
    s_mul_i32 s28, s53, 7
    s_sub_u32 s52, s52, s28
    s_mul_i32 s28, s48, 3
    s_add_u32 s28, s28, s52
    s_add_u32 s28, s28, 0
    s_mov_b32 s54, s28
    s_mul_i32 s28, s48, 2
    s_add_u32 s28, s28, s52
    s_add_u32 s28, s28, 97
    s_cmp_ge_u32 s52, 3
    s_cselect_b32 s54, s28, s54
    s_mul_i32 s28, s48, 2
    s_add_u32 s28, s28, s52
    s_add_u32 s28, s28, 163
    s_cmp_ge_u32 s52, 5
    s_cselect_b32 s54, s28, s54
    s_mul_i32 s53, s53, 248
    s_add_u32 s54, s54, s53
    s_lshl_b32 s54, s54, 10
    s_add_u32 s54, s54, 45924352
    buffer_store_dwordx4 v[28:31], v4, s[32:35], s54 offen
    s_endpgm
k0_kernel_p2s:
    v_lshl_add_u32 v8, v2, 5, v8
    s_waitcnt vmcnt(0)
    ds_read_b64_tr_b16 v[16:17], v8 offset:0
    ds_read_b64_tr_b16 v[18:19], v8 offset:512
    ds_read_b64_tr_b16 v[20:21], v8 offset:64
    ds_read_b64_tr_b16 v[22:23], v8 offset:576
    ds_read_b64_tr_b16 v[24:25], v8 offset:2048
    ds_read_b64_tr_b16 v[26:27], v8 offset:2560
    ds_read_b64_tr_b16 v[28:29], v8 offset:2112
    ds_read_b64_tr_b16 v[30:31], v8 offset:2624
    s_cmp_eq_u32 s55, 2
    s_cbranch_scc1 k0_kernel_p2q
    s_mul_i32 s28, s49, s50
    s_add_u32 s28, s28, s48
    s_lshl_b32 s28, s28, 11
    s_add_u32 s51, s51, s28
    s_lshl_b32 s50, s50, 10
    s_add_u32 s28, s51, s50
    s_waitcnt lgkmcnt(0)
    buffer_store_dwordx4 v[16:19], v4, s[32:35], s51 offen offset:0
    buffer_store_dwordx4 v[20:23], v4, s[32:35], s28 offen offset:0
    buffer_store_dwordx4 v[24:27], v4, s[32:35], s51 offen offset:1024
    buffer_store_dwordx4 v[28:31], v4, s[32:35], s28 offen offset:1024
    s_endpgm
k0_kernel_p2q:
    s_lshr_b32 s52, s49, 3
    s_and_b32 s53, s49, 7
    s_mul_i32 s53, s53, 198
    s_lshl_b32 s28, s48, 2
    s_add_u32 s28, s28, s52
    s_lshl_b32 s29, s48, 1
    s_add_u32 s29, s29, 66
    s_cmp_eq_u32 s52, 2
    s_cselect_b32 s28, s29, s28
    s_cselect_b32 s50, 1, 2
    s_lshl_b32 s50, s50, 10
    s_add_u32 s53, s53, s28
    s_lshl_b32 s53, s53, 10
    s_add_u32 s51, s51, s53
    s_add_u32 s28, s51, 101376
    s_add_u32 s44, s51, s50
    s_add_u32 s45, s28, s50
    s_waitcnt lgkmcnt(0)
    buffer_store_dwordx4 v[16:19], v4, s[32:35], s51 offen
    buffer_store_dwordx4 v[20:23], v4, s[32:35], s28 offen
    buffer_store_dwordx4 v[24:27], v4, s[32:35], s44 offen
    buffer_store_dwordx4 v[28:31], v4, s[32:35], s45 offen
    s_endpgm
k0_kernel_x:
    s_sub_u32 s30, s2, 544
    s_cmp_ge_u32 s30, 28
    s_cbranch_scc1 k0_kernel_x2
    v_lshlrev_b32 v2, 4, v0
    v_mov_b32 v16, 0
    v_mov_b32 v17, 0
    v_mov_b32 v18, 0
    v_mov_b32 v19, 0
    s_lshl_b32 s28, s30, 12
    s_add_u32 s28, s28, 49987584
    buffer_store_dwordx4 v[16:19], v2, s[32:35], s28 offen
    s_nop 1
k0_kernel_x2:
    s_lshl_b32 s30, s30, 2
    s_add_u32 s30, s30, s3
    s_mov_b32 s36, s4
    s_and_b32 s37, s5, 0xffff
    s_mov_b32 s38, 2097152
    s_mov_b32 s39, 0x00020000
    s_lshr_b32 s48, s30, 3
    s_and_b32 s49, s30, 7
    v_lshlrev_b32 v7, 10, v5
    v_lshl_add_u32 v7, v6, 4, v7
    s_lshl_b32 s44, s48, 15
    s_lshl_b32 s28, s49, 7
    s_add_u32 s45, s44, s28
    buffer_load_dwordx4 v[16:19], v7, s[36:39], s45 offen offset:0
    buffer_load_dwordx4 v[20:23], v7, s[36:39], s45 offen offset:32
    buffer_load_dwordx4 v[24:27], v7, s[36:39], s45 offen offset:64
    buffer_load_dwordx4 v[28:31], v7, s[36:39], s45 offen offset:96
    s_lshl_b32 s28, s49, 12
    s_add_u32 s44, s44, s28
    s_add_u32 s44, s44, 0
    v_mov_b32 v32, 0
    v_mov_b32 v33, 0
    v_mov_b32 v34, 0
    v_mov_b32 v35, 0
    s_waitcnt vmcnt(0)
    buffer_store_dwordx4 v[16:19], v4, s[32:35], s44 offen offset:0
    buffer_store_dwordx4 v[20:23], v4, s[32:35], s44 offen offset:1024
    buffer_store_dwordx4 v[24:27], v4, s[32:35], s44 offen offset:2048
    buffer_store_dwordx4 v[28:31], v4, s[32:35], s44 offen offset:3072
    v_lshlrev_b32 v2, 16, v16
    v_and_b32 v3, 0xffff0000, v16
    v_add_f32 v32, v32, v2
    v_fmac_f32 v33, v2, v2
    v_add_f32 v32, v32, v3
    v_fmac_f32 v33, v3, v3
    v_lshlrev_b32 v2, 16, v17
    v_and_b32 v3, 0xffff0000, v17
    v_add_f32 v32, v32, v2
    v_fmac_f32 v33, v2, v2
    v_add_f32 v32, v32, v3
    v_fmac_f32 v33, v3, v3
    v_lshlrev_b32 v2, 16, v18
    v_and_b32 v3, 0xffff0000, v18
    v_add_f32 v32, v32, v2
    v_fmac_f32 v33, v2, v2
    v_add_f32 v32, v32, v3
    v_fmac_f32 v33, v3, v3
    v_lshlrev_b32 v2, 16, v19
    v_and_b32 v3, 0xffff0000, v19
    v_add_f32 v32, v32, v2
    v_fmac_f32 v33, v2, v2
    v_add_f32 v32, v32, v3
    v_fmac_f32 v33, v3, v3
    v_lshlrev_b32 v2, 16, v20
    v_and_b32 v3, 0xffff0000, v20
    v_add_f32 v32, v32, v2
    v_fmac_f32 v33, v2, v2
    v_add_f32 v32, v32, v3
    v_fmac_f32 v33, v3, v3
    v_lshlrev_b32 v2, 16, v21
    v_and_b32 v3, 0xffff0000, v21
    v_add_f32 v32, v32, v2
    v_fmac_f32 v33, v2, v2
    v_add_f32 v32, v32, v3
    v_fmac_f32 v33, v3, v3
    v_lshlrev_b32 v2, 16, v22
    v_and_b32 v3, 0xffff0000, v22
    v_add_f32 v32, v32, v2
    v_fmac_f32 v33, v2, v2
    v_add_f32 v32, v32, v3
    v_fmac_f32 v33, v3, v3
    v_lshlrev_b32 v2, 16, v23
    v_and_b32 v3, 0xffff0000, v23
    v_add_f32 v32, v32, v2
    v_fmac_f32 v33, v2, v2
    v_add_f32 v32, v32, v3
    v_fmac_f32 v33, v3, v3
    v_lshlrev_b32 v2, 16, v24
    v_and_b32 v3, 0xffff0000, v24
    v_add_f32 v34, v34, v2
    v_fmac_f32 v35, v2, v2
    v_add_f32 v34, v34, v3
    v_fmac_f32 v35, v3, v3
    v_lshlrev_b32 v2, 16, v25
    v_and_b32 v3, 0xffff0000, v25
    v_add_f32 v34, v34, v2
    v_fmac_f32 v35, v2, v2
    v_add_f32 v34, v34, v3
    v_fmac_f32 v35, v3, v3
    v_lshlrev_b32 v2, 16, v26
    v_and_b32 v3, 0xffff0000, v26
    v_add_f32 v34, v34, v2
    v_fmac_f32 v35, v2, v2
    v_add_f32 v34, v34, v3
    v_fmac_f32 v35, v3, v3
    v_lshlrev_b32 v2, 16, v27
    v_and_b32 v3, 0xffff0000, v27
    v_add_f32 v34, v34, v2
    v_fmac_f32 v35, v2, v2
    v_add_f32 v34, v34, v3
    v_fmac_f32 v35, v3, v3
    v_lshlrev_b32 v2, 16, v28
    v_and_b32 v3, 0xffff0000, v28
    v_add_f32 v34, v34, v2
    v_fmac_f32 v35, v2, v2
    v_add_f32 v34, v34, v3
    v_fmac_f32 v35, v3, v3
    v_lshlrev_b32 v2, 16, v29
    v_and_b32 v3, 0xffff0000, v29
    v_add_f32 v34, v34, v2
    v_fmac_f32 v35, v2, v2
    v_add_f32 v34, v34, v3
    v_fmac_f32 v35, v3, v3
    v_lshlrev_b32 v2, 16, v30
    v_and_b32 v3, 0xffff0000, v30
    v_add_f32 v34, v34, v2
    v_fmac_f32 v35, v2, v2
    v_add_f32 v34, v34, v3
    v_fmac_f32 v35, v3, v3
    v_lshlrev_b32 v2, 16, v31
    v_and_b32 v3, 0xffff0000, v31
    v_add_f32 v34, v34, v2
    v_fmac_f32 v35, v2, v2
    v_add_f32 v34, v34, v3
    v_fmac_f32 v35, v3, v3
    v_mov_b32 v36, v32
    v_mov_b32 v37, v33
    v_mov_b32 v38, v34
    v_mov_b32 v39, v35
    s_nop 1
    v_permlane32_swap_b32 v32, v36
    v_permlane32_swap_b32 v33, v37
    v_permlane32_swap_b32 v34, v38
    v_permlane32_swap_b32 v35, v39
    v_add_f32 v32, v32, v36
    v_add_f32 v33, v33, v37
    v_add_f32 v34, v34, v38
    v_add_f32 v35, v35, v39
    s_lshl_b32 s28, s49, 15
    s_lshl_b32 s29, s48, 8
    s_add_u32 s28, s28, s29
    s_add_u32 s28, s28, 19922944
    s_add_u32 s29, s28, 16384
    v_lshlrev_b32 v2, 3, v1
    s_mov_b64 exec, 0xffffffff
    buffer_store_dwordx2 v[32:33], v2, s[32:35], s28 offen
    buffer_store_dwordx2 v[34:35], v2, s[32:35], s29 offen
    s_endpgm
k0_kernel_cs:
    s_cmp_ge_u32 s2, 56
    s_cbranch_scc1 k0_kernel_csq
    s_cmp_ge_u32 s2, 28
    s_cselect_b32 s36, s14, s12
    s_cselect_b32 s37, s15, s13
    s_cselect_b32 s55, 1, 0
    s_cselect_b32 s28, 28, 0
    s_and_b32 s37, s37, 0xffff
    s_mov_b32 s38, 1835008
    s_mov_b32 s39, 0x00020000
    s_sub_u32 s49, s2, s28
    s_mov_b32 s46, 3584
    s_branch k0_kernel_csj
k0_kernel_csq:
    s_mov_b32 s36, s6
    s_and_b32 s37, s7, 0xffff
    s_mov_b32 s38, 1572864
    s_mov_b32 s39, 0x00020000
    s_sub_u32 s49, s2, 56
    s_mov_b32 s46, 3072
    s_mov_b32 s55, 2
k0_kernel_csj:
    v_lshrrev_b32 v2, 3, v0
    v_mul_lo_u32 v7, v2, s46
    v_and_b32 v3, 7, v0
    v_lshl_add_u32 v7, v3, 4, v7
    s_lshl_b32 s44, s49, 7
    s_lshl_b32 s29, s46, 5
    buffer_load_dwordx4 v[16:19], v7, s[36:39], s44 offen
    s_add_u32 s44, s44, s29
    buffer_load_dwordx4 v[20:23], v7, s[36:39], s44 offen
    s_add_u32 s44, s44, s29
    buffer_load_dwordx4 v[24:27], v7, s[36:39], s44 offen
    s_add_u32 s44, s44, s29
    buffer_load_dwordx4 v[28:31], v7, s[36:39], s44 offen
    s_add_u32 s44, s44, s29
    buffer_load_dwordx4 v[32:35], v7, s[36:39], s44 offen
    s_add_u32 s44, s44, s29
    buffer_load_dwordx4 v[36:39], v7, s[36:39], s44 offen
    s_add_u32 s44, s44, s29
    buffer_load_dwordx4 v[40:43], v7, s[36:39], s44 offen
    s_add_u32 s44, s44, s29
    buffer_load_dwordx4 v[44:47], v7, s[36:39], s44 offen
    s_add_u32 s44, s44, s29
    buffer_load_dwordx4 v[48:51], v7, s[36:39], s44 offen
    s_add_u32 s44, s44, s29
    buffer_load_dwordx4 v[52:55], v7, s[36:39], s44 offen
    s_add_u32 s44, s44, s29
    buffer_load_dwordx4 v[56:59], v7, s[36:39], s44 offen
    s_add_u32 s44, s44, s29
    buffer_load_dwordx4 v[60:63], v7, s[36:39], s44 offen
    s_add_u32 s44, s44, s29
    buffer_load_dwordx4 v[64:67], v7, s[36:39], s44 offen
    s_add_u32 s44, s44, s29
    buffer_load_dwordx4 v[68:71], v7, s[36:39], s44 offen
    s_add_u32 s44, s44, s29
    buffer_load_dwordx4 v[72:75], v7, s[36:39], s44 offen
    s_add_u32 s44, s44, s29
    buffer_load_dwordx4 v[76:79], v7, s[36:39], s44 offen
    v_mov_b32 v80, 0
    v_mov_b32 v81, 0
    v_mov_b32 v82, 0
    v_mov_b32 v83, 0
    v_mov_b32 v84, 0
    v_mov_b32 v85, 0
    v_mov_b32 v86, 0
    v_mov_b32 v87, 0
    s_waitcnt vmcnt(15)
    v_lshlrev_b32 v9, 16, v16
    v_and_b32 v16, 0xffff0000, v16
    v_add_f32 v80, v80, v9
    v_add_f32 v81, v81, v16
    v_lshlrev_b32 v9, 16, v17
    v_and_b32 v17, 0xffff0000, v17
    v_add_f32 v82, v82, v9
    v_add_f32 v83, v83, v17
    v_lshlrev_b32 v9, 16, v18
    v_and_b32 v18, 0xffff0000, v18
    v_add_f32 v84, v84, v9
    v_add_f32 v85, v85, v18
    v_lshlrev_b32 v9, 16, v19
    v_and_b32 v19, 0xffff0000, v19
    v_add_f32 v86, v86, v9
    v_add_f32 v87, v87, v19
    s_waitcnt vmcnt(14)
    v_lshlrev_b32 v9, 16, v20
    v_and_b32 v20, 0xffff0000, v20
    v_add_f32 v80, v80, v9
    v_add_f32 v81, v81, v20
    v_lshlrev_b32 v9, 16, v21
    v_and_b32 v21, 0xffff0000, v21
    v_add_f32 v82, v82, v9
    v_add_f32 v83, v83, v21
    v_lshlrev_b32 v9, 16, v22
    v_and_b32 v22, 0xffff0000, v22
    v_add_f32 v84, v84, v9
    v_add_f32 v85, v85, v22
    v_lshlrev_b32 v9, 16, v23
    v_and_b32 v23, 0xffff0000, v23
    v_add_f32 v86, v86, v9
    v_add_f32 v87, v87, v23
    s_waitcnt vmcnt(13)
    v_lshlrev_b32 v9, 16, v24
    v_and_b32 v24, 0xffff0000, v24
    v_add_f32 v80, v80, v9
    v_add_f32 v81, v81, v24
    v_lshlrev_b32 v9, 16, v25
    v_and_b32 v25, 0xffff0000, v25
    v_add_f32 v82, v82, v9
    v_add_f32 v83, v83, v25
    v_lshlrev_b32 v9, 16, v26
    v_and_b32 v26, 0xffff0000, v26
    v_add_f32 v84, v84, v9
    v_add_f32 v85, v85, v26
    v_lshlrev_b32 v9, 16, v27
    v_and_b32 v27, 0xffff0000, v27
    v_add_f32 v86, v86, v9
    v_add_f32 v87, v87, v27
    s_waitcnt vmcnt(12)
    v_lshlrev_b32 v9, 16, v28
    v_and_b32 v28, 0xffff0000, v28
    v_add_f32 v80, v80, v9
    v_add_f32 v81, v81, v28
    v_lshlrev_b32 v9, 16, v29
    v_and_b32 v29, 0xffff0000, v29
    v_add_f32 v82, v82, v9
    v_add_f32 v83, v83, v29
    v_lshlrev_b32 v9, 16, v30
    v_and_b32 v30, 0xffff0000, v30
    v_add_f32 v84, v84, v9
    v_add_f32 v85, v85, v30
    v_lshlrev_b32 v9, 16, v31
    v_and_b32 v31, 0xffff0000, v31
    v_add_f32 v86, v86, v9
    v_add_f32 v87, v87, v31
    s_waitcnt vmcnt(11)
    v_lshlrev_b32 v9, 16, v32
    v_and_b32 v32, 0xffff0000, v32
    v_add_f32 v80, v80, v9
    v_add_f32 v81, v81, v32
    v_lshlrev_b32 v9, 16, v33
    v_and_b32 v33, 0xffff0000, v33
    v_add_f32 v82, v82, v9
    v_add_f32 v83, v83, v33
    v_lshlrev_b32 v9, 16, v34
    v_and_b32 v34, 0xffff0000, v34
    v_add_f32 v84, v84, v9
    v_add_f32 v85, v85, v34
    v_lshlrev_b32 v9, 16, v35
    v_and_b32 v35, 0xffff0000, v35
    v_add_f32 v86, v86, v9
    v_add_f32 v87, v87, v35
    s_waitcnt vmcnt(10)
    v_lshlrev_b32 v9, 16, v36
    v_and_b32 v36, 0xffff0000, v36
    v_add_f32 v80, v80, v9
    v_add_f32 v81, v81, v36
    v_lshlrev_b32 v9, 16, v37
    v_and_b32 v37, 0xffff0000, v37
    v_add_f32 v82, v82, v9
    v_add_f32 v83, v83, v37
    v_lshlrev_b32 v9, 16, v38
    v_and_b32 v38, 0xffff0000, v38
    v_add_f32 v84, v84, v9
    v_add_f32 v85, v85, v38
    v_lshlrev_b32 v9, 16, v39
    v_and_b32 v39, 0xffff0000, v39
    v_add_f32 v86, v86, v9
    v_add_f32 v87, v87, v39
    s_waitcnt vmcnt(9)
    v_lshlrev_b32 v9, 16, v40
    v_and_b32 v40, 0xffff0000, v40
    v_add_f32 v80, v80, v9
    v_add_f32 v81, v81, v40
    v_lshlrev_b32 v9, 16, v41
    v_and_b32 v41, 0xffff0000, v41
    v_add_f32 v82, v82, v9
    v_add_f32 v83, v83, v41
    v_lshlrev_b32 v9, 16, v42
    v_and_b32 v42, 0xffff0000, v42
    v_add_f32 v84, v84, v9
    v_add_f32 v85, v85, v42
    v_lshlrev_b32 v9, 16, v43
    v_and_b32 v43, 0xffff0000, v43
    v_add_f32 v86, v86, v9
    v_add_f32 v87, v87, v43
    s_waitcnt vmcnt(8)
    v_lshlrev_b32 v9, 16, v44
    v_and_b32 v44, 0xffff0000, v44
    v_add_f32 v80, v80, v9
    v_add_f32 v81, v81, v44
    v_lshlrev_b32 v9, 16, v45
    v_and_b32 v45, 0xffff0000, v45
    v_add_f32 v82, v82, v9
    v_add_f32 v83, v83, v45
    v_lshlrev_b32 v9, 16, v46
    v_and_b32 v46, 0xffff0000, v46
    v_add_f32 v84, v84, v9
    v_add_f32 v85, v85, v46
    v_lshlrev_b32 v9, 16, v47
    v_and_b32 v47, 0xffff0000, v47
    v_add_f32 v86, v86, v9
    v_add_f32 v87, v87, v47
    s_waitcnt vmcnt(7)
    v_lshlrev_b32 v9, 16, v48
    v_and_b32 v48, 0xffff0000, v48
    v_add_f32 v80, v80, v9
    v_add_f32 v81, v81, v48
    v_lshlrev_b32 v9, 16, v49
    v_and_b32 v49, 0xffff0000, v49
    v_add_f32 v82, v82, v9
    v_add_f32 v83, v83, v49
    v_lshlrev_b32 v9, 16, v50
    v_and_b32 v50, 0xffff0000, v50
    v_add_f32 v84, v84, v9
    v_add_f32 v85, v85, v50
    v_lshlrev_b32 v9, 16, v51
    v_and_b32 v51, 0xffff0000, v51
    v_add_f32 v86, v86, v9
    v_add_f32 v87, v87, v51
    s_waitcnt vmcnt(6)
    v_lshlrev_b32 v9, 16, v52
    v_and_b32 v52, 0xffff0000, v52
    v_add_f32 v80, v80, v9
    v_add_f32 v81, v81, v52
    v_lshlrev_b32 v9, 16, v53
    v_and_b32 v53, 0xffff0000, v53
    v_add_f32 v82, v82, v9
    v_add_f32 v83, v83, v53
    v_lshlrev_b32 v9, 16, v54
    v_and_b32 v54, 0xffff0000, v54
    v_add_f32 v84, v84, v9
    v_add_f32 v85, v85, v54
    v_lshlrev_b32 v9, 16, v55
    v_and_b32 v55, 0xffff0000, v55
    v_add_f32 v86, v86, v9
    v_add_f32 v87, v87, v55
    s_waitcnt vmcnt(5)
    v_lshlrev_b32 v9, 16, v56
    v_and_b32 v56, 0xffff0000, v56
    v_add_f32 v80, v80, v9
    v_add_f32 v81, v81, v56
    v_lshlrev_b32 v9, 16, v57
    v_and_b32 v57, 0xffff0000, v57
    v_add_f32 v82, v82, v9
    v_add_f32 v83, v83, v57
    v_lshlrev_b32 v9, 16, v58
    v_and_b32 v58, 0xffff0000, v58
    v_add_f32 v84, v84, v9
    v_add_f32 v85, v85, v58
    v_lshlrev_b32 v9, 16, v59
    v_and_b32 v59, 0xffff0000, v59
    v_add_f32 v86, v86, v9
    v_add_f32 v87, v87, v59
    s_waitcnt vmcnt(4)
    v_lshlrev_b32 v9, 16, v60
    v_and_b32 v60, 0xffff0000, v60
    v_add_f32 v80, v80, v9
    v_add_f32 v81, v81, v60
    v_lshlrev_b32 v9, 16, v61
    v_and_b32 v61, 0xffff0000, v61
    v_add_f32 v82, v82, v9
    v_add_f32 v83, v83, v61
    v_lshlrev_b32 v9, 16, v62
    v_and_b32 v62, 0xffff0000, v62
    v_add_f32 v84, v84, v9
    v_add_f32 v85, v85, v62
    v_lshlrev_b32 v9, 16, v63
    v_and_b32 v63, 0xffff0000, v63
    v_add_f32 v86, v86, v9
    v_add_f32 v87, v87, v63
    s_waitcnt vmcnt(3)
    v_lshlrev_b32 v9, 16, v64
    v_and_b32 v64, 0xffff0000, v64
    v_add_f32 v80, v80, v9
    v_add_f32 v81, v81, v64
    v_lshlrev_b32 v9, 16, v65
    v_and_b32 v65, 0xffff0000, v65
    v_add_f32 v82, v82, v9
    v_add_f32 v83, v83, v65
    v_lshlrev_b32 v9, 16, v66
    v_and_b32 v66, 0xffff0000, v66
    v_add_f32 v84, v84, v9
    v_add_f32 v85, v85, v66
    v_lshlrev_b32 v9, 16, v67
    v_and_b32 v67, 0xffff0000, v67
    v_add_f32 v86, v86, v9
    v_add_f32 v87, v87, v67
    s_waitcnt vmcnt(2)
    v_lshlrev_b32 v9, 16, v68
    v_and_b32 v68, 0xffff0000, v68
    v_add_f32 v80, v80, v9
    v_add_f32 v81, v81, v68
    v_lshlrev_b32 v9, 16, v69
    v_and_b32 v69, 0xffff0000, v69
    v_add_f32 v82, v82, v9
    v_add_f32 v83, v83, v69
    v_lshlrev_b32 v9, 16, v70
    v_and_b32 v70, 0xffff0000, v70
    v_add_f32 v84, v84, v9
    v_add_f32 v85, v85, v70
    v_lshlrev_b32 v9, 16, v71
    v_and_b32 v71, 0xffff0000, v71
    v_add_f32 v86, v86, v9
    v_add_f32 v87, v87, v71
    s_waitcnt vmcnt(1)
    v_lshlrev_b32 v9, 16, v72
    v_and_b32 v72, 0xffff0000, v72
    v_add_f32 v80, v80, v9
    v_add_f32 v81, v81, v72
    v_lshlrev_b32 v9, 16, v73
    v_and_b32 v73, 0xffff0000, v73
    v_add_f32 v82, v82, v9
    v_add_f32 v83, v83, v73
    v_lshlrev_b32 v9, 16, v74
    v_and_b32 v74, 0xffff0000, v74
    v_add_f32 v84, v84, v9
    v_add_f32 v85, v85, v74
    v_lshlrev_b32 v9, 16, v75
    v_and_b32 v75, 0xffff0000, v75
    v_add_f32 v86, v86, v9
    v_add_f32 v87, v87, v75
    s_waitcnt vmcnt(0)
    v_lshlrev_b32 v9, 16, v76
    v_and_b32 v76, 0xffff0000, v76
    v_add_f32 v80, v80, v9
    v_add_f32 v81, v81, v76
    v_lshlrev_b32 v9, 16, v77
    v_and_b32 v77, 0xffff0000, v77
    v_add_f32 v82, v82, v9
    v_add_f32 v83, v83, v77
    v_lshlrev_b32 v9, 16, v78
    v_and_b32 v78, 0xffff0000, v78
    v_add_f32 v84, v84, v9
    v_add_f32 v85, v85, v78
    v_lshlrev_b32 v9, 16, v79
    v_and_b32 v79, 0xffff0000, v79
    v_add_f32 v86, v86, v9
    v_add_f32 v87, v87, v79
    v_mul_u32_u24 v8, 272, v2
    v_lshl_add_u32 v8, v3, 5, v8
    ds_write_b128 v8, v[80:83]
    ds_write_b128 v8, v[84:87] offset:16
    s_waitcnt lgkmcnt(0)
    s_barrier
    s_cmp_lg_u32 s3, 0
    s_cbranch_scc1 k0_kernel_end
    v_lshlrev_b32 v8, 2, v1
    ds_read_b32 v16, v8 offset:0
    ds_read_b32 v17, v8 offset:272
    ds_read_b32 v18, v8 offset:544
    ds_read_b32 v19, v8 offset:816
    ds_read_b32 v20, v8 offset:1088
    ds_read_b32 v21, v8 offset:1360
    ds_read_b32 v22, v8 offset:1632
    ds_read_b32 v23, v8 offset:1904
    ds_read_b32 v24, v8 offset:2176
    ds_read_b32 v25, v8 offset:2448
    ds_read_b32 v26, v8 offset:2720
    ds_read_b32 v27, v8 offset:2992
    ds_read_b32 v28, v8 offset:3264
    ds_read_b32 v29, v8 offset:3536
    ds_read_b32 v30, v8 offset:3808
    ds_read_b32 v31, v8 offset:4080
    ds_read_b32 v32, v8 offset:4352
    ds_read_b32 v33, v8 offset:4624
    ds_read_b32 v34, v8 offset:4896
    ds_read_b32 v35, v8 offset:5168
    ds_read_b32 v36, v8 offset:5440
    ds_read_b32 v37, v8 offset:5712
    ds_read_b32 v38, v8 offset:5984
    ds_read_b32 v39, v8 offset:6256
    ds_read_b32 v40, v8 offset:6528
    ds_read_b32 v41, v8 offset:6800
    ds_read_b32 v42, v8 offset:7072
    ds_read_b32 v43, v8 offset:7344
    ds_read_b32 v44, v8 offset:7616
    ds_read_b32 v45, v8 offset:7888
    ds_read_b32 v46, v8 offset:8160
    ds_read_b32 v47, v8 offset:8432
    s_waitcnt lgkmcnt(0)
    v_add_f32 v16, v16, v32
    v_add_f32 v17, v17, v33
    v_add_f32 v18, v18, v34
    v_add_f32 v19, v19, v35
    v_add_f32 v20, v20, v36
    v_add_f32 v21, v21, v37
    v_add_f32 v22, v22, v38
    v_add_f32 v23, v23, v39
    v_add_f32 v24, v24, v40
    v_add_f32 v25, v25, v41
    v_add_f32 v26, v26, v42
    v_add_f32 v27, v27, v43
    v_add_f32 v28, v28, v44
    v_add_f32 v29, v29, v45
    v_add_f32 v30, v30, v46
    v_add_f32 v31, v31, v47
    v_add_f32 v16, v16, v24
    v_add_f32 v17, v17, v25
    v_add_f32 v18, v18, v26
    v_add_f32 v19, v19, v27
    v_add_f32 v20, v20, v28
    v_add_f32 v21, v21, v29
    v_add_f32 v22, v22, v30
    v_add_f32 v23, v23, v31
    v_add_f32 v16, v16, v20
    v_add_f32 v17, v17, v21
    v_add_f32 v18, v18, v22
    v_add_f32 v19, v19, v23
    v_add_f32 v16, v16, v18
    v_add_f32 v17, v17, v19
    v_add_f32 v16, v16, v17
    v_cvt_pk_bf16_f32 v17, v16, v16
    v_lshlrev_b32 v18, 16, v17
    v_sub_f32 v16, v16, v18
    v_cvt_pk_bf16_f32 v19, v16, v16
    v_lshlrev_b32 v18, 16, v19
    v_sub_f32 v16, v16, v18
    v_cvt_pk_bf16_f32 v21, v16, v16
    v_and_b32 v21, 0xffff, v21
    v_and_b32 v17, 0xffff, v17
    v_or_b32 v20, v17, v18
    v_mov_b32 v22, 0
    v_mov_b32 v23, 0
    v_mov_b32 v24, 0
    v_mov_b32 v25, 0
    v_mov_b32 v26, 0
    v_mov_b32 v27, 0
    s_cmp_eq_u32 s55, 2
    s_cbranch_scc1 k0_kernel_csq2
    v_and_b32 v2, 15, v1
    s_lshl_b32 s28, s55, 4
    v_add_u32 v2, s28, v2
    v_lshlrev_b32 v2, 4, v2
    s_mov_b32 s48, 32
    s_lshl_b32 s52, s49, 2
    s_add_u32 s52, s52, 0
    s_mul_i32 s53, s52, 9363
    s_lshr_b32 s53, s53, 16
    s_mul_i32 s28, s53, 7
    s_sub_u32 s52, s52, s28
    s_mul_i32 s28, s48, 3
    s_add_u32 s28, s28, s52
    s_add_u32 s28, s28, 0
    s_mov_b32 s54, s28
    s_mul_i32 s28, s48, 2
    s_add_u32 s28, s28, s52
    s_add_u32 s28, s28, 97
    s_cmp_ge_u32 s52, 3
    s_cselect_b32 s54, s28, s54
    s_mul_i32 s28, s48, 2
    s_add_u32 s28, s28, s52
    s_add_u32 s28, s28, 163
    s_cmp_ge_u32 s52, 5
    s_cselect_b32 s54, s28, s54
    s_mul_i32 s53, s53, 248
    s_add_u32 s54, s54, s53
    s_lshl_b32 s54, s54, 10
    s_add_u32 s54, s54, 45924352
    s_mov_b32 exec_lo, 65535
    s_mov_b32 exec_hi, 0
    buffer_store_dwordx4 v[20:23], v2, s[32:35], s54 offen
    buffer_store_dwordx4 v[24:27], v2, s[32:35], s54 offen offset:512
    s_lshl_b32 s52, s49, 2
    s_add_u32 s52, s52, 1
    s_mul_i32 s53, s52, 9363
    s_lshr_b32 s53, s53, 16
    s_mul_i32 s28, s53, 7
    s_sub_u32 s52, s52, s28
    s_mul_i32 s28, s48, 3
    s_add_u32 s28, s28, s52
    s_add_u32 s28, s28, 0
    s_mov_b32 s54, s28
    s_mul_i32 s28, s48, 2
    s_add_u32 s28, s28, s52
    s_add_u32 s28, s28, 97
    s_cmp_ge_u32 s52, 3
    s_cselect_b32 s54, s28, s54
    s_mul_i32 s28, s48, 2
    s_add_u32 s28, s28, s52
    s_add_u32 s28, s28, 163
    s_cmp_ge_u32 s52, 5
    s_cselect_b32 s54, s28, s54
    s_mul_i32 s53, s53, 248
    s_add_u32 s54, s54, s53
    s_lshl_b32 s54, s54, 10
    s_add_u32 s54, s54, 45924352
    s_mov_b32 exec_lo, 4294901760
    s_mov_b32 exec_hi, 0
    buffer_store_dwordx4 v[20:23], v2, s[32:35], s54 offen
    buffer_store_dwordx4 v[24:27], v2, s[32:35], s54 offen offset:512
    s_lshl_b32 s52, s49, 2
    s_add_u32 s52, s52, 2
    s_mul_i32 s53, s52, 9363
    s_lshr_b32 s53, s53, 16
    s_mul_i32 s28, s53, 7
    s_sub_u32 s52, s52, s28
    s_mul_i32 s28, s48, 3
    s_add_u32 s28, s28, s52
    s_add_u32 s28, s28, 0
    s_mov_b32 s54, s28
    s_mul_i32 s28, s48, 2
    s_add_u32 s28, s28, s52
    s_add_u32 s28, s28, 97
    s_cmp_ge_u32 s52, 3
    s_cselect_b32 s54, s28, s54
    s_mul_i32 s28, s48, 2
    s_add_u32 s28, s28, s52
    s_add_u32 s28, s28, 163
    s_cmp_ge_u32 s52, 5
    s_cselect_b32 s54, s28, s54
    s_mul_i32 s53, s53, 248
    s_add_u32 s54, s54, s53
    s_lshl_b32 s54, s54, 10
    s_add_u32 s54, s54, 45924352
    s_mov_b32 exec_lo, 0
    s_mov_b32 exec_hi, 65535
    buffer_store_dwordx4 v[20:23], v2, s[32:35], s54 offen
    buffer_store_dwordx4 v[24:27], v2, s[32:35], s54 offen offset:512
    s_lshl_b32 s52, s49, 2
    s_add_u32 s52, s52, 3
    s_mul_i32 s53, s52, 9363
    s_lshr_b32 s53, s53, 16
    s_mul_i32 s28, s53, 7
    s_sub_u32 s52, s52, s28
    s_mul_i32 s28, s48, 3
    s_add_u32 s28, s28, s52
    s_add_u32 s28, s28, 0
    s_mov_b32 s54, s28
    s_mul_i32 s28, s48, 2
    s_add_u32 s28, s28, s52
    s_add_u32 s28, s28, 97
    s_cmp_ge_u32 s52, 3
    s_cselect_b32 s54, s28, s54
    s_mul_i32 s28, s48, 2
    s_add_u32 s28, s28, s52
    s_add_u32 s28, s28, 163
    s_cmp_ge_u32 s52, 5
    s_cselect_b32 s54, s28, s54
    s_mul_i32 s53, s53, 248
    s_add_u32 s54, s54, s53
    s_lshl_b32 s54, s54, 10
    s_add_u32 s54, s54, 45924352
    s_mov_b32 exec_lo, 0
    s_mov_b32 exec_hi, 4294901760
    buffer_store_dwordx4 v[20:23], v2, s[32:35], s54 offen
    buffer_store_dwordx4 v[24:27], v2, s[32:35], s54 offen offset:512
    s_endpgm
k0_kernel_csq2:
    v_lshlrev_b32 v2, 4, v5
    v_mul_u32_u24 v3, 101376, v6
    v_add_u32 v2, v2, v3
    s_lshr_b32 s52, s49, 3
    s_and_b32 s53, s49, 7
    s_mul_i32 s53, s53, 198
    s_add_u32 s28, s52, 64
    s_cmp_eq_u32 s52, 2
    s_cselect_b32 s28, 98, s28
    s_add_u32 s53, s53, s28
    s_lshl_b32 s53, s53, 10
    s_add_u32 s53, s53, 44302336
    buffer_store_dwordx4 v[20:23], v2, s[32:35], s53 offen
    buffer_store_dwordx4 v[24:27], v2, s[32:35], s53 offen offset:512
k0_kernel_end:
    s_endpgm
.globl pk_kernel
.p2align 8
.type pk_kernel,@function
pk_kernel:
    s_cmp_ge_u32 s2, 256
    s_cbranch_scc1 pk_kernel_end
    s_load_dwordx16 s[4:19], s[0:1], 0
    s_load_dwordx4 s[20:23], s[0:1], 64
    v_and_b32 v1, 63, v0
    v_lshrrev_b32 v7, 6, v0
    v_lshlrev_b32 v2, 4, v1
    v_readfirstlane_b32 s3, v7
    v_and_b32 v3, 31, v1
    v_lshrrev_b32 v4, 5, v1
    v_mov_b32 v5, 1
    v_mov_b32 v6, 0
    s_bfe_u32 s28, s2, 0x20001
    s_lshl_b32 s28, s28, 2
    s_bfe_u32 s40, s2, 0x20003
    s_add_u32 s28, s28, s40
    s_and_b32 s40, s2, 1
    s_lshr_b32 s41, s2, 5
    s_lshl_b32 s29, s40, 3
    s_add_u32 s29, s29, s41
    s_lshl_b32 s47, s40, 2
    s_and_b32 s40, s41, 3
    s_add_u32 s47, s47, s40
    s_lshr_b32 s46, s41, 2
    s_lshl_b32 s33, s3, 12
    s_mul_i32 s80, s29, 101376
    s_add_u32 s80, s80, s33
    s_add_u32 s80, s80, 44302336
    s_waitcnt lgkmcnt(0)
    s_mov_b32 s24, s22
    s_and_b32 s25, s23, 0xffff
    s_mov_b32 s26, 52428800
    s_mov_b32 s27, 0x00020000
    s_mov_b32 s84, s22
    s_and_b32 s85, s23, 0xffff
    s_mov_b32 s86, 52428800
    s_mov_b32 s87, 0x00020000
    s_add_u32 m0, s33, 49152
    s_mov_b32 s49, s80
    buffer_load_dwordx4 v2, s[84:87], s49 offen offset:0 lds
    buffer_load_dwordx4 v2, s[84:87], s49 offen offset:1024 lds
    buffer_load_dwordx4 v2, s[84:87], s49 offen offset:2048 lds
    buffer_load_dwordx4 v2, s[84:87], s49 offen offset:3072 lds
    s_add_u32 m0, s33, 65536
    s_add_u32 s49, s49, 16384
    buffer_load_dwordx4 v2, s[84:87], s49 offen offset:0 lds
    buffer_load_dwordx4 v2, s[84:87], s49 offen offset:1024 lds
    buffer_load_dwordx4 v2, s[84:87], s49 offen offset:2048 lds
    buffer_load_dwordx4 v2, s[84:87], s49 offen offset:3072 lds
    s_mov_b32 s36, s18
    s_and_b32 s37, s19, 0xffff
    s_mov_b32 s38, 2097152
    s_mov_b32 s39, 0x00020000
    v_add_u32 v236, 0, v2
    v_add_u32 v237, 4096, v2
    v_add_u32 v238, 8192, v2
    v_add_u32 v239, 12288, v2
    v_add_u32 v240, 16384, v2
    v_add_u32 v241, 20480, v2
    v_add_u32 v242, 24576, v2
    v_add_u32 v243, 28672, v2
    s_mov_b32 s30, 0
    s_lshl_b32 s32, s28, 10
    s_add_u32 s32, s32, 49987584
    s_lshr_b32 s92, s29, 1
    s_lshl_b32 s92, s92, 7
    s_lshl_b32 s93, s46, 7
    s_lshr_b32 s94, s29, 2
    s_lshl_b32 s94, s94, 7
    s_lshl_b32 s95, s47, 7
    s_lshr_b32 s96, s3, 1
    s_lshl_b32 s96, s96, 7
    s_lshl_b32 s97, s3, 7
    s_mov_b32 s98, 2
    s_mov_b32 s99, 4
    s_mov_b32 s100, 8
    s_lshl_b32 s43, s28, 2
    s_add_u32 s43, s43, s3
    s_lshl_b32 s45, s28, 1
    s_add_u32 s45, s45, s46
    v_sub_u32 v10, s28, v1
    v_max_i32 v10, 0, v10
    v_lshlrev_b32 v10, 10, v10
    v_lshlrev_b32 v15, 3, v3
    v_lshl_add_u32 v15, v4, 17, v15
    s_lshl_b32 s62, s47, 2
    s_add_u32 s62, s62, s3
    s_lshl_b32 s63, s45, 1
    s_lshr_b32 s64, s3, 1
    s_add_u32 s64, s64, s63
    s_and_b32 s65, s3, 1
    s_lshl_b32 s40, s47, 1
    s_add_u32 s65, s65, s40
    s_lshl_b32 s66, s64, 15
    s_lshl_b32 s40, s65, 11
    s_add_u32 s66, s66, s40
    s_mul_i32 s81, s65, 32768
    s_add_u32 s81, s81, 41943040
    s_lshl_b32 s82, s65, 14
    s_lshl_b32 s40, s64, 8
    s_add_u32 s82, s82, s40
    s_mul_i32 s40, s3, 28672
    s_add_u32 s40, s40, 42467328
    s_mul_i32 s70, s65, 114688
    s_add_u32 s70, s70, s40
    s_xor_b32 s71, s65, 1
    s_mul_i32 s71, s71, 114688
    s_add_u32 s71, s71, s40
    s_mov_b32 s72, 0x0000ffff
    s_mov_b32 s73, 0x0000ffff
    s_lshl_b32 s44, s43, 15
    s_add_u32 s44, s44, s30
    s_add_u32 s44, s44, 0
    buffer_load_dwordx4 a[0:3], v236, s[24:27], s44 offen offset:0 sc1
    buffer_load_dwordx4 a[4:7], v236, s[24:27], s44 offen offset:1024 sc1
    buffer_load_dwordx4 a[8:11], v236, s[24:27], s44 offen offset:2048 sc1
    buffer_load_dwordx4 a[12:15], v236, s[24:27], s44 offen offset:3072 sc1
    buffer_load_dwordx4 a[16:19], v237, s[24:27], s44 offen offset:0 sc1
    buffer_load_dwordx4 a[20:23], v237, s[24:27], s44 offen offset:1024 sc1
    s_lshl_b32 s40, s43, 8
    s_add_u32 s40, s40, s30
    s_add_u32 s40, s40, 19922944
    buffer_load_dwordx2 v[100:101], v15, s[24:27], s40 offen sc1
    s_add_u32 s40, s40, 16384
    buffer_load_dwordx2 v[102:103], v15, s[24:27], s40 offen sc1
    s_add_u32 s40, s40, 16384
    buffer_load_dwordx2 v[104:105], v15, s[24:27], s40 offen sc1
    s_add_u32 s40, s40, 16384
    buffer_load_dwordx2 v[106:107], v15, s[24:27], s40 offen sc1
    s_add_u32 s40, s40, 16384
    buffer_load_dwordx2 v[108:109], v15, s[24:27], s40 offen sc1
    s_add_u32 s40, s40, 16384
    buffer_load_dwordx2 v[110:111], v15, s[24:27], s40 offen sc1
    s_add_u32 s40, s40, 16384
    buffer_load_dwordx2 v[112:113], v15, s[24:27], s40 offen sc1
    s_add_u32 s40, s40, 16384
    buffer_load_dwordx2 v[114:115], v15, s[24:27], s40 offen sc1
    buffer_load_dwordx4 a[24:27], v237, s[24:27], s44 offen offset:2048 sc1
    buffer_load_dwordx4 a[28:31], v237, s[24:27], s44 offen offset:3072 sc1
    buffer_load_dwordx4 a[32:35], v238, s[24:27], s44 offen offset:0 sc1
    buffer_load_dwordx4 a[36:39], v238, s[24:27], s44 offen offset:1024 sc1
    v_add_u32 v144, 49152, v2
    v_add_u32 v146, 114688, v2
    s_waitcnt vmcnt(22)
    s_barrier
    ds_read_b128 v[64:67], v144 offset:0
    ds_read_b128 v[68:71], v144 offset:1024
    ds_read_b128 v[72:75], v144 offset:2048
    ds_read_b128 v[76:79], v144 offset:3072
    ds_read_b128 v[80:83], v144 offset:4096
    ds_read_b128 v[84:87], v144 offset:5120
    ds_read_b128 v[88:91], v144 offset:6144
    s_waitcnt vmcnt(17) lgkmcnt(6)
    v_mfma_f32_32x32x16_bf16 v[16:31], v[64:67], a[0:3], 0
    ds_read_b128 v[92:95], v144 offset:7168
    buffer_load_dwordx4 a[40:43], v238, s[24:27], s44 offen offset:2048 sc1
    s_waitcnt lgkmcnt(6)
    v_mfma_f32_32x32x16_bf16 v[32:47], v[68:71], a[0:3], 0
    ds_read_b128 v[64:67], v144 offset:8192
    s_add_u32 m0, s33, 81920
    s_add_u32 s49, s49, 16384
    buffer_load_dwordx4 v2, s[84:87], s49 offen offset:0 lds
    s_waitcnt vmcnt(18) lgkmcnt(6)
    v_mfma_f32_32x32x16_bf16 v[16:31], v[72:75], a[4:7], v[16:31]
    ds_read_b128 v[68:71], v144 offset:9216
    buffer_load_dwordx4 a[44:47], v238, s[24:27], s44 offen offset:3072 sc1
    s_waitcnt lgkmcnt(6)
    v_mfma_f32_32x32x16_bf16 v[32:47], v[76:79], a[4:7], v[32:47]
    ds_read_b128 v[72:75], v144 offset:10240
    buffer_load_dwordx4 v2, s[84:87], s49 offen offset:1024 lds
    s_waitcnt vmcnt(19) lgkmcnt(6)
    v_mfma_f32_32x32x16_bf16 v[16:31], v[80:83], a[8:11], v[16:31]
    ds_read_b128 v[76:79], v144 offset:11264
    buffer_load_dwordx4 a[48:51], v239, s[24:27], s44 offen offset:0 sc1
    s_waitcnt lgkmcnt(6)
    v_mfma_f32_32x32x16_bf16 v[32:47], v[84:87], a[8:11], v[32:47]
    ds_read_b128 v[80:83], v144 offset:12288
    buffer_load_dwordx4 v2, s[84:87], s49 offen offset:2048 lds
    s_waitcnt vmcnt(20) lgkmcnt(6)
    v_mfma_f32_32x32x16_bf16 v[16:31], v[88:91], a[12:15], v[16:31]
    ds_read_b128 v[84:87], v144 offset:13312
    buffer_load_dwordx4 a[52:55], v239, s[24:27], s44 offen offset:1024 sc1
    s_waitcnt lgkmcnt(6)
    v_mfma_f32_32x32x16_bf16 v[32:47], v[92:95], a[12:15], v[32:47]
    ds_read_b128 v[88:91], v144 offset:14336
    buffer_load_dwordx4 v2, s[84:87], s49 offen offset:3072 lds
    s_waitcnt vmcnt(21) lgkmcnt(6)
    v_mfma_f32_32x32x16_bf16 v[16:31], v[64:67], a[16:19], v[16:31]
    ds_read_b128 v[92:95], v144 offset:15360
    buffer_load_dwordx4 a[56:59], v239, s[24:27], s44 offen offset:2048 sc1
    s_waitcnt lgkmcnt(6)
    v_mfma_f32_32x32x16_bf16 v[32:47], v[68:71], a[16:19], v[32:47]
    s_barrier
    ds_read_b128 v[64:67], v144 offset:16384
    s_add_u32 m0, s33, 98304
    s_add_u32 s49, s49, 16384
    buffer_load_dwordx4 v2, s[84:87], s49 offen offset:0 lds
    s_waitcnt vmcnt(22) lgkmcnt(6)
    v_mfma_f32_32x32x16_bf16 v[16:31], v[72:75], a[20:23], v[16:31]
    ds_read_b128 v[68:71], v144 offset:17408
    buffer_load_dwordx4 a[60:63], v239, s[24:27], s44 offen offset:3072 sc1
    s_waitcnt lgkmcnt(6)
    v_mfma_f32_32x32x16_bf16 v[32:47], v[76:79], a[20:23], v[32:47]
    ds_read_b128 v[72:75], v144 offset:18432
    buffer_load_dwordx4 v2, s[84:87], s49 offen offset:1024 lds
    s_waitcnt vmcnt(15) lgkmcnt(6)
    v_mfma_f32_32x32x16_bf16 v[16:31], v[80:83], a[24:27], v[16:31]
    ds_read_b128 v[76:79], v144 offset:19456
    buffer_load_dwordx4 a[64:67], v240, s[24:27], s44 offen offset:0 sc1
    s_waitcnt lgkmcnt(6)
    v_mfma_f32_32x32x16_bf16 v[32:47], v[84:87], a[24:27], v[32:47]
    ds_read_b128 v[80:83], v144 offset:20480
    buffer_load_dwordx4 v2, s[84:87], s49 offen offset:2048 lds
    s_waitcnt vmcnt(16) lgkmcnt(6)
    v_mfma_f32_32x32x16_bf16 v[16:31], v[88:91], a[28:31], v[16:31]
    ds_read_b128 v[84:87], v144 offset:21504
    buffer_load_dwordx4 a[68:71], v240, s[24:27], s44 offen offset:1024 sc1
    s_waitcnt lgkmcnt(6)
    v_mfma_f32_32x32x16_bf16 v[32:47], v[92:95], a[28:31], v[32:47]
    ds_read_b128 v[88:91], v144 offset:22528
    buffer_load_dwordx4 v2, s[84:87], s49 offen offset:3072 lds
    s_waitcnt vmcnt(17) lgkmcnt(6)
    v_mfma_f32_32x32x16_bf16 v[16:31], v[64:67], a[32:35], v[16:31]
    ds_read_b128 v[92:95], v144 offset:23552
    buffer_load_dwordx4 a[72:75], v240, s[24:27], s44 offen offset:2048 sc1
    s_waitcnt lgkmcnt(6)
    v_mfma_f32_32x32x16_bf16 v[32:47], v[68:71], a[32:35], v[32:47]
    ds_read_b128 v[64:67], v144 offset:24576
    s_add_u32 m0, s33, 114688
    s_add_u32 s49, s49, 16384
    buffer_load_dwordx4 v2, s[84:87], s49 offen offset:0 lds
    s_waitcnt vmcnt(18) lgkmcnt(6)
    v_mfma_f32_32x32x16_bf16 v[16:31], v[72:75], a[36:39], v[16:31]
    ds_read_b128 v[68:71], v144 offset:25600
    buffer_load_dwordx4 a[76:79], v240, s[24:27], s44 offen offset:3072 sc1
    s_waitcnt lgkmcnt(6)
    v_mfma_f32_32x32x16_bf16 v[32:47], v[76:79], a[36:39], v[32:47]
    ds_read_b128 v[72:75], v144 offset:26624
    buffer_load_dwordx4 v2, s[84:87], s49 offen offset:1024 lds
    s_waitcnt vmcnt(19) lgkmcnt(6)
    v_mfma_f32_32x32x16_bf16 v[16:31], v[80:83], a[40:43], v[16:31]
    ds_read_b128 v[76:79], v144 offset:27648
    buffer_load_dwordx4 a[80:83], v241, s[24:27], s44 offen offset:0 sc1
    s_waitcnt lgkmcnt(6)
    v_mfma_f32_32x32x16_bf16 v[32:47], v[84:87], a[40:43], v[32:47]
    ds_read_b128 v[80:83], v144 offset:28672
    buffer_load_dwordx4 v2, s[84:87], s49 offen offset:2048 lds
    s_waitcnt vmcnt(19) lgkmcnt(6)
    v_mfma_f32_32x32x16_bf16 v[16:31], v[88:91], a[44:47], v[16:31]
    ds_read_b128 v[84:87], v144 offset:29696
    buffer_load_dwordx4 a[84:87], v241, s[24:27], s44 offen offset:1024 sc1
    s_waitcnt lgkmcnt(6)
    v_mfma_f32_32x32x16_bf16 v[32:47], v[92:95], a[44:47], v[32:47]
    ds_read_b128 v[88:91], v144 offset:30720
    buffer_load_dwordx4 v2, s[84:87], s49 offen offset:3072 lds
    s_waitcnt vmcnt(19) lgkmcnt(6)
    v_mfma_f32_32x32x16_bf16 v[16:31], v[64:67], a[48:51], v[16:31]
    ds_read_b128 v[92:95], v144 offset:31744
    buffer_load_dwordx4 a[88:91], v241, s[24:27], s44 offen offset:2048 sc1
    v_add_f32 v100, v100, v102
    s_waitcnt lgkmcnt(6)
    v_mfma_f32_32x32x16_bf16 v[32:47], v[68:71], a[48:51], v[32:47]
    s_waitcnt vmcnt(17)
    s_barrier
    ds_read_b128 v[64:67], v144 offset:32768
    s_add_u32 m0, s33, 131072
    s_add_u32 s49, s49, 16384
    buffer_load_dwordx4 v2, s[84:87], s49 offen offset:0 lds
    v_add_f32 v101, v101, v103
    v_add_f32 v100, v100, v104
    s_waitcnt lgkmcnt(6)
    v_mfma_f32_32x32x16_bf16 v[16:31], v[72:75], a[52:55], v[16:31]
    ds_read_b128 v[68:71], v144 offset:33792
    buffer_load_dwordx4 a[92:95], v241, s[24:27], s44 offen offset:3072 sc1
    v_add_f32 v101, v101, v105
    v_add_f32 v100, v100, v106
    s_waitcnt lgkmcnt(6)
    v_mfma_f32_32x32x16_bf16 v[32:47], v[76:79], a[52:55], v[32:47]
    ds_read_b128 v[72:75], v144 offset:34816
    buffer_load_dwordx4 v2, s[84:87], s49 offen offset:1024 lds
    v_add_f32 v101, v101, v107
    v_add_f32 v100, v100, v108
    s_waitcnt vmcnt(19) lgkmcnt(6)
    v_mfma_f32_32x32x16_bf16 v[16:31], v[80:83], a[56:59], v[16:31]
    ds_read_b128 v[76:79], v144 offset:35840
    buffer_load_dwordx4 a[96:99], v242, s[24:27], s44 offen offset:0 sc1
    v_add_f32 v101, v101, v109
    v_add_f32 v100, v100, v110
    s_waitcnt lgkmcnt(6)
    v_mfma_f32_32x32x16_bf16 v[32:47], v[84:87], a[56:59], v[32:47]
    ds_read_b128 v[80:83], v144 offset:36864
    buffer_load_dwordx4 v2, s[84:87], s49 offen offset:2048 lds
    v_add_f32 v101, v101, v111
    v_add_f32 v100, v100, v112
    s_waitcnt vmcnt(19) lgkmcnt(6)
    v_mfma_f32_32x32x16_bf16 v[16:31], v[88:91], a[60:63], v[16:31]
    ds_read_b128 v[84:87], v144 offset:37888
    buffer_load_dwordx4 a[100:103], v242, s[24:27], s44 offen offset:1024 sc1
    v_add_f32 v101, v101, v113
    v_add_f32 v100, v100, v114
    s_waitcnt lgkmcnt(6)
    v_mfma_f32_32x32x16_bf16 v[32:47], v[92:95], a[60:63], v[32:47]
    ds_read_b128 v[88:91], v144 offset:38912
    buffer_load_dwordx4 v2, s[84:87], s49 offen offset:3072 lds
    v_add_f32 v101, v101, v115
    v_mov_b32 v102, v100
    s_waitcnt vmcnt(19) lgkmcnt(6)
    v_mfma_f32_32x32x16_bf16 v[16:31], v[64:67], a[64:67], v[16:31]
    ds_read_b128 v[92:95], v144 offset:39936
    buffer_load_dwordx4 a[104:107], v242, s[24:27], s44 offen offset:2048 sc1
    v_mov_b32 v103, v101
    s_nop 1
    s_waitcnt lgkmcnt(6)
    v_mfma_f32_32x32x16_bf16 v[32:47], v[68:71], a[64:67], v[32:47]
    ds_read_b128 v[64:67], v144 offset:40960
    s_add_u32 m0, s33, 147456
    s_add_u32 s49, s49, 16384
    buffer_load_dwordx4 v2, s[84:87], s49 offen offset:0 lds
    v_permlane32_swap_b32 v100, v102
    v_permlane32_swap_b32 v101, v103
    s_waitcnt vmcnt(19) lgkmcnt(6)
    v_mfma_f32_32x32x16_bf16 v[16:31], v[72:75], a[68:71], v[16:31]
    ds_read_b128 v[68:71], v144 offset:41984
    buffer_load_dwordx4 a[108:111], v242, s[24:27], s44 offen offset:3072 sc1
    v_add_f32 v100, v100, v102
    v_add_f32 v101, v101, v103
    s_waitcnt lgkmcnt(6)
    v_mfma_f32_32x32x16_bf16 v[32:47], v[76:79], a[68:71], v[32:47]
    ds_read_b128 v[72:75], v144 offset:43008
    buffer_load_dwordx4 v2, s[84:87], s49 offen offset:1024 lds
    v_mul_f32 v100, -0.001953125, v100
    v_mul_f32 v101, 0.001953125, v101
    s_waitcnt vmcnt(19) lgkmcnt(6)
    v_mfma_f32_32x32x16_bf16 v[16:31], v[80:83], a[72:75], v[16:31]
    ds_read_b128 v[76:79], v144 offset:44032
    buffer_load_dwordx4 a[112:115], v243, s[24:27], s44 offen offset:0 sc1
    v_fma_f32 v101, -v100, v100, v101
    v_max_f32 v101, 0, v101
    s_waitcnt lgkmcnt(6)
    v_mfma_f32_32x32x16_bf16 v[32:47], v[84:87], a[72:75], v[32:47]
    ds_read_b128 v[80:83], v144 offset:45056
    buffer_load_dwordx4 v2, s[84:87], s49 offen offset:2048 lds
    v_cvt_pk_bf16_f32 v102, v101, v101
    v_lshlrev_b32 v101, 16, v102
    s_waitcnt vmcnt(19) lgkmcnt(6)
    v_mfma_f32_32x32x16_bf16 v[16:31], v[88:91], a[76:79], v[16:31]
    ds_read_b128 v[84:87], v144 offset:46080
    buffer_load_dwordx4 a[116:119], v243, s[24:27], s44 offen offset:1024 sc1
    v_add_f32 v101, 1e-5, v101
    v_cvt_pk_bf16_f32 v102, v101, v101
    s_waitcnt lgkmcnt(6)
    v_mfma_f32_32x32x16_bf16 v[32:47], v[92:95], a[76:79], v[32:47]
    ds_read_b128 v[88:91], v144 offset:47104
    buffer_load_dwordx4 v2, s[84:87], s49 offen offset:3072 lds
    v_lshlrev_b32 v101, 16, v102
    v_sqrt_f32 v101, v101
    s_waitcnt vmcnt(19) lgkmcnt(6)
    v_mfma_f32_32x32x16_bf16 v[16:31], v[64:67], a[80:83], v[16:31]
    ds_read_b128 v[92:95], v144 offset:48128
    buffer_load_dwordx4 a[120:123], v243, s[24:27], s44 offen offset:2048 sc1
    v_cmp_eq_u32 vcc, 0, v4
    v_cvt_pk_bf16_f32 v102, v101, v101
    s_waitcnt lgkmcnt(6)
    v_mfma_f32_32x32x16_bf16 v[32:47], v[68:71], a[80:83], v[32:47]
    s_barrier
    ds_read_b128 v[64:67], v144 offset:49152
    v_lshlrev_b32 v101, 16, v102
    v_rcp_f32 v12, v101
    s_waitcnt vmcnt(18) lgkmcnt(6)
    v_mfma_f32_32x32x16_bf16 v[16:31], v[72:75], a[84:87], v[16:31]
    ds_read_b128 v[68:71], v144 offset:50176
    buffer_load_dwordx4 a[124:127], v243, s[24:27], s44 offen offset:3072 sc1
    buffer_load_dwordx4 a[128:131], v236, s[24:27], s81 offen offset:0
    v_cvt_pk_bf16_f32 v102, v100, v100
    v_and_b32 v103, 0xffff, v102
    s_waitcnt lgkmcnt(6)
    v_mfma_f32_32x32x16_bf16 v[32:47], v[76:79], a[84:87], v[32:47]
    ds_read_b128 v[72:75], v144 offset:51200
    v_mov_b32 v118, 0
    v_cndmask_b32 v116, 0, v102, vcc
    s_waitcnt vmcnt(18) lgkmcnt(6)
    v_mfma_f32_32x32x16_bf16 v[16:31], v[80:83], a[88:91], v[16:31]
    ds_read_b128 v[76:79], v144 offset:52224
    buffer_load_dwordx4 a[132:135], v236, s[24:27], s81 offen offset:1024
    v_cndmask_b32 v117, 0, v103, vcc
    v_mov_b32 v119, 0
    s_waitcnt lgkmcnt(6)
    v_mfma_f32_32x32x16_bf16 v[32:47], v[84:87], a[88:91], v[32:47]
    ds_read_b128 v[80:83], v144 offset:53248
    s_lshl_b32 s40, s3, 7
    s_add_u32 s40, s40, 0
    s_waitcnt vmcnt(17) lgkmcnt(6)
    v_mfma_f32_32x32x16_bf16 v[16:31], v[88:91], a[92:95], v[16:31]
    ds_read_b128 v[84:87], v144 offset:54272
    buffer_load_dwordx4 a[136:139], v236, s[24:27], s81 offen offset:2048
    v_lshl_add_u32 v7, v3, 2, s40
    ds_write_b32 v7, v12
    s_waitcnt lgkmcnt(7)
    v_mfma_f32_32x32x16_bf16 v[32:47], v[92:95], a[92:95], v[32:47]
    ds_read_b128 v[88:91], v144 offset:55296
    v_lshl_add_u32 v7, v4, 4, s40
    ds_read_b128 v[120:123], v7 offset:0
    s_waitcnt vmcnt(16) lgkmcnt(8)
    v_mfma_f32_32x32x16_bf16 v[16:31], v[64:67], a[96:99], v[16:31]
    ds_read_b128 v[92:95], v144 offset:56320
    buffer_load_dwordx4 a[140:143], v236, s[24:27], s81 offen offset:3072
    ds_read_b128 v[124:127], v7 offset:32
    ds_read_b128 v[128:131], v7 offset:64
    s_waitcnt lgkmcnt(10)
    v_mfma_f32_32x32x16_bf16 v[32:47], v[68:71], a[96:99], v[32:47]
    ds_read_b128 v[64:67], v144 offset:57344
    ds_read_b128 v[132:135], v7 offset:96
    v_mul_f32 v13, 0.36067376022224085, v12
    s_waitcnt vmcnt(15) lgkmcnt(11)
    v_mfma_f32_32x32x16_bf16 v[16:31], v[72:75], a[100:103], v[16:31]
    ds_read_b128 v[68:71], v144 offset:58368
    buffer_load_dwordx4 a[144:147], v237, s[24:27], s81 offen offset:0
    s_waitcnt lgkmcnt(11)
    v_mfma_f32_32x32x16_bf16 v[32:47], v[76:79], a[100:103], v[32:47]
    ds_read_b128 v[72:75], v144 offset:59392
    s_waitcnt vmcnt(14) lgkmcnt(11)
    v_mfma_f32_32x32x16_bf16 v[16:31], v[80:83], a[104:107], v[16:31]
    ds_read_b128 v[76:79], v144 offset:60416
    buffer_load_dwordx4 a[148:151], v237, s[24:27], s81 offen offset:1024
    s_waitcnt lgkmcnt(11)
    v_mfma_f32_32x32x16_bf16 v[32:47], v[84:87], a[104:107], v[32:47]
    ds_read_b128 v[80:83], v144 offset:61440
    s_waitcnt vmcnt(13) lgkmcnt(10)
    v_mfma_f32_32x32x16_bf16 v[16:31], v[88:91], a[108:111], v[16:31]
    ds_read_b128 v[84:87], v144 offset:62464
    buffer_load_dwordx4 a[152:155], v237, s[24:27], s81 offen offset:2048
    s_waitcnt lgkmcnt(9)
    v_mfma_f32_32x32x16_bf16 v[32:47], v[92:95], a[108:111], v[32:47]
    ds_read_b128 v[88:91], v144 offset:63488
    s_waitcnt vmcnt(12) lgkmcnt(7)
    v_mfma_f32_32x32x16_bf16 v[16:31], v[64:67], a[112:115], v[16:31]
    ds_read_b128 v[92:95], v144 offset:64512
    buffer_load_dwordx4 a[156:159], v237, s[24:27], s81 offen offset:3072
    s_waitcnt lgkmcnt(6)
    v_mfma_f32_32x32x16_bf16 v[32:47], v[68:71], a[112:115], v[32:47]
    s_barrier
    ds_read_b128 v[64:67], v146 offset:0
    s_waitcnt vmcnt(11) lgkmcnt(6)
    v_mfma_f32_32x32x16_bf16 v[16:31], v[72:75], a[116:119], v[16:31]
    ds_read_b128 v[68:71], v146 offset:1024
    buffer_load_dwordx4 a[160:163], v238, s[24:27], s81 offen offset:0
    s_waitcnt lgkmcnt(6)
    v_mfma_f32_32x32x16_bf16 v[32:47], v[76:79], a[116:119], v[32:47]
    ds_read_b128 v[72:75], v146 offset:2048
    s_waitcnt vmcnt(10) lgkmcnt(6)
    v_mfma_f32_32x32x16_bf16 v[16:31], v[80:83], a[120:123], v[16:31]
    ds_read_b128 v[76:79], v146 offset:3072
    buffer_load_dwordx4 a[164:167], v238, s[24:27], s81 offen offset:1024
    s_waitcnt lgkmcnt(6)
    v_mfma_f32_32x32x16_bf16 v[32:47], v[84:87], a[120:123], v[32:47]
    ds_read_b128 v[80:83], v146 offset:4096
    s_waitcnt vmcnt(10) lgkmcnt(6)
    v_mfma_f32_32x32x16_bf16 v[16:31], v[88:91], a[124:127], v[16:31]
    ds_read_b128 v[84:87], v146 offset:5120
    buffer_load_dwordx4 a[168:171], v238, s[24:27], s81 offen offset:2048
    s_waitcnt lgkmcnt(6)
    v_mfma_f32_32x32x16_bf16 v[32:47], v[92:95], a[124:127], v[32:47]
    ds_read_b128 v[88:91], v146 offset:6144
    s_nop 1
    s_waitcnt lgkmcnt(6)
    v_mfma_f32_32x32x16_bf16 v[16:31], v[64:67], v[116:119], v[16:31]
    ds_read_b128 v[92:95], v146 offset:7168
    buffer_load_dwordx4 a[172:175], v238, s[24:27], s81 offen offset:3072
    s_waitcnt lgkmcnt(6)
    v_mfma_f32_32x32x16_bf16 v[32:47], v[68:71], v[116:119], v[32:47]
    ds_read_b128 v[64:67], v146 offset:8192
    s_waitcnt lgkmcnt(6)
    v_mfma_f32_32x32x16_bf16 v[48:63], a[0:3], v[72:75], 0
    ds_read_b128 v[68:71], v146 offset:9216
    buffer_load_dwordx4 a[176:179], v239, s[24:27], s81 offen offset:0
    s_waitcnt lgkmcnt(6)
    v_mfma_f32_32x32x16_bf16 v[48:63], a[4:7], v[76:79], v[48:63]
    ds_read_b128 v[72:75], v146 offset:10240
    s_waitcnt lgkmcnt(6)
    v_mfma_f32_32x32x16_bf16 v[48:63], a[8:11], v[80:83], v[48:63]
    ds_read_b128 v[76:79], v146 offset:11264
    buffer_load_dwordx4 a[180:183], v239, s[24:27], s81 offen offset:1024
    s_waitcnt lgkmcnt(6)
    v_mfma_f32_32x32x16_bf16 v[48:63], a[12:15], v[84:87], v[48:63]
    ds_read_b128 v[80:83], v146 offset:12288
    s_lshl_b32 s40, s29, 17
    s_lshl_b32 s41, s43, 10
    s_add_u32 s44, s40, s41
    s_add_u32 s44, s44, s30
    v_mul_f32 v16, v13, v16
    v_mul_f32 v17, v13, v17
    s_waitcnt lgkmcnt(6)
    v_mfma_f32_32x32x16_bf16 v[48:63], a[16:19], v[88:91], v[48:63]
    ds_read_b128 v[84:87], v146 offset:13312
    buffer_load_dwordx4 a[184:187], v239, s[24:27], s81 offen offset:2048
    v_mul_f32 v18, v13, v18
    v_mul_f32 v19, v13, v19
    v_mul_f32 v20, v13, v20
    v_mul_f32 v21, v13, v21
    v_mul_f32 v22, v13, v22
    v_mul_f32 v23, v13, v23
    s_waitcnt lgkmcnt(6)
    v_mfma_f32_32x32x16_bf16 v[48:63], a[20:23], v[92:95], v[48:63]
    ds_read_b128 v[88:91], v146 offset:14336
    v_mul_f32 v24, v13, v24
    v_mul_f32 v25, v13, v25
    v_mul_f32 v26, v13, v26
    v_mul_f32 v27, v13, v27
    v_mul_f32 v28, v13, v28
    v_mul_f32 v29, v13, v29
    s_waitcnt lgkmcnt(6)
    v_mfma_f32_32x32x16_bf16 v[48:63], a[24:27], v[64:67], v[48:63]
    ds_read_b128 v[92:95], v146 offset:15360
    buffer_load_dwordx4 a[188:191], v239, s[24:27], s81 offen offset:3072
    v_mul_f32 v30, v13, v30
    v_mul_f32 v31, v13, v31
    v_cvt_pk_bf16_f32 v136, v16, v17
    v_cvt_pk_bf16_f32 v137, v18, v19
    v_cvt_pk_bf16_f32 v138, v20, v21
    v_cvt_pk_bf16_f32 v139, v22, v23
    s_waitcnt lgkmcnt(6)
    v_mfma_f32_32x32x16_bf16 v[48:63], a[28:31], v[68:71], v[48:63]
    s_barrier
    ds_read_b128 v[64:67], v146 offset:16384
    v_cvt_pk_bf16_f32 v140, v24, v25
    v_cvt_pk_bf16_f32 v141, v26, v27
    v_cvt_pk_bf16_f32 v142, v28, v29
    v_cvt_pk_bf16_f32 v143, v30, v31
    s_add_u32 s40, s44, 2097152
    s_add_u32 s41, s40, 65536
    s_waitcnt lgkmcnt(6)
    v_mfma_f32_32x32x16_bf16 v[48:63], a[32:35], v[72:75], v[48:63]
    ds_read_b128 v[68:71], v146 offset:17408
    v_permlane32_swap_b32 v136, v138
    v_permlane32_swap_b32 v137, v139
    v_permlane32_swap_b32 v140, v142
    v_permlane32_swap_b32 v141, v143
    buffer_store_dwordx4 v[136:139], v2, s[24:27], s40 offen sc1
    buffer_store_dwordx4 v[140:143], v2, s[24:27], s41 offen sc1
    s_waitcnt lgkmcnt(6)
    v_mfma_f32_32x32x16_bf16 v[48:63], a[36:39], v[76:79], v[48:63]
    ds_read_b128 v[72:75], v146 offset:18432
    v_mul_f32 v32, v12, v32
    v_mul_f32 v33, v12, v33
    v_mul_f32 v34, v12, v34
    v_mul_f32 v35, v12, v35
    v_mul_f32 v36, v12, v36
    v_mul_f32 v37, v12, v37
    s_waitcnt lgkmcnt(6)
    v_mfma_f32_32x32x16_bf16 v[48:63], a[40:43], v[80:83], v[48:63]
    ds_read_b128 v[76:79], v146 offset:19456
    v_mul_f32 v38, v12, v38
    v_mul_f32 v39, v12, v39
    v_mul_f32 v40, v12, v40
    v_mul_f32 v41, v12, v41
    v_mul_f32 v42, v12, v42
    v_mul_f32 v43, v12, v43
    s_waitcnt lgkmcnt(6)
    v_mfma_f32_32x32x16_bf16 v[48:63], a[44:47], v[84:87], v[48:63]
    ds_read_b128 v[80:83], v146 offset:20480
    v_mul_f32 v44, v12, v44
    v_mul_f32 v45, v12, v45
    v_mul_f32 v46, v12, v46
    v_mul_f32 v47, v12, v47
    v_cvt_pk_bf16_f32 v100, v32, v33
    v_cvt_pk_bf16_f32 v101, v34, v35
    s_waitcnt lgkmcnt(6)
    v_mfma_f32_32x32x16_bf16 v[48:63], a[48:51], v[88:91], v[48:63]
    ds_read_b128 v[84:87], v146 offset:21504
    v_cvt_pk_bf16_f32 v102, v36, v37
    v_cvt_pk_bf16_f32 v103, v38, v39
    v_cvt_pk_bf16_f32 v104, v40, v41
    v_cvt_pk_bf16_f32 v105, v42, v43
    v_cvt_pk_bf16_f32 v106, v44, v45
    v_cvt_pk_bf16_f32 v107, v46, v47
    s_waitcnt lgkmcnt(6)
    v_mfma_f32_32x32x16_bf16 v[48:63], a[52:55], v[92:95], v[48:63]
    ds_read_b128 v[88:91], v146 offset:22528
    s_add_u32 s40, s44, 4194304
    s_add_u32 s41, s40, 65536
    v_permlane32_swap_b32 v100, v102
    v_permlane32_swap_b32 v101, v103
    v_permlane32_swap_b32 v104, v106
    v_permlane32_swap_b32 v105, v107
    s_waitcnt lgkmcnt(6)
    v_mfma_f32_32x32x16_bf16 v[48:63], a[56:59], v[64:67], v[48:63]
    ds_read_b128 v[92:95], v146 offset:23552
    buffer_store_dwordx4 v[100:103], v2, s[24:27], s40 offen sc1
    buffer_store_dwordx4 v[104:107], v2, s[24:27], s41 offen sc1
    v_lshrrev_b32 v145, 4, v3
    v_lshlrev_b32 v145, 16, v145
    v_lshl_add_u32 v145, v4, 8, v145
    v_and_b32 v8, 15, v3
    s_waitcnt lgkmcnt(6)
    v_mfma_f32_32x32x16_bf16 v[48:63], a[60:63], v[68:71], v[48:63]
    ds_read_b128 v[64:67], v146 offset:24576
    v_lshl_add_u32 v145, v8, 4, v145
    s_add_u32 s40, s44, 6291456
    s_waitcnt lgkmcnt(6)
    v_mfma_f32_32x32x16_bf16 v[48:63], a[64:67], v[72:75], v[48:63]
    ds_read_b128 v[68:71], v146 offset:25600
    s_waitcnt lgkmcnt(6)
    v_mfma_f32_32x32x16_bf16 v[48:63], a[68:71], v[76:79], v[48:63]
    ds_read_b128 v[72:75], v146 offset:26624
    s_waitcnt lgkmcnt(6)
    v_mfma_f32_32x32x16_bf16 v[48:63], a[72:75], v[80:83], v[48:63]
    ds_read_b128 v[76:79], v146 offset:27648
    s_waitcnt lgkmcnt(6)
    v_mfma_f32_32x32x16_bf16 v[48:63], a[76:79], v[84:87], v[48:63]
    ds_read_b128 v[80:83], v146 offset:28672
    s_waitcnt lgkmcnt(6)
    v_mfma_f32_32x32x16_bf16 v[48:63], a[80:83], v[88:91], v[48:63]
    ds_read_b128 v[84:87], v146 offset:29696
    s_waitcnt lgkmcnt(6)
    v_mfma_f32_32x32x16_bf16 v[48:63], a[84:87], v[92:95], v[48:63]
    ds_read_b128 v[88:91], v146 offset:30720
    s_waitcnt lgkmcnt(6)
    v_mfma_f32_32x32x16_bf16 v[48:63], a[88:91], v[64:67], v[48:63]
    ds_read_b128 v[92:95], v146 offset:31744
    s_waitcnt lgkmcnt(6)
    v_mfma_f32_32x32x16_bf16 v[48:63], a[92:95], v[68:71], v[48:63]
    s_barrier
    ds_read_b128 v[64:67], v146 offset:32768
    s_waitcnt lgkmcnt(6)
    v_mfma_f32_32x32x16_bf16 v[48:63], a[96:99], v[72:75], v[48:63]
    ds_read_b128 v[68:71], v146 offset:33792
    s_waitcnt lgkmcnt(6)
    v_mfma_f32_32x32x16_bf16 v[48:63], a[100:103], v[76:79], v[48:63]
    ds_read_b128 v[72:75], v146 offset:34816
    s_waitcnt lgkmcnt(6)
    v_mfma_f32_32x32x16_bf16 v[48:63], a[104:107], v[80:83], v[48:63]
    s_waitcnt lgkmcnt(5)
    v_mfma_f32_32x32x16_bf16 v[48:63], a[108:111], v[84:87], v[48:63]
    s_waitcnt lgkmcnt(4)
    v_mfma_f32_32x32x16_bf16 v[48:63], a[112:115], v[88:91], v[48:63]
    s_waitcnt lgkmcnt(3)
    v_mfma_f32_32x32x16_bf16 v[48:63], a[116:119], v[92:95], v[48:63]
    s_add_u32 s42, s32, 0
    s_add_u32 s42, s42, s92
    s_cmp_lg_u32 s3, 0
    s_waitcnt vmcnt(0)
    s_barrier
    s_cbranch_scc1 pk_kernel_sg_1
    s_mov_b64 exec, 1
    buffer_atomic_add v5, v6, s[24:27], s42 offen sc1
    s_mov_b64 exec, -1
pk_kernel_sg_1:
    s_waitcnt lgkmcnt(2)
    v_mfma_f32_32x32x16_bf16 v[48:63], a[120:123], v[64:67], v[48:63]
    s_waitcnt lgkmcnt(1)
    v_mfma_f32_32x32x16_bf16 v[48:63], a[124:127], v[68:71], v[48:63]
    s_waitcnt lgkmcnt(0)
    v_mfma_f32_32x32x16_bf16 v[48:63], v[116:119], v[72:75], v[48:63]
    s_nop 7
    s_nop 3
    v_mul_f32 v48, v120, v48
    v_mul_f32 v49, v121, v49
    v_mul_f32 v50, v122, v50
    v_mul_f32 v51, v123, v51
    v_mul_f32 v52, v124, v52
    v_mul_f32 v53, v125, v53
    v_mul_f32 v54, v126, v54
    v_mul_f32 v55, v127, v55
    v_mul_f32 v56, v128, v56
    v_mul_f32 v57, v129, v57
    v_mul_f32 v58, v130, v58
    v_mul_f32 v59, v131, v59
    v_mul_f32 v60, v132, v60
    v_mul_f32 v61, v133, v61
    v_mul_f32 v62, v134, v62
    v_mul_f32 v63, v135, v63
    v_cvt_pk_bf16_f32 v64, v48, v49
    v_cvt_pk_bf16_f32 v65, v50, v51
    v_cvt_pk_bf16_f32 v66, v52, v53
    v_cvt_pk_bf16_f32 v67, v54, v55
    v_cvt_pk_bf16_f32 v68, v56, v57
    v_cvt_pk_bf16_f32 v69, v58, v59
    v_cvt_pk_bf16_f32 v70, v60, v61
    v_cvt_pk_bf16_f32 v71, v62, v63
    buffer_store_dwordx4 v[64:67], v145, s[24:27], s40 offen sc1
    buffer_store_dwordx4 v[68:71], v145, s[24:27], s40 offen offset:512 sc1
    v_lshlrev_b32 v7, 2, v4
    v_sub_u32 v8, v3, v7
    v_mov_b32 v234, 0xf149f2ca
    v_cmp_le_i32 s[74:75], 0, v8
    v_cmp_le_i32 s[76:77], 1, v8
    v_cmp_le_i32 s[78:79], 2, v8
    s_nop 1
    v_cndmask_b32 v32, v234, 0, s[74:75]
    v_cndmask_b32 v16, 0, v234, s[74:75]
    v_cndmask_b32 v33, v234, 0, s[76:77]
    v_cndmask_b32 v17, 0, v234, s[76:77]
    v_cndmask_b32 v34, v234, 0, s[78:79]
    v_cndmask_b32 v18, 0, v234, s[78:79]
    v_cmp_le_i32 s[74:75], 3, v8
    v_cmp_le_i32 s[76:77], 8, v8
    v_cmp_le_i32 s[78:79], 9, v8
    s_nop 1
    v_cndmask_b32 v35, v234, 0, s[74:75]
    v_cndmask_b32 v19, 0, v234, s[74:75]
    v_cndmask_b32 v36, v234, 0, s[76:77]
    v_cndmask_b32 v20, 0, v234, s[76:77]
    v_cndmask_b32 v37, v234, 0, s[78:79]
    v_cndmask_b32 v21, 0, v234, s[78:79]
    v_cmp_le_i32 s[74:75], 10, v8
    v_cmp_le_i32 s[76:77], 11, v8
    v_cmp_le_i32 s[78:79], 16, v8
    s_nop 1
    v_cndmask_b32 v38, v234, 0, s[74:75]
    v_cndmask_b32 v22, 0, v234, s[74:75]
    v_cndmask_b32 v39, v234, 0, s[76:77]
    v_cndmask_b32 v23, 0, v234, s[76:77]
    v_cndmask_b32 v40, v234, 0, s[78:79]
    v_cndmask_b32 v24, 0, v234, s[78:79]
    v_cmp_le_i32 s[74:75], 17, v8
    v_cmp_le_i32 s[76:77], 18, v8
    v_cmp_le_i32 s[78:79], 19, v8
    s_nop 1
    v_cndmask_b32 v41, v234, 0, s[74:75]
    v_cndmask_b32 v25, 0, v234, s[74:75]
    v_cndmask_b32 v42, v234, 0, s[76:77]
    v_cndmask_b32 v26, 0, v234, s[76:77]
    v_cndmask_b32 v43, v234, 0, s[78:79]
    v_cndmask_b32 v27, 0, v234, s[78:79]
    v_cmp_le_i32 s[74:75], 24, v8
    v_cmp_le_i32 s[76:77], 25, v8
    v_cmp_le_i32 s[78:79], 26, v8
    s_nop 1
    v_cndmask_b32 v44, v234, 0, s[74:75]
    v_cndmask_b32 v28, 0, v234, s[74:75]
    v_cndmask_b32 v45, v234, 0, s[76:77]
    v_cndmask_b32 v29, 0, v234, s[76:77]
    v_cndmask_b32 v46, v234, 0, s[78:79]
    v_cndmask_b32 v30, 0, v234, s[78:79]
    v_cmp_le_i32 s[74:75], 27, v8
    s_nop 1
    v_cndmask_b32 v47, v234, 0, s[74:75]
    v_cndmask_b32 v31, 0, v234, s[74:75]
    v_lshlrev_b32 v235, 4, v3
    v_lshl_add_u32 v235, v4, 8, v235
    s_lshl_b32 s41, s62, 16
    s_add_u32 s41, s41, s30
    s_add_u32 s41, s41, 4194304
    s_sub_i32 s40, s63, 8
    s_max_i32 s40, s40, 0
    s_lshl_b32 s40, s40, 10
    s_add_u32 s52, s40, s41
    s_sub_i32 s40, s63, 7
    s_max_i32 s40, s40, 0
    s_lshl_b32 s40, s40, 10
    s_add_u32 s53, s40, s41
    s_sub_i32 s40, s63, 6
    s_max_i32 s40, s40, 0
    s_lshl_b32 s40, s40, 10
    s_add_u32 s54, s40, s41
    s_sub_i32 s40, s63, 5
    s_max_i32 s40, s40, 0
    s_lshl_b32 s40, s40, 10
    s_add_u32 s55, s40, s41
    s_sub_i32 s40, s63, 4
    s_max_i32 s40, s40, 0
    s_lshl_b32 s40, s40, 10
    s_add_u32 s56, s40, s41
    s_sub_i32 s40, s63, 3
    s_max_i32 s40, s40, 0
    s_lshl_b32 s40, s40, 10
    s_add_u32 s57, s40, s41
    s_sub_i32 s40, s63, 2
    s_max_i32 s40, s40, 0
    s_lshl_b32 s40, s40, 10
    s_add_u32 s58, s40, s41
    s_sub_i32 s40, s63, 1
    s_max_i32 s40, s40, 0
    s_lshl_b32 s40, s40, 10
    s_add_u32 s59, s40, s41
    s_sub_i32 s40, s63, 0
    s_max_i32 s40, s40, 0
    s_lshl_b32 s40, s40, 10
    s_add_u32 s60, s40, s41
    s_sub_i32 s40, s63, -1
    s_max_i32 s40, s40, 0
    s_lshl_b32 s40, s40, 10
    s_add_u32 s61, s40, s41
    v_add_u32 v235, 2097152, v235
    s_mov_b64 exec, 7
    s_add_u32 s42, s95, 49987584
    buffer_load_dword v11, v10, s[24:27], s42 offen sc1
    s_mov_b64 exec, -1
    s_add_u32 s42, s32, 16384
    s_add_u32 s42, s42, s92
    s_cmp_lg_u32 s3, 0
    s_waitcnt vmcnt(0)
    s_barrier
    s_cbranch_scc1 pk_kernel_sg_2
    s_mov_b64 exec, 1
    buffer_atomic_add v5, v6, s[24:27], s42 offen sc1
    s_mov_b64 exec, -1
pk_kernel_sg_2:
pk_kernel_loop:
    v_cmp_gt_u32 vcc, s98, v11
    s_and_b32 vcc_lo, vcc_lo, 7
    s_cbranch_scc1 pk_kernel_sp_3
pk_kernel_pr_4:
    s_sub_u32 s40, s60, 2097152
    buffer_load_dwordx4 v[224:227], v2, s[24:27], s40 offen sc1
    s_sub_u32 s40, s61, 2097152
    buffer_load_dwordx4 v[228:231], v2, s[24:27], s40 offen sc1
    buffer_load_dwordx4 a[0:3], v2, s[24:27], s52 offen sc1
    buffer_load_dwordx4 a[4:7], v2, s[24:27], s53 offen sc1
    buffer_load_dwordx4 a[8:11], v2, s[24:27], s54 offen sc1
    buffer_load_dwordx4 a[12:15], v2, s[24:27], s55 offen sc1
    buffer_load_dwordx4 a[16:19], v2, s[24:27], s56 offen sc1
    buffer_load_dwordx4 a[20:23], v2, s[24:27], s57 offen sc1
    buffer_load_dwordx4 a[24:27], v2, s[24:27], s58 offen sc1
    buffer_load_dwordx4 a[28:31], v2, s[24:27], s59 offen sc1
    buffer_load_dwordx4 a[32:35], v2, s[24:27], s60 offen sc1
    buffer_load_dwordx4 a[36:39], v2, s[24:27], s61 offen sc1
    s_mov_b64 exec, 7
    s_add_u32 s42, s95, 50003968
    buffer_load_dword v11, v10, s[24:27], s42 offen sc1
    s_mov_b64 exec, -1
    v_mov_b32 v7, 0x3f803f80
    v_accvgpr_write_b32 a40, v7
    v_accvgpr_write_b32 a41, v7
    v_accvgpr_write_b32 a42, v7
    v_accvgpr_write_b32 a43, v7
    v_accvgpr_write_b32 a44, v7
    v_accvgpr_write_b32 a45, v7
    v_accvgpr_write_b32 a46, v7
    v_accvgpr_write_b32 a47, v7
    v_accvgpr_write_b32 a48, v7
    v_accvgpr_write_b32 a49, v7
    v_accvgpr_write_b32 a50, v7
    v_accvgpr_write_b32 a51, v7
    v_accvgpr_write_b32 a52, v7
    v_accvgpr_write_b32 a53, v7
    v_accvgpr_write_b32 a54, v7
    v_accvgpr_write_b32 a55, v7
    v_accvgpr_write_b32 a56, v7
    v_accvgpr_write_b32 a57, v7
    v_accvgpr_write_b32 a58, v7
    v_accvgpr_write_b32 a59, v7
    v_accvgpr_write_b32 a60, v7
    v_accvgpr_write_b32 a61, v7
    v_accvgpr_write_b32 a62, v7
    v_accvgpr_write_b32 a63, v7
    v_accvgpr_write_b32 a64, v7
    v_accvgpr_write_b32 a65, v7
    v_accvgpr_write_b32 a66, v7
    v_accvgpr_write_b32 a67, v7
    v_accvgpr_write_b32 a68, v7
    v_accvgpr_write_b32 a69, v7
    v_accvgpr_write_b32 a70, v7
    v_accvgpr_write_b32 a71, v7
    v_accvgpr_write_b32 a72, v7
    v_accvgpr_write_b32 a73, v7
    v_accvgpr_write_b32 a74, v7
    v_accvgpr_write_b32 a75, v7
    v_accvgpr_write_b32 a76, v7
    v_accvgpr_write_b32 a77, v7
    v_accvgpr_write_b32 a78, v7
    v_accvgpr_write_b32 a79, v7
    v_accvgpr_write_b32 a80, v7
    v_accvgpr_write_b32 a81, v7
    v_accvgpr_write_b32 a82, v7
    v_accvgpr_write_b32 a83, v7
    v_accvgpr_write_b32 a84, v7
    v_accvgpr_write_b32 a85, v7
    v_accvgpr_write_b32 a86, v7
    v_accvgpr_write_b32 a87, v7
    v_accvgpr_write_b32 a88, v7
    v_accvgpr_write_b32 a89, v7
    v_accvgpr_write_b32 a90, v7
    v_accvgpr_write_b32 a91, v7
    v_accvgpr_write_b32 a92, v7
    v_accvgpr_write_b32 a93, v7
    v_accvgpr_write_b32 a94, v7
    v_accvgpr_write_b32 a95, v7
    v_accvgpr_write_b32 a96, v7
    v_accvgpr_write_b32 a97, v7
    v_accvgpr_write_b32 a98, v7
    v_accvgpr_write_b32 a99, v7
    v_accvgpr_write_b32 a100, v7
    v_accvgpr_write_b32 a101, v7
    v_accvgpr_write_b32 a102, v7
    v_accvgpr_write_b32 a103, v7
    v_accvgpr_write_b32 a104, v7
    v_accvgpr_write_b32 a105, v7
    v_accvgpr_write_b32 a106, v7
    v_accvgpr_write_b32 a107, v7
    v_accvgpr_write_b32 a108, v7
    v_accvgpr_write_b32 a109, v7
    v_accvgpr_write_b32 a110, v7
    v_accvgpr_write_b32 a111, v7
    v_accvgpr_write_b32 a112, v7
    v_accvgpr_write_b32 a113, v7
    v_accvgpr_write_b32 a114, v7
    v_accvgpr_write_b32 a115, v7
    v_accvgpr_write_b32 a116, v7
    v_accvgpr_write_b32 a117, v7
    v_accvgpr_write_b32 a118, v7
    v_accvgpr_write_b32 a119, v7
    s_cmp_lt_u32 s63, 8
    s_cbranch_scc1 pk_kernel_edge_7
    s_waitcnt vmcnt(10)
    v_mfma_f32_32x32x16_bf16 v[48:63], a[0:3], v[224:227], v[16:31]
    s_waitcnt vmcnt(9)
    v_mfma_f32_32x32x16_bf16 v[64:79], a[4:7], v[224:227], 0
    s_waitcnt vmcnt(8)
    v_mfma_f32_32x32x16_bf16 v[80:95], a[8:11], v[224:227], 0
    s_nop 7
    s_nop 1
    v_max3_f32 v232, v48, v49, v50
    v_max3_f32 v233, v51, v52, v53
    v_max3_f32 v232, v232, v54, v55
    v_max3_f32 v233, v233, v56, v57
    v_max3_f32 v232, v232, v58, v59
    v_max3_f32 v233, v233, v60, v61
    v_max3_f32 v232, v232, v62, v63
    s_waitcnt vmcnt(7)
    v_mfma_f32_32x32x16_bf16 v[96:111], a[12:15], v[224:227], 0
    v_max3_f32 v232, v232, v64, v65
    v_max3_f32 v233, v233, v66, v67
    v_max3_f32 v232, v232, v68, v69
    v_max3_f32 v233, v233, v70, v71
    v_max3_f32 v232, v232, v72, v73
    v_max3_f32 v233, v233, v74, v75
    v_max3_f32 v232, v232, v76, v77
    v_max3_f32 v233, v233, v78, v79
    s_waitcnt vmcnt(6)
    v_mfma_f32_32x32x16_bf16 v[48:63], a[16:19], v[224:227], 0
    v_max3_f32 v232, v232, v80, v81
    v_max3_f32 v233, v233, v82, v83
    v_max3_f32 v232, v232, v84, v85
    v_max3_f32 v233, v233, v86, v87
    v_max3_f32 v232, v232, v88, v89
    v_max3_f32 v233, v233, v90, v91
    v_max3_f32 v232, v232, v92, v93
    v_max3_f32 v233, v233, v94, v95
    s_waitcnt vmcnt(5)
    v_mfma_f32_32x32x16_bf16 v[64:79], a[20:23], v[224:227], 0
    v_max3_f32 v232, v232, v96, v97
    v_max3_f32 v233, v233, v98, v99
    v_max3_f32 v232, v232, v100, v101
    v_max3_f32 v233, v233, v102, v103
    v_max3_f32 v232, v232, v104, v105
    v_max3_f32 v233, v233, v106, v107
    v_max3_f32 v232, v232, v108, v109
    v_max3_f32 v233, v233, v110, v111
    s_waitcnt vmcnt(4)
    v_mfma_f32_32x32x16_bf16 v[80:95], a[24:27], v[224:227], 0
    v_max3_f32 v232, v232, v48, v49
    v_max3_f32 v233, v233, v50, v51
    v_max3_f32 v232, v232, v52, v53
    v_max3_f32 v233, v233, v54, v55
    v_max3_f32 v232, v232, v56, v57
    v_max3_f32 v233, v233, v58, v59
    v_max3_f32 v232, v232, v60, v61
    v_max3_f32 v233, v233, v62, v63
    s_waitcnt vmcnt(3)
    v_mfma_f32_32x32x16_bf16 v[96:111], a[28:31], v[224:227], 0
    v_max3_f32 v232, v232, v64, v65
    v_max3_f32 v233, v233, v66, v67
    v_max3_f32 v232, v232, v68, v69
    v_max3_f32 v233, v233, v70, v71
    v_max3_f32 v232, v232, v72, v73
    v_max3_f32 v233, v233, v74, v75
    v_max3_f32 v232, v232, v76, v77
    v_max3_f32 v233, v233, v78, v79
    s_waitcnt vmcnt(2)
    v_mfma_f32_32x32x16_bf16 v[48:63], a[32:35], v[224:227], v[32:47]
    v_max3_f32 v232, v232, v80, v81
    v_max3_f32 v233, v233, v82, v83
    v_max3_f32 v232, v232, v84, v85
    v_max3_f32 v233, v233, v86, v87
    v_max3_f32 v232, v232, v88, v89
    v_max3_f32 v233, v233, v90, v91
    v_max3_f32 v232, v232, v92, v93
    v_max3_f32 v233, v233, v94, v95
    s_nop 3
    v_max3_f32 v232, v232, v96, v97
    v_max3_f32 v233, v233, v98, v99
    v_max3_f32 v232, v232, v100, v101
    v_max3_f32 v233, v233, v102, v103
    v_max3_f32 v232, v232, v104, v105
    v_max3_f32 v233, v233, v106, v107
    v_max3_f32 v232, v232, v108, v109
    v_max3_f32 v233, v233, v110, v111
    s_nop 3
    v_max3_f32 v232, v232, v48, v49
    v_max3_f32 v233, v233, v50, v51
    v_max3_f32 v232, v232, v52, v53
    v_max3_f32 v233, v233, v54, v55
    v_max3_f32 v232, v232, v56, v57
    v_max3_f32 v233, v233, v58, v59
    v_max3_f32 v232, v232, v60, v61
    v_max3_f32 v233, v233, v62, v63
    v_max_f32 v232, v232, v233
    v_mov_b32 v233, v232
    s_nop 1
    v_permlane32_swap_b32 v232, v233
    v_max_f32 v232, v232, v233
    v_sub_f32 v232, 0, v232
    v_pk_add_f32 v[128:129], v[16:17], v[232:233] op_sel_hi:[1,0]
    v_pk_add_f32 v[144:145], v[32:33], v[232:233] op_sel_hi:[1,0]
    v_pk_mov_b32 v[112:113], v[232:233], v[232:233] op_sel:[0,0]
    v_pk_add_f32 v[130:131], v[18:19], v[232:233] op_sel_hi:[1,0]
    v_pk_add_f32 v[146:147], v[34:35], v[232:233] op_sel_hi:[1,0]
    v_pk_mov_b32 v[114:115], v[232:233], v[232:233] op_sel:[0,0]
    v_pk_add_f32 v[132:133], v[20:21], v[232:233] op_sel_hi:[1,0]
    v_pk_add_f32 v[148:149], v[36:37], v[232:233] op_sel_hi:[1,0]
    v_pk_mov_b32 v[116:117], v[232:233], v[232:233] op_sel:[0,0]
    v_pk_add_f32 v[134:135], v[22:23], v[232:233] op_sel_hi:[1,0]
    v_pk_add_f32 v[150:151], v[38:39], v[232:233] op_sel_hi:[1,0]
    v_pk_mov_b32 v[118:119], v[232:233], v[232:233] op_sel:[0,0]
    v_pk_add_f32 v[136:137], v[24:25], v[232:233] op_sel_hi:[1,0]
    v_pk_add_f32 v[152:153], v[40:41], v[232:233] op_sel_hi:[1,0]
    v_pk_mov_b32 v[120:121], v[232:233], v[232:233] op_sel:[0,0]
    v_pk_add_f32 v[138:139], v[26:27], v[232:233] op_sel_hi:[1,0]
    v_pk_add_f32 v[154:155], v[42:43], v[232:233] op_sel_hi:[1,0]
    v_pk_mov_b32 v[122:123], v[232:233], v[232:233] op_sel:[0,0]
    v_pk_add_f32 v[140:141], v[28:29], v[232:233] op_sel_hi:[1,0]
    v_pk_add_f32 v[156:157], v[44:45], v[232:233] op_sel_hi:[1,0]
    v_pk_mov_b32 v[124:125], v[232:233], v[232:233] op_sel:[0,0]
    v_pk_add_f32 v[142:143], v[30:31], v[232:233] op_sel_hi:[1,0]
    v_pk_add_f32 v[158:159], v[46:47], v[232:233] op_sel_hi:[1,0]
    v_pk_mov_b32 v[126:127], v[232:233], v[232:233] op_sel:[0,0]
    s_waitcnt vmcnt(0)
    v_cmp_gt_u32 vcc, s98, v11
    s_and_b32 vcc_lo, vcc_lo, 7
    s_cbranch_scc1 pk_kernel_sp_9
pk_kernel_pr_10:
    s_mov_b64 exec, s[72:73]
    buffer_load_dwordx4 a[40:43], v235, s[24:27], s52 offen offset:0 sc1
    buffer_load_dwordx4 a[44:47], v235, s[24:27], s52 offen offset:512 sc1
    buffer_load_dwordx4 a[48:51], v235, s[24:27], s53 offen offset:0 sc1
    buffer_load_dwordx4 a[52:55], v235, s[24:27], s53 offen offset:512 sc1
    buffer_load_dwordx4 a[56:59], v235, s[24:27], s54 offen offset:0 sc1
    buffer_load_dwordx4 a[60:63], v235, s[24:27], s54 offen offset:512 sc1
    buffer_load_dwordx4 a[64:67], v235, s[24:27], s55 offen offset:0 sc1
    buffer_load_dwordx4 a[68:71], v235, s[24:27], s55 offen offset:512 sc1
    buffer_load_dwordx4 a[72:75], v235, s[24:27], s56 offen offset:0 sc1
    buffer_load_dwordx4 a[76:79], v235, s[24:27], s56 offen offset:512 sc1
    buffer_load_dwordx4 a[80:83], v235, s[24:27], s57 offen offset:0 sc1
    buffer_load_dwordx4 a[84:87], v235, s[24:27], s57 offen offset:512 sc1
    buffer_load_dwordx4 a[88:91], v235, s[24:27], s58 offen offset:0 sc1
    buffer_load_dwordx4 a[92:95], v235, s[24:27], s58 offen offset:512 sc1
    buffer_load_dwordx4 a[96:99], v235, s[24:27], s59 offen offset:0 sc1
    buffer_load_dwordx4 a[100:103], v235, s[24:27], s59 offen offset:512 sc1
    buffer_load_dwordx4 a[104:107], v235, s[24:27], s60 offen offset:0 sc1
    buffer_load_dwordx4 a[108:111], v235, s[24:27], s60 offen offset:512 sc1
    buffer_load_dwordx4 a[112:115], v235, s[24:27], s61 offen offset:0 sc1
    buffer_load_dwordx4 a[116:119], v235, s[24:27], s61 offen offset:512 sc1
    s_mov_b64 exec, -1
    v_mfma_f32_32x32x16_bf16 v[48:63], a[4:7], v[228:231], v[16:31]
    v_mfma_f32_32x32x16_bf16 v[64:79], a[8:11], v[228:231], 0
    v_mfma_f32_32x32x16_bf16 v[80:95], a[12:15], v[228:231], 0
    s_nop 7
    s_nop 1
    v_max3_f32 v232, v48, v49, v50
    v_max3_f32 v233, v51, v52, v53
    v_max3_f32 v232, v232, v54, v55
    v_max3_f32 v233, v233, v56, v57
    v_max3_f32 v232, v232, v58, v59
    v_max3_f32 v233, v233, v60, v61
    v_max3_f32 v232, v232, v62, v63
    v_mfma_f32_32x32x16_bf16 v[96:111], a[16:19], v[228:231], 0
    v_max3_f32 v232, v232, v64, v65
    v_max3_f32 v233, v233, v66, v67
    v_max3_f32 v232, v232, v68, v69
    v_max3_f32 v233, v233, v70, v71
    v_max3_f32 v232, v232, v72, v73
    v_max3_f32 v233, v233, v74, v75
    v_max3_f32 v232, v232, v76, v77
    v_max3_f32 v233, v233, v78, v79
    v_mfma_f32_32x32x16_bf16 v[48:63], a[20:23], v[228:231], 0
    v_max3_f32 v232, v232, v80, v81
    v_max3_f32 v233, v233, v82, v83
    v_max3_f32 v232, v232, v84, v85
    v_max3_f32 v233, v233, v86, v87
    v_max3_f32 v232, v232, v88, v89
    v_max3_f32 v233, v233, v90, v91
    v_max3_f32 v232, v232, v92, v93
    v_max3_f32 v233, v233, v94, v95
    v_mfma_f32_32x32x16_bf16 v[64:79], a[24:27], v[228:231], 0
    v_max3_f32 v232, v232, v96, v97
    v_max3_f32 v233, v233, v98, v99
    v_max3_f32 v232, v232, v100, v101
    v_max3_f32 v233, v233, v102, v103
    v_max3_f32 v232, v232, v104, v105
    v_max3_f32 v233, v233, v106, v107
    v_max3_f32 v232, v232, v108, v109
    v_max3_f32 v233, v233, v110, v111
    v_mfma_f32_32x32x16_bf16 v[80:95], a[28:31], v[228:231], 0
    v_max3_f32 v232, v232, v48, v49
    v_max3_f32 v233, v233, v50, v51
    v_max3_f32 v232, v232, v52, v53
    v_max3_f32 v233, v233, v54, v55
    v_max3_f32 v232, v232, v56, v57
    v_max3_f32 v233, v233, v58, v59
    v_max3_f32 v232, v232, v60, v61
    v_max3_f32 v233, v233, v62, v63
    v_mfma_f32_32x32x16_bf16 v[96:111], a[32:35], v[228:231], 0
    v_max3_f32 v232, v232, v64, v65
    v_max3_f32 v233, v233, v66, v67
    v_max3_f32 v232, v232, v68, v69
    v_max3_f32 v233, v233, v70, v71
    v_max3_f32 v232, v232, v72, v73
    v_max3_f32 v233, v233, v74, v75
    v_max3_f32 v232, v232, v76, v77
    v_max3_f32 v233, v233, v78, v79
    v_mfma_f32_32x32x16_bf16 v[48:63], a[36:39], v[228:231], v[32:47]
    v_max3_f32 v232, v232, v80, v81
    v_max3_f32 v233, v233, v82, v83
    v_max3_f32 v232, v232, v84, v85
    v_max3_f32 v233, v233, v86, v87
    v_max3_f32 v232, v232, v88, v89
    v_max3_f32 v233, v233, v90, v91
    v_max3_f32 v232, v232, v92, v93
    v_max3_f32 v233, v233, v94, v95
    s_nop 3
    v_max3_f32 v232, v232, v96, v97
    v_max3_f32 v233, v233, v98, v99
    v_max3_f32 v232, v232, v100, v101
    v_max3_f32 v233, v233, v102, v103
    v_max3_f32 v232, v232, v104, v105
    v_max3_f32 v233, v233, v106, v107
    v_max3_f32 v232, v232, v108, v109
    v_max3_f32 v233, v233, v110, v111
    s_nop 3
    v_max3_f32 v232, v232, v48, v49
    v_max3_f32 v233, v233, v50, v51
    v_max3_f32 v232, v232, v52, v53
    v_max3_f32 v233, v233, v54, v55
    v_max3_f32 v232, v232, v56, v57
    v_max3_f32 v233, v233, v58, v59
    v_max3_f32 v232, v232, v60, v61
    v_max3_f32 v233, v233, v62, v63
    v_max_f32 v232, v232, v233
    v_mov_b32 v233, v232
    s_nop 1
    v_permlane32_swap_b32 v232, v233
    v_max_f32 v232, v232, v233
    v_sub_f32 v232, 0, v232
    v_pk_add_f32 v[176:177], v[16:17], v[232:233] op_sel_hi:[1,0]
    v_pk_add_f32 v[192:193], v[32:33], v[232:233] op_sel_hi:[1,0]
    v_pk_mov_b32 v[160:161], v[232:233], v[232:233] op_sel:[0,0]
    v_pk_add_f32 v[178:179], v[18:19], v[232:233] op_sel_hi:[1,0]
    v_pk_add_f32 v[194:195], v[34:35], v[232:233] op_sel_hi:[1,0]
    v_pk_mov_b32 v[162:163], v[232:233], v[232:233] op_sel:[0,0]
    v_pk_add_f32 v[180:181], v[20:21], v[232:233] op_sel_hi:[1,0]
    v_pk_add_f32 v[196:197], v[36:37], v[232:233] op_sel_hi:[1,0]
    v_pk_mov_b32 v[164:165], v[232:233], v[232:233] op_sel:[0,0]
    v_pk_add_f32 v[182:183], v[22:23], v[232:233] op_sel_hi:[1,0]
    v_pk_add_f32 v[198:199], v[38:39], v[232:233] op_sel_hi:[1,0]
    v_pk_mov_b32 v[166:167], v[232:233], v[232:233] op_sel:[0,0]
    v_pk_add_f32 v[184:185], v[24:25], v[232:233] op_sel_hi:[1,0]
    v_pk_add_f32 v[200:201], v[40:41], v[232:233] op_sel_hi:[1,0]
    v_pk_mov_b32 v[168:169], v[232:233], v[232:233] op_sel:[0,0]
    v_pk_add_f32 v[186:187], v[26:27], v[232:233] op_sel_hi:[1,0]
    v_pk_add_f32 v[202:203], v[42:43], v[232:233] op_sel_hi:[1,0]
    v_pk_mov_b32 v[170:171], v[232:233], v[232:233] op_sel:[0,0]
    v_pk_add_f32 v[188:189], v[28:29], v[232:233] op_sel_hi:[1,0]
    v_pk_add_f32 v[204:205], v[44:45], v[232:233] op_sel_hi:[1,0]
    v_pk_mov_b32 v[172:173], v[232:233], v[232:233] op_sel:[0,0]
    v_pk_add_f32 v[190:191], v[30:31], v[232:233] op_sel_hi:[1,0]
    v_pk_add_f32 v[206:207], v[46:47], v[232:233] op_sel_hi:[1,0]
    v_pk_mov_b32 v[174:175], v[232:233], v[232:233] op_sel:[0,0]
    s_nop 1
    v_mfma_f32_32x32x16_bf16 v[48:63], a[0:3], v[224:227], v[128:143]
    v_mfma_f32_32x32x16_bf16 v[64:79], a[4:7], v[224:227], v[112:127]
    v_mfma_f32_32x32x16_bf16 v[80:95], a[8:11], v[224:227], v[112:127]
    s_nop 7
    s_nop 1
    v_exp_f32 v48, v48
    v_exp_f32 v49, v49
    v_exp_f32 v50, v50
    v_exp_f32 v51, v51
    buffer_load_dwordx4 a[192:195], v240, s[24:27], s81 offen offset:0
    v_exp_f32 v52, v52
    v_exp_f32 v53, v53
    v_exp_f32 v54, v54
    v_exp_f32 v55, v55
    v_exp_f32 v56, v56
    v_exp_f32 v57, v57
    v_exp_f32 v58, v58
    v_exp_f32 v59, v59
    v_exp_f32 v60, v60
    v_exp_f32 v61, v61
    buffer_load_dwordx4 a[196:199], v240, s[24:27], s81 offen offset:1024
    v_exp_f32 v62, v62
    v_exp_f32 v63, v63
    v_cvt_pk_bf16_f32 v48, v48, v49
    v_cvt_pk_bf16_f32 v49, v50, v51
    v_cvt_pk_bf16_f32 v50, v52, v53
    v_cvt_pk_bf16_f32 v51, v54, v55
    v_cvt_pk_bf16_f32 v52, v56, v57
    v_cvt_pk_bf16_f32 v53, v58, v59
    v_cvt_pk_bf16_f32 v54, v60, v61
    v_cvt_pk_bf16_f32 v55, v62, v63
    v_exp_f32 v64, v64
    v_exp_f32 v65, v65
    s_waitcnt vmcnt(21)
    v_mfma_f32_32x32x16_bf16 v[208:223], a[40:43], v[48:51], 0
    v_exp_f32 v66, v66
    v_exp_f32 v67, v67
    buffer_load_dwordx4 a[200:203], v240, s[24:27], s81 offen offset:2048
    v_exp_f32 v68, v68
    v_exp_f32 v69, v69
    v_exp_f32 v70, v70
    s_waitcnt vmcnt(21)
    v_mfma_f32_32x32x16_bf16 v[208:223], a[44:47], v[52:55], v[208:223]
    v_exp_f32 v71, v71
    v_exp_f32 v72, v72
    v_exp_f32 v73, v73
    v_exp_f32 v74, v74
    v_exp_f32 v75, v75
    v_mfma_f32_32x32x16_bf16 v[96:111], a[12:15], v[224:227], v[112:127]
    v_exp_f32 v76, v76
    v_exp_f32 v77, v77
    buffer_load_dwordx4 a[204:207], v240, s[24:27], s81 offen offset:3072
    v_exp_f32 v78, v78
    v_exp_f32 v79, v79
    v_cvt_pk_bf16_f32 v64, v64, v65
    v_cvt_pk_bf16_f32 v65, v66, v67
    v_cvt_pk_bf16_f32 v66, v68, v69
    v_cvt_pk_bf16_f32 v67, v70, v71
    v_cvt_pk_bf16_f32 v68, v72, v73
    v_cvt_pk_bf16_f32 v69, v74, v75
    v_cvt_pk_bf16_f32 v70, v76, v77
    v_cvt_pk_bf16_f32 v71, v78, v79
    v_exp_f32 v80, v80
    v_exp_f32 v81, v81
    s_waitcnt vmcnt(21)
    v_mfma_f32_32x32x16_bf16 v[208:223], a[48:51], v[64:67], v[208:223]
    v_exp_f32 v82, v82
    v_exp_f32 v83, v83
    buffer_load_dwordx4 a[208:211], v241, s[24:27], s81 offen offset:0
    v_exp_f32 v84, v84
    v_exp_f32 v85, v85
    v_exp_f32 v86, v86
    s_waitcnt vmcnt(21)
    v_mfma_f32_32x32x16_bf16 v[208:223], a[52:55], v[68:71], v[208:223]
    v_exp_f32 v87, v87
    v_exp_f32 v88, v88
    v_exp_f32 v89, v89
    v_exp_f32 v90, v90
    v_exp_f32 v91, v91
    v_mfma_f32_32x32x16_bf16 v[48:63], a[16:19], v[224:227], v[112:127]
    v_exp_f32 v92, v92
    v_exp_f32 v93, v93
    buffer_load_dwordx4 a[212:215], v241, s[24:27], s81 offen offset:1024
    v_exp_f32 v94, v94
    v_exp_f32 v95, v95
    v_cvt_pk_bf16_f32 v80, v80, v81
    v_cvt_pk_bf16_f32 v81, v82, v83
    v_cvt_pk_bf16_f32 v82, v84, v85
    v_cvt_pk_bf16_f32 v83, v86, v87
    v_cvt_pk_bf16_f32 v84, v88, v89
    v_cvt_pk_bf16_f32 v85, v90, v91
    v_cvt_pk_bf16_f32 v86, v92, v93
    v_cvt_pk_bf16_f32 v87, v94, v95
    v_exp_f32 v96, v96
    v_exp_f32 v97, v97
    s_waitcnt vmcnt(21)
    v_mfma_f32_32x32x16_bf16 v[208:223], a[56:59], v[80:83], v[208:223]
    v_exp_f32 v98, v98
    v_exp_f32 v99, v99
    buffer_load_dwordx4 a[216:219], v241, s[24:27], s81 offen offset:2048
    v_exp_f32 v100, v100
    v_exp_f32 v101, v101
    v_exp_f32 v102, v102
    s_waitcnt vmcnt(21)
    v_mfma_f32_32x32x16_bf16 v[208:223], a[60:63], v[84:87], v[208:223]
    v_exp_f32 v103, v103
    v_exp_f32 v104, v104
    v_exp_f32 v105, v105
    v_exp_f32 v106, v106
    v_exp_f32 v107, v107
    v_mfma_f32_32x32x16_bf16 v[64:79], a[20:23], v[224:227], v[112:127]
    v_exp_f32 v108, v108
    v_exp_f32 v109, v109
    buffer_load_dwordx4 a[220:223], v241, s[24:27], s81 offen offset:3072
    v_exp_f32 v110, v110
    v_exp_f32 v111, v111
    v_cvt_pk_bf16_f32 v96, v96, v97
    v_cvt_pk_bf16_f32 v97, v98, v99
    v_cvt_pk_bf16_f32 v98, v100, v101
    v_cvt_pk_bf16_f32 v99, v102, v103
    v_cvt_pk_bf16_f32 v100, v104, v105
    v_cvt_pk_bf16_f32 v101, v106, v107
    v_cvt_pk_bf16_f32 v102, v108, v109
    v_cvt_pk_bf16_f32 v103, v110, v111
    v_exp_f32 v48, v48
    v_exp_f32 v49, v49
    s_waitcnt vmcnt(21)
    v_mfma_f32_32x32x16_bf16 v[208:223], a[64:67], v[96:99], v[208:223]
    v_exp_f32 v50, v50
    v_exp_f32 v51, v51
    buffer_load_dwordx4 a[224:227], v242, s[24:27], s81 offen offset:0
    v_exp_f32 v52, v52
    v_exp_f32 v53, v53
    v_exp_f32 v54, v54
    s_waitcnt vmcnt(21)
    v_mfma_f32_32x32x16_bf16 v[208:223], a[68:71], v[100:103], v[208:223]
    v_exp_f32 v55, v55
    v_exp_f32 v56, v56
    v_exp_f32 v57, v57
    v_exp_f32 v58, v58
    v_exp_f32 v59, v59
    v_mfma_f32_32x32x16_bf16 v[80:95], a[24:27], v[224:227], v[112:127]
    v_exp_f32 v60, v60
    v_exp_f32 v61, v61
    buffer_load_dwordx4 a[228:231], v242, s[24:27], s81 offen offset:1024
    v_exp_f32 v62, v62
    v_exp_f32 v63, v63
    v_cvt_pk_bf16_f32 v48, v48, v49
    v_cvt_pk_bf16_f32 v49, v50, v51
    v_cvt_pk_bf16_f32 v50, v52, v53
    v_cvt_pk_bf16_f32 v51, v54, v55
    v_cvt_pk_bf16_f32 v52, v56, v57
    v_cvt_pk_bf16_f32 v53, v58, v59
    v_cvt_pk_bf16_f32 v54, v60, v61
    v_cvt_pk_bf16_f32 v55, v62, v63
    v_exp_f32 v64, v64
    v_exp_f32 v65, v65
    s_waitcnt vmcnt(21)
    v_mfma_f32_32x32x16_bf16 v[208:223], a[72:75], v[48:51], v[208:223]
    v_exp_f32 v66, v66
    v_exp_f32 v67, v67
    buffer_load_dwordx4 a[232:235], v242, s[24:27], s81 offen offset:2048
    v_exp_f32 v68, v68
    v_exp_f32 v69, v69
    v_exp_f32 v70, v70
    s_waitcnt vmcnt(21)
    v_mfma_f32_32x32x16_bf16 v[208:223], a[76:79], v[52:55], v[208:223]
    v_exp_f32 v71, v71
    v_exp_f32 v72, v72
    v_exp_f32 v73, v73
    v_exp_f32 v74, v74
    v_exp_f32 v75, v75
    v_mfma_f32_32x32x16_bf16 v[96:111], a[28:31], v[224:227], v[112:127]
    v_exp_f32 v76, v76
    v_exp_f32 v77, v77
    buffer_load_dwordx4 a[236:239], v242, s[24:27], s81 offen offset:3072
    v_exp_f32 v78, v78
    v_exp_f32 v79, v79
    v_cvt_pk_bf16_f32 v64, v64, v65
    v_cvt_pk_bf16_f32 v65, v66, v67
    v_cvt_pk_bf16_f32 v66, v68, v69
    v_cvt_pk_bf16_f32 v67, v70, v71
    v_cvt_pk_bf16_f32 v68, v72, v73
    v_cvt_pk_bf16_f32 v69, v74, v75
    v_cvt_pk_bf16_f32 v70, v76, v77
    v_cvt_pk_bf16_f32 v71, v78, v79
    v_exp_f32 v80, v80
    v_exp_f32 v81, v81
    s_waitcnt vmcnt(21)
    v_mfma_f32_32x32x16_bf16 v[208:223], a[80:83], v[64:67], v[208:223]
    v_exp_f32 v82, v82
    v_exp_f32 v83, v83
    buffer_load_dwordx4 a[240:243], v243, s[24:27], s81 offen offset:0
    v_exp_f32 v84, v84
    v_exp_f32 v85, v85
    v_exp_f32 v86, v86
    s_waitcnt vmcnt(21)
    v_mfma_f32_32x32x16_bf16 v[208:223], a[84:87], v[68:71], v[208:223]
    v_exp_f32 v87, v87
    v_exp_f32 v88, v88
    v_exp_f32 v89, v89
    v_exp_f32 v90, v90
    v_exp_f32 v91, v91
    v_mfma_f32_32x32x16_bf16 v[48:63], a[32:35], v[224:227], v[144:159]
    v_exp_f32 v92, v92
    v_exp_f32 v93, v93
    buffer_load_dwordx4 a[244:247], v243, s[24:27], s81 offen offset:1024
    v_exp_f32 v94, v94
    v_exp_f32 v95, v95
    v_cvt_pk_bf16_f32 v80, v80, v81
    v_cvt_pk_bf16_f32 v81, v82, v83
    v_cvt_pk_bf16_f32 v82, v84, v85
    v_cvt_pk_bf16_f32 v83, v86, v87
    v_cvt_pk_bf16_f32 v84, v88, v89
    v_cvt_pk_bf16_f32 v85, v90, v91
    v_cvt_pk_bf16_f32 v86, v92, v93
    v_cvt_pk_bf16_f32 v87, v94, v95
    v_exp_f32 v96, v96
    v_exp_f32 v97, v97
    s_waitcnt vmcnt(21)
    v_mfma_f32_32x32x16_bf16 v[208:223], a[88:91], v[80:83], v[208:223]
    v_exp_f32 v98, v98
    v_exp_f32 v99, v99
    buffer_load_dwordx4 a[248:251], v243, s[24:27], s81 offen offset:2048
    v_exp_f32 v100, v100
    v_exp_f32 v101, v101
    v_exp_f32 v102, v102
    s_waitcnt vmcnt(21)
    v_mfma_f32_32x32x16_bf16 v[208:223], a[92:95], v[84:87], v[208:223]
    v_exp_f32 v103, v103
    v_exp_f32 v104, v104
    v_exp_f32 v105, v105
    v_exp_f32 v106, v106
    v_exp_f32 v107, v107
    v_exp_f32 v108, v108
    v_exp_f32 v109, v109
    buffer_load_dwordx4 a[252:255], v243, s[24:27], s81 offen offset:3072
    v_exp_f32 v110, v110
    v_exp_f32 v111, v111
    v_cvt_pk_bf16_f32 v96, v96, v97
    v_cvt_pk_bf16_f32 v97, v98, v99
    v_cvt_pk_bf16_f32 v98, v100, v101
    v_cvt_pk_bf16_f32 v99, v102, v103
    v_cvt_pk_bf16_f32 v100, v104, v105
    v_cvt_pk_bf16_f32 v101, v106, v107
    v_cvt_pk_bf16_f32 v102, v108, v109
    v_cvt_pk_bf16_f32 v103, v110, v111
    v_exp_f32 v48, v48
    v_exp_f32 v49, v49
    s_waitcnt vmcnt(21)
    v_mfma_f32_32x32x16_bf16 v[208:223], a[96:99], v[96:99], v[208:223]
    v_exp_f32 v50, v50
    v_exp_f32 v51, v51
    s_add_u32 m0, s33, 0
    s_mul_i32 s48, s29, 253952
    s_add_u32 s48, s48, s33
    s_add_u32 s48, s48, 45924352
    buffer_load_dwordx4 v2, s[24:27], s48 offen offset:0 lds
    v_exp_f32 v52, v52
    v_exp_f32 v53, v53
    v_exp_f32 v54, v54
    s_waitcnt vmcnt(21)
    v_mfma_f32_32x32x16_bf16 v[208:223], a[100:103], v[100:103], v[208:223]
    v_exp_f32 v55, v55
    v_exp_f32 v56, v56
    v_exp_f32 v57, v57
    v_exp_f32 v58, v58
    v_exp_f32 v59, v59
    v_exp_f32 v60, v60
    v_exp_f32 v61, v61
    buffer_load_dwordx4 v2, s[24:27], s48 offen offset:1024 lds
    v_exp_f32 v62, v62
    v_exp_f32 v63, v63
    v_cvt_pk_bf16_f32 v48, v48, v49
    v_cvt_pk_bf16_f32 v49, v50, v51
    v_cvt_pk_bf16_f32 v50, v52, v53
    v_cvt_pk_bf16_f32 v51, v54, v55
    v_cvt_pk_bf16_f32 v52, v56, v57
    v_cvt_pk_bf16_f32 v53, v58, v59
    v_cvt_pk_bf16_f32 v54, v60, v61
    v_cvt_pk_bf16_f32 v55, v62, v63
    s_add_u32 s40, s63, 0
    s_waitcnt vmcnt(21)
    v_mfma_f32_32x32x16_bf16 v[208:223], a[104:107], v[48:51], v[208:223]
    s_lshl_b32 s40, s40, 15
    s_lshl_b32 s41, s62, 10
    s_waitcnt vmcnt(20)
    v_mfma_f32_32x32x16_bf16 v[208:223], a[108:111], v[52:55], v[208:223]
    s_add_u32 s40, s40, s41
    s_add_u32 s40, s40, s30
    s_add_u32 s40, s40, 8388608
    v_mfma_f32_32x32x16_bf16 v[64:79], a[8:11], v[228:231], v[160:175]
    v_mfma_f32_32x32x16_bf16 v[80:95], a[12:15], v[228:231], v[160:175]
    v_mfma_f32_32x32x16_bf16 v[48:63], a[4:7], v[228:231], v[176:191]
    s_nop 6
    v_rcp_f32 v7, v216
    s_nop 0
    v_mul_f32 v208, v208, v7
    v_mul_f32 v209, v209, v7
    v_mul_f32 v210, v210, v7
    v_mul_f32 v211, v211, v7
    v_mul_f32 v212, v212, v7
    v_mul_f32 v213, v213, v7
    v_mul_f32 v214, v214, v7
    v_mul_f32 v215, v215, v7
    v_cvt_pk_bf16_f32 v112, v208, v209
    v_cvt_pk_bf16_f32 v113, v210, v211
    v_cvt_pk_bf16_f32 v114, v212, v213
    v_cvt_pk_bf16_f32 v115, v214, v215
    s_nop 1
    v_permlane32_swap_b32 v112, v114
    v_permlane32_swap_b32 v113, v115
    buffer_store_dwordx4 v[112:115], v2, s[24:27], s40 offen sc1
    v_exp_f32 v48, v48
    v_exp_f32 v49, v49
    v_exp_f32 v50, v50
    v_exp_f32 v51, v51
    buffer_load_dwordx4 v2, s[24:27], s48 offen offset:2048 lds
    v_exp_f32 v52, v52
    v_exp_f32 v53, v53
    v_exp_f32 v54, v54
    v_exp_f32 v55, v55
    v_exp_f32 v56, v56
    v_exp_f32 v57, v57
    v_exp_f32 v58, v58
    v_exp_f32 v59, v59
    v_exp_f32 v60, v60
    v_exp_f32 v61, v61
    buffer_load_dwordx4 v2, s[24:27], s48 offen offset:3072 lds
    v_exp_f32 v62, v62
    v_exp_f32 v63, v63
    v_cvt_pk_bf16_f32 v48, v48, v49
    v_cvt_pk_bf16_f32 v49, v50, v51
    v_cvt_pk_bf16_f32 v50, v52, v53
    v_cvt_pk_bf16_f32 v51, v54, v55
    v_cvt_pk_bf16_f32 v52, v56, v57
    v_cvt_pk_bf16_f32 v53, v58, v59
    v_cvt_pk_bf16_f32 v54, v60, v61
    v_cvt_pk_bf16_f32 v55, v62, v63
    v_exp_f32 v64, v64
    v_exp_f32 v65, v65
    v_mfma_f32_32x32x16_bf16 v[208:223], a[48:51], v[48:51], 0
    v_exp_f32 v66, v66
    v_exp_f32 v67, v67
    s_add_u32 m0, s33, 16384
    s_add_u32 s48, s48, 16384
    buffer_load_dwordx4 v2, s[24:27], s48 offen offset:0 lds
    v_exp_f32 v68, v68
    v_exp_f32 v69, v69
    v_exp_f32 v70, v70
    v_mfma_f32_32x32x16_bf16 v[208:223], a[52:55], v[52:55], v[208:223]
    v_exp_f32 v71, v71
    v_exp_f32 v72, v72
    v_exp_f32 v73, v73
    v_exp_f32 v74, v74
    v_exp_f32 v75, v75
    v_mfma_f32_32x32x16_bf16 v[96:111], a[16:19], v[228:231], v[160:175]
    v_exp_f32 v76, v76
    v_exp_f32 v77, v77
    buffer_load_dwordx4 v2, s[24:27], s48 offen offset:1024 lds
    v_exp_f32 v78, v78
    v_exp_f32 v79, v79
    v_cvt_pk_bf16_f32 v64, v64, v65
    v_cvt_pk_bf16_f32 v65, v66, v67
    v_cvt_pk_bf16_f32 v66, v68, v69
    v_cvt_pk_bf16_f32 v67, v70, v71
    v_cvt_pk_bf16_f32 v68, v72, v73
    v_cvt_pk_bf16_f32 v69, v74, v75
    v_cvt_pk_bf16_f32 v70, v76, v77
    v_cvt_pk_bf16_f32 v71, v78, v79
    v_exp_f32 v80, v80
    v_exp_f32 v81, v81
    v_mfma_f32_32x32x16_bf16 v[208:223], a[56:59], v[64:67], v[208:223]
    v_exp_f32 v82, v82
    v_exp_f32 v83, v83
    buffer_load_dwordx4 v2, s[24:27], s48 offen offset:2048 lds
    v_exp_f32 v84, v84
    v_exp_f32 v85, v85
    v_exp_f32 v86, v86
    v_mfma_f32_32x32x16_bf16 v[208:223], a[60:63], v[68:71], v[208:223]
    v_exp_f32 v87, v87
    v_exp_f32 v88, v88
    v_exp_f32 v89, v89
    v_exp_f32 v90, v90
    v_exp_f32 v91, v91
    v_mfma_f32_32x32x16_bf16 v[48:63], a[20:23], v[228:231], v[160:175]
    v_exp_f32 v92, v92
    v_exp_f32 v93, v93
    buffer_load_dwordx4 v2, s[24:27], s48 offen offset:3072 lds
    v_exp_f32 v94, v94
    v_exp_f32 v95, v95
    v_cvt_pk_bf16_f32 v80, v80, v81
    v_cvt_pk_bf16_f32 v81, v82, v83
    v_cvt_pk_bf16_f32 v82, v84, v85
    v_cvt_pk_bf16_f32 v83, v86, v87
    v_cvt_pk_bf16_f32 v84, v88, v89
    v_cvt_pk_bf16_f32 v85, v90, v91
    v_cvt_pk_bf16_f32 v86, v92, v93
    v_cvt_pk_bf16_f32 v87, v94, v95
    v_exp_f32 v96, v96
    v_exp_f32 v97, v97
    v_mfma_f32_32x32x16_bf16 v[208:223], a[64:67], v[80:83], v[208:223]
    v_exp_f32 v98, v98
    v_exp_f32 v99, v99
    v_exp_f32 v100, v100
    v_exp_f32 v101, v101
    v_exp_f32 v102, v102
    v_mfma_f32_32x32x16_bf16 v[208:223], a[68:71], v[84:87], v[208:223]
    v_exp_f32 v103, v103
    v_exp_f32 v104, v104
    v_exp_f32 v105, v105
    v_exp_f32 v106, v106
    v_exp_f32 v107, v107
    v_mfma_f32_32x32x16_bf16 v[64:79], a[24:27], v[228:231], v[160:175]
    v_exp_f32 v108, v108
    v_exp_f32 v109, v109
    v_exp_f32 v110, v110
    v_exp_f32 v111, v111
    v_cvt_pk_bf16_f32 v96, v96, v97
    v_cvt_pk_bf16_f32 v97, v98, v99
    v_cvt_pk_bf16_f32 v98, v100, v101
    v_cvt_pk_bf16_f32 v99, v102, v103
    v_cvt_pk_bf16_f32 v100, v104, v105
    v_cvt_pk_bf16_f32 v101, v106, v107
    v_cvt_pk_bf16_f32 v102, v108, v109
    v_cvt_pk_bf16_f32 v103, v110, v111
    v_exp_f32 v48, v48
    v_exp_f32 v49, v49
    v_mfma_f32_32x32x16_bf16 v[208:223], a[72:75], v[96:99], v[208:223]
    v_exp_f32 v50, v50
    v_exp_f32 v51, v51
    v_exp_f32 v52, v52
    v_exp_f32 v53, v53
    v_exp_f32 v54, v54
    v_mfma_f32_32x32x16_bf16 v[208:223], a[76:79], v[100:103], v[208:223]
    v_exp_f32 v55, v55
    v_exp_f32 v56, v56
    v_exp_f32 v57, v57
    v_exp_f32 v58, v58
    v_exp_f32 v59, v59
    v_mfma_f32_32x32x16_bf16 v[80:95], a[28:31], v[228:231], v[160:175]
    v_exp_f32 v60, v60
    v_exp_f32 v61, v61
    v_exp_f32 v62, v62
    v_exp_f32 v63, v63
    v_cvt_pk_bf16_f32 v48, v48, v49
    v_cvt_pk_bf16_f32 v49, v50, v51
    v_cvt_pk_bf16_f32 v50, v52, v53
    v_cvt_pk_bf16_f32 v51, v54, v55
    v_cvt_pk_bf16_f32 v52, v56, v57
    v_cvt_pk_bf16_f32 v53, v58, v59
    v_cvt_pk_bf16_f32 v54, v60, v61
    v_cvt_pk_bf16_f32 v55, v62, v63
    v_exp_f32 v64, v64
    v_exp_f32 v65, v65
    v_mfma_f32_32x32x16_bf16 v[208:223], a[80:83], v[48:51], v[208:223]
    v_exp_f32 v66, v66
    v_exp_f32 v67, v67
    v_exp_f32 v68, v68
    v_exp_f32 v69, v69
    v_exp_f32 v70, v70
    v_mfma_f32_32x32x16_bf16 v[208:223], a[84:87], v[52:55], v[208:223]
    v_exp_f32 v71, v71
    v_exp_f32 v72, v72
    v_exp_f32 v73, v73
    v_exp_f32 v74, v74
    v_exp_f32 v75, v75
    v_mfma_f32_32x32x16_bf16 v[96:111], a[32:35], v[228:231], v[160:175]
    v_exp_f32 v76, v76
    v_exp_f32 v77, v77
    v_exp_f32 v78, v78
    v_exp_f32 v79, v79
    v_cvt_pk_bf16_f32 v64, v64, v65
    v_cvt_pk_bf16_f32 v65, v66, v67
    v_cvt_pk_bf16_f32 v66, v68, v69
    v_cvt_pk_bf16_f32 v67, v70, v71
    v_cvt_pk_bf16_f32 v68, v72, v73
    v_cvt_pk_bf16_f32 v69, v74, v75
    v_cvt_pk_bf16_f32 v70, v76, v77
    v_cvt_pk_bf16_f32 v71, v78, v79
    v_exp_f32 v80, v80
    v_exp_f32 v81, v81
    v_mfma_f32_32x32x16_bf16 v[208:223], a[88:91], v[64:67], v[208:223]
    v_exp_f32 v82, v82
    v_exp_f32 v83, v83
    v_exp_f32 v84, v84
    v_exp_f32 v85, v85
    v_exp_f32 v86, v86
    v_mfma_f32_32x32x16_bf16 v[208:223], a[92:95], v[68:71], v[208:223]
    v_exp_f32 v87, v87
    v_exp_f32 v88, v88
    v_exp_f32 v89, v89
    v_exp_f32 v90, v90
    v_exp_f32 v91, v91
    v_mfma_f32_32x32x16_bf16 v[48:63], a[36:39], v[228:231], v[192:207]
    v_exp_f32 v92, v92
    v_exp_f32 v93, v93
    v_exp_f32 v94, v94
    v_exp_f32 v95, v95
    v_cvt_pk_bf16_f32 v80, v80, v81
    v_cvt_pk_bf16_f32 v81, v82, v83
    v_cvt_pk_bf16_f32 v82, v84, v85
    v_cvt_pk_bf16_f32 v83, v86, v87
    v_cvt_pk_bf16_f32 v84, v88, v89
    v_cvt_pk_bf16_f32 v85, v90, v91
    v_cvt_pk_bf16_f32 v86, v92, v93
    v_cvt_pk_bf16_f32 v87, v94, v95
    v_exp_f32 v96, v96
    v_exp_f32 v97, v97
    v_mfma_f32_32x32x16_bf16 v[208:223], a[96:99], v[80:83], v[208:223]
    v_exp_f32 v98, v98
    v_exp_f32 v99, v99
    v_exp_f32 v100, v100
    v_exp_f32 v101, v101
    v_exp_f32 v102, v102
    v_mfma_f32_32x32x16_bf16 v[208:223], a[100:103], v[84:87], v[208:223]
    v_exp_f32 v103, v103
    v_exp_f32 v104, v104
    v_exp_f32 v105, v105
    v_exp_f32 v106, v106
    v_exp_f32 v107, v107
    v_exp_f32 v108, v108
    v_exp_f32 v109, v109
    v_exp_f32 v110, v110
    v_exp_f32 v111, v111
    v_cvt_pk_bf16_f32 v96, v96, v97
    v_cvt_pk_bf16_f32 v97, v98, v99
    v_cvt_pk_bf16_f32 v98, v100, v101
    v_cvt_pk_bf16_f32 v99, v102, v103
    v_cvt_pk_bf16_f32 v100, v104, v105
    v_cvt_pk_bf16_f32 v101, v106, v107
    v_cvt_pk_bf16_f32 v102, v108, v109
    v_cvt_pk_bf16_f32 v103, v110, v111
    v_exp_f32 v48, v48
    v_exp_f32 v49, v49
    v_mfma_f32_32x32x16_bf16 v[208:223], a[104:107], v[96:99], v[208:223]
    v_exp_f32 v50, v50
    v_exp_f32 v51, v51
    v_exp_f32 v52, v52
    v_exp_f32 v53, v53
    v_exp_f32 v54, v54
    v_mfma_f32_32x32x16_bf16 v[208:223], a[108:111], v[100:103], v[208:223]
    v_exp_f32 v55, v55
    v_exp_f32 v56, v56
    v_exp_f32 v57, v57
    v_exp_f32 v58, v58
    v_exp_f32 v59, v59
    v_exp_f32 v60, v60
    v_exp_f32 v61, v61
    v_exp_f32 v62, v62
    v_exp_f32 v63, v63
    v_cvt_pk_bf16_f32 v48, v48, v49
    v_cvt_pk_bf16_f32 v49, v50, v51
    v_cvt_pk_bf16_f32 v50, v52, v53
    v_cvt_pk_bf16_f32 v51, v54, v55
    v_cvt_pk_bf16_f32 v52, v56, v57
    v_cvt_pk_bf16_f32 v53, v58, v59
    v_cvt_pk_bf16_f32 v54, v60, v61
    v_cvt_pk_bf16_f32 v55, v62, v63
    s_add_u32 s40, s63, 1
    s_waitcnt vmcnt(26)
    v_mfma_f32_32x32x16_bf16 v[208:223], a[112:115], v[48:51], v[208:223]
    s_lshl_b32 s40, s40, 15
    s_lshl_b32 s41, s62, 10
    s_waitcnt vmcnt(25)
    v_mfma_f32_32x32x16_bf16 v[208:223], a[116:119], v[52:55], v[208:223]
    s_add_u32 s40, s40, s41
    s_add_u32 s40, s40, s30
    s_add_u32 s40, s40, 8388608
    s_nop 7
    s_nop 1
    v_rcp_f32 v7, v216
    s_nop 0
    v_mul_f32 v208, v208, v7
    v_mul_f32 v209, v209, v7
    v_mul_f32 v210, v210, v7
    v_mul_f32 v211, v211, v7
    v_mul_f32 v212, v212, v7
    v_mul_f32 v213, v213, v7
    v_mul_f32 v214, v214, v7
    v_mul_f32 v215, v215, v7
    v_cvt_pk_bf16_f32 v16, v208, v209
    v_cvt_pk_bf16_f32 v17, v210, v211
    v_cvt_pk_bf16_f32 v18, v212, v213
    v_cvt_pk_bf16_f32 v19, v214, v215
    s_nop 1
    v_permlane32_swap_b32 v16, v18
    v_permlane32_swap_b32 v17, v19
    buffer_store_dwordx4 v[16:19], v2, s[24:27], s40 offen sc1
pk_kernel_ajoin_8:
    s_add_u32 s40, s66, s30
    buffer_load_dwordx4 v[32:35], v2, s[24:27], s40 offen sc1
    buffer_load_dwordx4 v[36:39], v2, s[24:27], s40 offen offset:1024 sc1
    s_lshl_b32 s44, s64, 15
    s_add_u32 s44, s44, s30
    s_add_u32 s44, s44, 8388608
    s_add_u32 s42, s32, 32768
    s_add_u32 s42, s42, s93
    s_cmp_lg_u32 s3, 0
    s_waitcnt vmcnt(2)
    s_barrier
    s_cbranch_scc1 pk_kernel_sg_49
    s_mov_b64 exec, 1
    buffer_atomic_add v5, v6, s[24:27], s42 offen sc1
    s_mov_b64 exec, -1
pk_kernel_sg_49:
    s_add_u32 m0, s33, 32768
    s_add_u32 s48, s48, 16384
    buffer_load_dwordx4 v2, s[24:27], s48 offen offset:0 lds
    buffer_load_dwordx4 v2, s[24:27], s48 offen offset:1024 lds
    buffer_load_dwordx4 v2, s[24:27], s48 offen offset:2048 lds
    buffer_load_dwordx4 v2, s[24:27], s48 offen offset:3072 lds
    s_add_u32 m0, s33, 49152
    s_add_u32 s48, s48, 16384
    buffer_load_dwordx4 v2, s[24:27], s48 offen offset:0 lds
    buffer_load_dwordx4 v2, s[24:27], s48 offen offset:1024 lds
    buffer_load_dwordx4 v2, s[24:27], s48 offen offset:2048 lds
    buffer_load_dwordx4 v2, s[24:27], s48 offen offset:3072 lds
    s_add_u32 m0, s33, 65536
    s_add_u32 s48, s48, 16384
    buffer_load_dwordx4 v2, s[24:27], s48 offen offset:0 lds
    buffer_load_dwordx4 v2, s[24:27], s48 offen offset:1024 lds
    buffer_load_dwordx4 v2, s[24:27], s48 offen offset:2048 lds
    buffer_load_dwordx4 v2, s[24:27], s48 offen offset:3072 lds
    s_add_u32 m0, s33, 81920
    s_add_u32 s48, s48, 16384
    buffer_load_dwordx4 v2, s[24:27], s48 offen offset:0 lds
    buffer_load_dwordx4 v2, s[24:27], s48 offen offset:1024 lds
    buffer_load_dwordx4 v2, s[24:27], s48 offen offset:2048 lds
    buffer_load_dwordx4 v2, s[24:27], s48 offen offset:3072 lds
    s_add_u32 m0, s33, 98304
    s_add_u32 s48, s48, 16384
    buffer_load_dwordx4 v2, s[24:27], s48 offen offset:0 lds
    buffer_load_dwordx4 v2, s[24:27], s48 offen offset:1024 lds
    buffer_load_dwordx4 v2, s[24:27], s48 offen offset:2048 lds
    buffer_load_dwordx4 v2, s[24:27], s48 offen offset:3072 lds
    s_mov_b64 exec, 1
    s_add_u32 s42, s93, 50020352
    buffer_load_dword v11, v10, s[24:27], s42 offen sc1
    s_mov_b64 exec, -1
    s_waitcnt vmcnt(0)
    v_cmp_gt_u32 vcc, s100, v11
    s_and_b32 vcc_lo, vcc_lo, 1
    s_cbranch_scc1 pk_kernel_sp_50
pk_kernel_pr_51:
    buffer_load_dwordx4 a[0:3], v236, s[24:27], s44 offen offset:0 sc1
    buffer_load_dwordx4 a[4:7], v236, s[24:27], s44 offen offset:1024 sc1
    buffer_load_dwordx4 a[8:11], v236, s[24:27], s44 offen offset:2048 sc1
    buffer_load_dwordx4 a[12:15], v236, s[24:27], s44 offen offset:3072 sc1
    buffer_load_dwordx4 a[16:19], v237, s[24:27], s44 offen offset:0 sc1
    buffer_load_dwordx4 a[20:23], v237, s[24:27], s44 offen offset:1024 sc1
    buffer_load_dwordx4 a[24:27], v237, s[24:27], s44 offen offset:2048 sc1
    buffer_load_dwordx4 a[28:31], v237, s[24:27], s44 offen offset:3072 sc1
    buffer_load_dwordx4 a[32:35], v238, s[24:27], s44 offen offset:0 sc1
    buffer_load_dwordx4 a[36:39], v238, s[24:27], s44 offen offset:1024 sc1
    buffer_load_dwordx4 a[40:43], v238, s[24:27], s44 offen offset:2048 sc1
    buffer_load_dwordx4 a[44:47], v238, s[24:27], s44 offen offset:3072 sc1
    s_waitcnt vmcnt(11)
    v_mfma_f32_32x32x16_bf16 v[16:31], a[128:131], a[0:3], 0
    buffer_load_dwordx4 a[48:51], v239, s[24:27], s44 offen offset:0 sc1
    s_waitcnt vmcnt(11)
    v_mfma_f32_32x32x16_bf16 v[16:31], a[132:135], a[4:7], v[16:31]
    buffer_load_dwordx4 a[52:55], v239, s[24:27], s44 offen offset:1024 sc1
    s_waitcnt vmcnt(11)
    v_mfma_f32_32x32x16_bf16 v[16:31], a[136:139], a[8:11], v[16:31]
    buffer_load_dwordx4 a[56:59], v239, s[24:27], s44 offen offset:2048 sc1
    s_waitcnt vmcnt(11)
    v_mfma_f32_32x32x16_bf16 v[16:31], a[140:143], a[12:15], v[16:31]
    buffer_load_dwordx4 a[60:63], v239, s[24:27], s44 offen offset:3072 sc1
    s_waitcnt vmcnt(11)
    v_mfma_f32_32x32x16_bf16 v[16:31], a[144:147], a[16:19], v[16:31]
    buffer_load_dwordx4 a[64:67], v240, s[24:27], s44 offen offset:0 sc1
    s_waitcnt vmcnt(11)
    v_mfma_f32_32x32x16_bf16 v[16:31], a[148:151], a[20:23], v[16:31]
    buffer_load_dwordx4 a[68:71], v240, s[24:27], s44 offen offset:1024 sc1
    s_waitcnt vmcnt(11)
    v_mfma_f32_32x32x16_bf16 v[16:31], a[152:155], a[24:27], v[16:31]
    buffer_load_dwordx4 a[72:75], v240, s[24:27], s44 offen offset:2048 sc1
    s_waitcnt vmcnt(11)
    v_mfma_f32_32x32x16_bf16 v[16:31], a[156:159], a[28:31], v[16:31]
    buffer_load_dwordx4 a[76:79], v240, s[24:27], s44 offen offset:3072 sc1
    s_waitcnt vmcnt(11)
    v_mfma_f32_32x32x16_bf16 v[16:31], a[160:163], a[32:35], v[16:31]
    buffer_load_dwordx4 a[80:83], v241, s[24:27], s44 offen offset:0 sc1
    s_waitcnt vmcnt(11)
    v_mfma_f32_32x32x16_bf16 v[16:31], a[164:167], a[36:39], v[16:31]
    buffer_load_dwordx4 a[84:87], v241, s[24:27], s44 offen offset:1024 sc1
    s_waitcnt vmcnt(11)
    v_mfma_f32_32x32x16_bf16 v[16:31], a[168:171], a[40:43], v[16:31]
    buffer_load_dwordx4 a[88:91], v241, s[24:27], s44 offen offset:2048 sc1
    s_waitcnt vmcnt(11)
    v_mfma_f32_32x32x16_bf16 v[16:31], a[172:175], a[44:47], v[16:31]
    buffer_load_dwordx4 a[92:95], v241, s[24:27], s44 offen offset:3072 sc1
    s_waitcnt vmcnt(11)
    v_mfma_f32_32x32x16_bf16 v[16:31], a[176:179], a[48:51], v[16:31]
    buffer_load_dwordx4 a[96:99], v242, s[24:27], s44 offen offset:0 sc1
    s_waitcnt vmcnt(11)
    v_mfma_f32_32x32x16_bf16 v[16:31], a[180:183], a[52:55], v[16:31]
    buffer_load_dwordx4 a[100:103], v242, s[24:27], s44 offen offset:1024 sc1
    s_waitcnt vmcnt(11)
    v_mfma_f32_32x32x16_bf16 v[16:31], a[184:187], a[56:59], v[16:31]
    buffer_load_dwordx4 a[104:107], v242, s[24:27], s44 offen offset:2048 sc1
    s_waitcnt vmcnt(11)
    v_mfma_f32_32x32x16_bf16 v[16:31], a[188:191], a[60:63], v[16:31]
    buffer_load_dwordx4 a[108:111], v242, s[24:27], s44 offen offset:3072 sc1
    s_waitcnt vmcnt(11)
    v_mfma_f32_32x32x16_bf16 v[16:31], a[192:195], a[64:67], v[16:31]
    buffer_load_dwordx4 a[112:115], v243, s[24:27], s44 offen offset:0 sc1
    s_waitcnt vmcnt(11)
    v_mfma_f32_32x32x16_bf16 v[16:31], a[196:199], a[68:71], v[16:31]
    buffer_load_dwordx4 a[116:119], v243, s[24:27], s44 offen offset:1024 sc1
    s_waitcnt vmcnt(11)
    v_mfma_f32_32x32x16_bf16 v[16:31], a[200:203], a[72:75], v[16:31]
    buffer_load_dwordx4 a[120:123], v243, s[24:27], s44 offen offset:2048 sc1
    s_waitcnt vmcnt(11)
    v_mfma_f32_32x32x16_bf16 v[16:31], a[204:207], a[76:79], v[16:31]
    buffer_load_dwordx4 a[124:127], v243, s[24:27], s44 offen offset:3072 sc1
    s_waitcnt vmcnt(11)
    v_mfma_f32_32x32x16_bf16 v[16:31], a[208:211], a[80:83], v[16:31]
    s_waitcnt vmcnt(10)
    v_mfma_f32_32x32x16_bf16 v[16:31], a[212:215], a[84:87], v[16:31]
    s_waitcnt vmcnt(9)
    v_mfma_f32_32x32x16_bf16 v[16:31], a[216:219], a[88:91], v[16:31]
    s_waitcnt vmcnt(8)
    v_mfma_f32_32x32x16_bf16 v[16:31], a[220:223], a[92:95], v[16:31]
    s_waitcnt vmcnt(7)
    v_mfma_f32_32x32x16_bf16 v[16:31], a[224:227], a[96:99], v[16:31]
    s_waitcnt vmcnt(6)
    v_mfma_f32_32x32x16_bf16 v[16:31], a[228:231], a[100:103], v[16:31]
    s_waitcnt vmcnt(5)
    v_mfma_f32_32x32x16_bf16 v[16:31], a[232:235], a[104:107], v[16:31]
    s_waitcnt vmcnt(4)
    v_mfma_f32_32x32x16_bf16 v[16:31], a[236:239], a[108:111], v[16:31]
    s_waitcnt vmcnt(3)
    v_mfma_f32_32x32x16_bf16 v[16:31], a[240:243], a[112:115], v[16:31]
    s_waitcnt vmcnt(2)
    v_mfma_f32_32x32x16_bf16 v[16:31], a[244:247], a[116:119], v[16:31]
    s_waitcnt vmcnt(1)
    v_mfma_f32_32x32x16_bf16 v[16:31], a[248:251], a[120:123], v[16:31]
    s_waitcnt vmcnt(0)
    v_mfma_f32_32x32x16_bf16 v[16:31], a[252:255], a[124:127], v[16:31]
    s_add_u32 s40, s66, s30
    s_add_u32 s40, s40, 10485760
    s_nop 7
    s_nop 1
    v_permlane32_swap_b32 v16, v20
    v_permlane32_swap_b32 v17, v21
    v_permlane32_swap_b32 v18, v22
    v_permlane32_swap_b32 v19, v23
    v_permlane32_swap_b32 v24, v28
    v_permlane32_swap_b32 v25, v29
    v_permlane32_swap_b32 v26, v30
    v_permlane32_swap_b32 v27, v31
    v_lshlrev_b32 v8, 16, v32
    v_and_b32 v9, 0xffff0000, v32
    v_pk_add_f32 v[16:17], v[16:17], v[8:9]
    v_cvt_pk_bf16_f32 v248, v16, v17
    v_lshlrev_b32 v8, 16, v33
    v_and_b32 v9, 0xffff0000, v33
    v_pk_add_f32 v[18:19], v[18:19], v[8:9]
    v_cvt_pk_bf16_f32 v249, v18, v19
    v_lshlrev_b32 v8, 16, v34
    v_and_b32 v9, 0xffff0000, v34
    v_pk_add_f32 v[20:21], v[20:21], v[8:9]
    v_cvt_pk_bf16_f32 v250, v20, v21
    v_lshlrev_b32 v8, 16, v35
    v_and_b32 v9, 0xffff0000, v35
    v_pk_add_f32 v[22:23], v[22:23], v[8:9]
    v_cvt_pk_bf16_f32 v251, v22, v23
    v_lshlrev_b32 v8, 16, v36
    v_and_b32 v9, 0xffff0000, v36
    v_pk_add_f32 v[24:25], v[24:25], v[8:9]
    v_cvt_pk_bf16_f32 v252, v24, v25
    v_lshlrev_b32 v8, 16, v37
    v_and_b32 v9, 0xffff0000, v37
    v_pk_add_f32 v[26:27], v[26:27], v[8:9]
    v_cvt_pk_bf16_f32 v253, v26, v27
    v_lshlrev_b32 v8, 16, v38
    v_and_b32 v9, 0xffff0000, v38
    v_pk_add_f32 v[28:29], v[28:29], v[8:9]
    v_cvt_pk_bf16_f32 v254, v28, v29
    v_lshlrev_b32 v8, 16, v39
    v_and_b32 v9, 0xffff0000, v39
    v_pk_add_f32 v[30:31], v[30:31], v[8:9]
    v_cvt_pk_bf16_f32 v255, v30, v31
    buffer_store_dwordx4 v[248:251], v2, s[24:27], s40 offen sc1
    buffer_store_dwordx4 v[252:255], v2, s[24:27], s40 offen offset:1024 sc1
    v_pk_mul_f32 v[50:51], v[16:17], v[16:17]
    v_pk_add_f32 v[48:49], v[16:17], v[18:19]
    v_pk_fma_f32 v[50:51], v[18:19], v[18:19], v[50:51]
    v_pk_fma_f32 v[50:51], v[20:21], v[20:21], v[50:51]
    v_pk_add_f32 v[48:49], v[48:49], v[20:21]
    v_pk_fma_f32 v[50:51], v[22:23], v[22:23], v[50:51]
    v_pk_add_f32 v[48:49], v[48:49], v[22:23]
    v_pk_fma_f32 v[50:51], v[24:25], v[24:25], v[50:51]
    v_pk_add_f32 v[48:49], v[48:49], v[24:25]
    v_pk_fma_f32 v[50:51], v[26:27], v[26:27], v[50:51]
    v_pk_add_f32 v[48:49], v[48:49], v[26:27]
    v_pk_fma_f32 v[50:51], v[28:29], v[28:29], v[50:51]
    v_pk_add_f32 v[48:49], v[48:49], v[28:29]
    v_pk_fma_f32 v[50:51], v[30:31], v[30:31], v[50:51]
    v_pk_add_f32 v[48:49], v[48:49], v[30:31]
    v_add_f32 v48, v48, v49
    v_add_f32 v49, v50, v51
    v_mov_b32 v50, v48
    v_mov_b32 v51, v49
    s_add_u32 s40, s82, s30
    s_add_u32 s40, s40, 20185088
    v_permlane32_swap_b32 v48, v50
    v_permlane32_swap_b32 v49, v51
    v_pk_add_f32 v[48:49], v[48:49], v[50:51]
    s_mov_b64 exec, 0xffffffff
    buffer_store_dwordx2 v[48:49], v15, s[24:27], s40 offen sc1
    s_mov_b64 exec, -1
    v_add_u32 v200, 65536, v2
    v_add_u32 v201, 131072, v2
    s_mul_i32 s67, s43, 114688
    s_mul_i32 s40, s29, 7168
    s_add_u32 s67, s67, s40
    s_add_u32 s67, s67, s30
    s_add_u32 s67, s67, 12582912
    s_lshl_b32 s44, s43, 15
    s_add_u32 s44, s44, s30
    s_add_u32 s44, s44, 10485760
    s_add_u32 s42, s32, 49152
    s_add_u32 s42, s42, s93
    s_cmp_lg_u32 s3, 0
    s_waitcnt vmcnt(0)
    s_barrier
    s_cbranch_scc1 pk_kernel_sg_54
    s_mov_b64 exec, 1
    buffer_atomic_add v5, v6, s[24:27], s42 offen sc1
    s_mov_b64 exec, -1
pk_kernel_sg_54:
    ds_read_b128 v[128:131], v2 offset:0
    ds_read_b128 v[132:135], v2 offset:1024
    ds_read_b128 v[136:139], v2 offset:2048
    ds_read_b128 v[140:143], v2 offset:3072
    ds_read_b128 v[144:147], v2 offset:4096
    ds_read_b128 v[148:151], v2 offset:5120
    ds_read_b128 v[152:155], v2 offset:6144
    s_add_u32 m0, s33, 114688
    s_add_u32 s48, s48, 16384
    buffer_load_dwordx4 v2, s[24:27], s48 offen offset:0 lds
    buffer_load_dwordx4 v2, s[24:27], s48 offen offset:1024 lds
    buffer_load_dwordx4 v2, s[24:27], s48 offen offset:2048 lds
    buffer_load_dwordx4 v2, s[24:27], s48 offen offset:3072 lds
    s_add_u32 m0, s33, 131072
    s_add_u32 s48, s48, 16384
    buffer_load_dwordx4 v2, s[24:27], s48 offen offset:0 lds
    buffer_load_dwordx4 v2, s[24:27], s48 offen offset:1024 lds
    buffer_load_dwordx4 v2, s[24:27], s48 offen offset:2048 lds
    buffer_load_dwordx4 v2, s[24:27], s48 offen offset:3072 lds
    s_add_u32 m0, s33, 147456
    s_add_u32 s48, s48, 16384
    buffer_load_dwordx4 v2, s[24:27], s48 offen offset:0 lds
    buffer_load_dwordx4 v2, s[24:27], s48 offen offset:1024 lds
    buffer_load_dwordx4 v2, s[24:27], s48 offen offset:2048 lds
    buffer_load_dwordx4 v2, s[24:27], s48 offen offset:3072 lds
    buffer_load_dwordx4 a[128:131], v236, s[24:27], s70 offen offset:0
    buffer_load_dwordx4 a[132:135], v236, s[24:27], s71 offen offset:0
    buffer_load_dwordx4 a[136:139], v236, s[24:27], s70 offen offset:1024
    buffer_load_dwordx4 a[140:143], v236, s[24:27], s71 offen offset:1024
    s_mov_b64 exec, 1
    s_add_u32 s42, s96, 50036736
    buffer_load_dword v11, v10, s[24:27], s42 offen sc1
    s_mov_b64 exec, -1
    s_waitcnt vmcnt(0)
    v_cmp_gt_u32 vcc, s100, v11
    s_and_b32 vcc_lo, vcc_lo, 1
    s_cbranch_scc1 pk_kernel_sp_55
pk_kernel_pr_56:
    buffer_load_dwordx4 a[0:3], v236, s[24:27], s44 offen offset:0 sc1
    buffer_load_dwordx4 a[4:7], v236, s[24:27], s44 offen offset:1024 sc1
    buffer_load_dwordx4 a[8:11], v236, s[24:27], s44 offen offset:2048 sc1
    buffer_load_dwordx4 a[12:15], v236, s[24:27], s44 offen offset:3072 sc1
    buffer_load_dwordx4 a[16:19], v237, s[24:27], s44 offen offset:0 sc1
    buffer_load_dwordx4 a[20:23], v237, s[24:27], s44 offen offset:1024 sc1
    s_lshl_b32 s40, s43, 8
    s_add_u32 s40, s40, s30
    s_add_u32 s40, s40, 20185088
    buffer_load_dwordx2 v[160:161], v15, s[24:27], s40 offen sc1
    s_add_u32 s40, s40, 16384
    buffer_load_dwordx2 v[162:163], v15, s[24:27], s40 offen sc1
    s_add_u32 s40, s40, 16384
    buffer_load_dwordx2 v[164:165], v15, s[24:27], s40 offen sc1
    s_add_u32 s40, s40, 16384
    buffer_load_dwordx2 v[166:167], v15, s[24:27], s40 offen sc1
    s_add_u32 s40, s40, 16384
    buffer_load_dwordx2 v[168:169], v15, s[24:27], s40 offen sc1
    s_add_u32 s40, s40, 16384
    buffer_load_dwordx2 v[170:171], v15, s[24:27], s40 offen sc1
    s_add_u32 s40, s40, 16384
    buffer_load_dwordx2 v[172:173], v15, s[24:27], s40 offen sc1
    s_add_u32 s40, s40, 16384
    buffer_load_dwordx2 v[174:175], v15, s[24:27], s40 offen sc1
    buffer_load_dwordx4 a[24:27], v237, s[24:27], s44 offen offset:2048 sc1
    buffer_load_dwordx4 a[28:31], v237, s[24:27], s44 offen offset:3072 sc1
    buffer_load_dwordx4 a[32:35], v238, s[24:27], s44 offen offset:0 sc1
    buffer_load_dwordx4 a[36:39], v238, s[24:27], s44 offen offset:1024 sc1
    s_waitcnt vmcnt(17) lgkmcnt(6)
    v_mfma_f32_32x32x16_bf16 v[16:31], v[128:131], a[0:3], 0
    ds_read_b128 v[156:159], v2 offset:7168
    buffer_load_dwordx4 a[40:43], v238, s[24:27], s44 offen offset:2048 sc1
    s_waitcnt lgkmcnt(6)
    v_mfma_f32_32x32x16_bf16 v[32:47], v[132:135], a[0:3], 0
    ds_read_b128 v[128:131], v2 offset:8192
    s_waitcnt lgkmcnt(6)
    v_mfma_f32_32x32x16_bf16 v[48:63], v[136:139], a[0:3], 0
    ds_read_b128 v[132:135], v2 offset:9216
    s_waitcnt vmcnt(17) lgkmcnt(6)
    v_mfma_f32_32x32x16_bf16 v[16:31], v[140:143], a[4:7], v[16:31]
    ds_read_b128 v[136:139], v2 offset:10240
    buffer_load_dwordx4 a[44:47], v238, s[24:27], s44 offen offset:3072 sc1
    s_waitcnt lgkmcnt(6)
    v_mfma_f32_32x32x16_bf16 v[32:47], v[144:147], a[4:7], v[32:47]
    ds_read_b128 v[140:143], v2 offset:11264
    s_waitcnt lgkmcnt(6)
    v_mfma_f32_32x32x16_bf16 v[48:63], v[148:151], a[4:7], v[48:63]
    ds_read_b128 v[144:147], v2 offset:12288
    s_waitcnt vmcnt(17) lgkmcnt(6)
    v_mfma_f32_32x32x16_bf16 v[16:31], v[152:155], a[8:11], v[16:31]
    ds_read_b128 v[148:151], v2 offset:13312
    buffer_load_dwordx4 a[48:51], v239, s[24:27], s44 offen offset:0 sc1
    s_waitcnt lgkmcnt(6)
    v_mfma_f32_32x32x16_bf16 v[32:47], v[156:159], a[8:11], v[32:47]
    ds_read_b128 v[152:155], v2 offset:14336
    s_waitcnt lgkmcnt(6)
    v_mfma_f32_32x32x16_bf16 v[48:63], v[128:131], a[8:11], v[48:63]
    ds_read_b128 v[156:159], v2 offset:15360
    s_waitcnt vmcnt(17) lgkmcnt(6)
    v_mfma_f32_32x32x16_bf16 v[16:31], v[132:135], a[12:15], v[16:31]
    ds_read_b128 v[128:131], v2 offset:16384
    buffer_load_dwordx4 a[52:55], v239, s[24:27], s44 offen offset:1024 sc1
    s_waitcnt lgkmcnt(6)
    v_mfma_f32_32x32x16_bf16 v[32:47], v[136:139], a[12:15], v[32:47]
    ds_read_b128 v[132:135], v2 offset:17408
    s_waitcnt lgkmcnt(6)
    v_mfma_f32_32x32x16_bf16 v[48:63], v[140:143], a[12:15], v[48:63]
    ds_read_b128 v[136:139], v2 offset:18432
    s_waitcnt vmcnt(17) lgkmcnt(6)
    v_mfma_f32_32x32x16_bf16 v[16:31], v[144:147], a[16:19], v[16:31]
    ds_read_b128 v[140:143], v2 offset:19456
    buffer_load_dwordx4 a[56:59], v239, s[24:27], s44 offen offset:2048 sc1
    s_waitcnt lgkmcnt(6)
    v_mfma_f32_32x32x16_bf16 v[32:47], v[148:151], a[16:19], v[32:47]
    ds_read_b128 v[144:147], v2 offset:20480
    s_waitcnt lgkmcnt(6)
    v_mfma_f32_32x32x16_bf16 v[48:63], v[152:155], a[16:19], v[48:63]
    ds_read_b128 v[148:151], v2 offset:21504
    s_waitcnt vmcnt(17) lgkmcnt(6)
    v_mfma_f32_32x32x16_bf16 v[16:31], v[156:159], a[20:23], v[16:31]
    ds_read_b128 v[152:155], v2 offset:22528
    buffer_load_dwordx4 a[60:63], v239, s[24:27], s44 offen offset:3072 sc1
    s_waitcnt lgkmcnt(6)
    v_mfma_f32_32x32x16_bf16 v[32:47], v[128:131], a[20:23], v[32:47]
    ds_read_b128 v[156:159], v2 offset:23552
    s_waitcnt lgkmcnt(6)
    v_mfma_f32_32x32x16_bf16 v[48:63], v[132:135], a[20:23], v[48:63]
    ds_read_b128 v[128:131], v2 offset:24576
    s_waitcnt vmcnt(9) lgkmcnt(6)
    v_mfma_f32_32x32x16_bf16 v[16:31], v[136:139], a[24:27], v[16:31]
    ds_read_b128 v[132:135], v2 offset:25600
    buffer_load_dwordx4 a[64:67], v240, s[24:27], s44 offen offset:0 sc1
    s_waitcnt lgkmcnt(6)
    v_mfma_f32_32x32x16_bf16 v[32:47], v[140:143], a[24:27], v[32:47]
    ds_read_b128 v[136:139], v2 offset:26624
    s_waitcnt lgkmcnt(6)
    v_mfma_f32_32x32x16_bf16 v[48:63], v[144:147], a[24:27], v[48:63]
    ds_read_b128 v[140:143], v2 offset:27648
    s_waitcnt vmcnt(9) lgkmcnt(6)
    v_mfma_f32_32x32x16_bf16 v[16:31], v[148:151], a[28:31], v[16:31]
    ds_read_b128 v[144:147], v2 offset:28672
    buffer_load_dwordx4 a[68:71], v240, s[24:27], s44 offen offset:1024 sc1
    s_waitcnt lgkmcnt(6)
    v_mfma_f32_32x32x16_bf16 v[32:47], v[152:155], a[28:31], v[32:47]
    ds_read_b128 v[148:151], v2 offset:29696
    s_waitcnt lgkmcnt(6)
    v_mfma_f32_32x32x16_bf16 v[48:63], v[156:159], a[28:31], v[48:63]
    ds_read_b128 v[152:155], v2 offset:30720
    s_waitcnt vmcnt(9) lgkmcnt(6)
    v_mfma_f32_32x32x16_bf16 v[16:31], v[128:131], a[32:35], v[16:31]
    ds_read_b128 v[156:159], v2 offset:31744
    buffer_load_dwordx4 a[72:75], v240, s[24:27], s44 offen offset:2048 sc1
    s_waitcnt lgkmcnt(6)
    v_mfma_f32_32x32x16_bf16 v[32:47], v[132:135], a[32:35], v[32:47]
    ds_read_b128 v[128:131], v2 offset:32768
    s_waitcnt lgkmcnt(6)
    v_mfma_f32_32x32x16_bf16 v[48:63], v[136:139], a[32:35], v[48:63]
    ds_read_b128 v[132:135], v2 offset:33792
    s_waitcnt vmcnt(9) lgkmcnt(6)
    v_mfma_f32_32x32x16_bf16 v[16:31], v[140:143], a[36:39], v[16:31]
    ds_read_b128 v[136:139], v2 offset:34816
    buffer_load_dwordx4 a[76:79], v240, s[24:27], s44 offen offset:3072 sc1
    s_waitcnt lgkmcnt(6)
    v_mfma_f32_32x32x16_bf16 v[32:47], v[144:147], a[36:39], v[32:47]
    ds_read_b128 v[140:143], v2 offset:35840
    s_waitcnt lgkmcnt(6)
    v_mfma_f32_32x32x16_bf16 v[48:63], v[148:151], a[36:39], v[48:63]
    ds_read_b128 v[144:147], v2 offset:36864
    s_waitcnt vmcnt(9) lgkmcnt(6)
    v_mfma_f32_32x32x16_bf16 v[16:31], v[152:155], a[40:43], v[16:31]
    ds_read_b128 v[148:151], v2 offset:37888
    buffer_load_dwordx4 a[80:83], v241, s[24:27], s44 offen offset:0 sc1
    s_waitcnt lgkmcnt(6)
    v_mfma_f32_32x32x16_bf16 v[32:47], v[156:159], a[40:43], v[32:47]
    ds_read_b128 v[152:155], v2 offset:38912
    v_add_f32 v160, v160, v162
    s_waitcnt lgkmcnt(6)
    v_mfma_f32_32x32x16_bf16 v[48:63], v[128:131], a[40:43], v[48:63]
    ds_read_b128 v[156:159], v2 offset:39936
    v_add_f32 v161, v161, v163
    s_waitcnt vmcnt(9) lgkmcnt(6)
    v_mfma_f32_32x32x16_bf16 v[16:31], v[132:135], a[44:47], v[16:31]
    ds_read_b128 v[128:131], v2 offset:40960
    buffer_load_dwordx4 a[84:87], v241, s[24:27], s44 offen offset:1024 sc1
    v_add_f32 v160, v160, v164
    s_waitcnt lgkmcnt(6)
    v_mfma_f32_32x32x16_bf16 v[32:47], v[136:139], a[44:47], v[32:47]
    ds_read_b128 v[132:135], v2 offset:41984
    v_add_f32 v161, v161, v165
    s_waitcnt lgkmcnt(6)
    v_mfma_f32_32x32x16_bf16 v[48:63], v[140:143], a[44:47], v[48:63]
    ds_read_b128 v[136:139], v2 offset:43008
    v_add_f32 v160, v160, v166
    s_waitcnt vmcnt(9) lgkmcnt(6)
    v_mfma_f32_32x32x16_bf16 v[16:31], v[144:147], a[48:51], v[16:31]
    ds_read_b128 v[140:143], v2 offset:44032
    buffer_load_dwordx4 a[88:91], v241, s[24:27], s44 offen offset:2048 sc1
    v_add_f32 v161, v161, v167
    s_waitcnt lgkmcnt(6)
    v_mfma_f32_32x32x16_bf16 v[32:47], v[148:151], a[48:51], v[32:47]
    ds_read_b128 v[144:147], v2 offset:45056
    v_add_f32 v160, v160, v168
    s_waitcnt lgkmcnt(6)
    v_mfma_f32_32x32x16_bf16 v[48:63], v[152:155], a[48:51], v[48:63]
    ds_read_b128 v[148:151], v2 offset:46080
    v_add_f32 v161, v161, v169
    s_waitcnt vmcnt(9) lgkmcnt(6)
    v_mfma_f32_32x32x16_bf16 v[16:31], v[156:159], a[52:55], v[16:31]
    ds_read_b128 v[152:155], v2 offset:47104
    buffer_load_dwordx4 a[92:95], v241, s[24:27], s44 offen offset:3072 sc1
    v_add_f32 v160, v160, v170
    s_waitcnt lgkmcnt(6)
    v_mfma_f32_32x32x16_bf16 v[32:47], v[128:131], a[52:55], v[32:47]
    ds_read_b128 v[156:159], v2 offset:48128
    v_add_f32 v161, v161, v171
    s_waitcnt lgkmcnt(6)
    v_mfma_f32_32x32x16_bf16 v[48:63], v[132:135], a[52:55], v[48:63]
    ds_read_b128 v[128:131], v2 offset:49152
    v_add_f32 v160, v160, v172
    s_waitcnt vmcnt(9) lgkmcnt(6)
    v_mfma_f32_32x32x16_bf16 v[16:31], v[136:139], a[56:59], v[16:31]
    ds_read_b128 v[132:135], v2 offset:50176
    buffer_load_dwordx4 a[96:99], v242, s[24:27], s44 offen offset:0 sc1
    v_add_f32 v161, v161, v173
    s_waitcnt lgkmcnt(6)
    v_mfma_f32_32x32x16_bf16 v[32:47], v[140:143], a[56:59], v[32:47]
    ds_read_b128 v[136:139], v2 offset:51200
    v_add_f32 v160, v160, v174
    s_waitcnt lgkmcnt(6)
    v_mfma_f32_32x32x16_bf16 v[48:63], v[144:147], a[56:59], v[48:63]
    ds_read_b128 v[140:143], v2 offset:52224
    v_add_f32 v161, v161, v175
    s_waitcnt vmcnt(9) lgkmcnt(6)
    v_mfma_f32_32x32x16_bf16 v[16:31], v[148:151], a[60:63], v[16:31]
    ds_read_b128 v[144:147], v2 offset:53248
    buffer_load_dwordx4 a[100:103], v242, s[24:27], s44 offen offset:1024 sc1
    v_mov_b32 v162, v160
    s_waitcnt lgkmcnt(6)
    v_mfma_f32_32x32x16_bf16 v[32:47], v[152:155], a[60:63], v[32:47]
    ds_read_b128 v[148:151], v2 offset:54272
    v_mov_b32 v163, v161
    s_waitcnt lgkmcnt(6)
    v_mfma_f32_32x32x16_bf16 v[48:63], v[156:159], a[60:63], v[48:63]
    ds_read_b128 v[152:155], v2 offset:55296
    s_nop 1
    s_waitcnt vmcnt(9) lgkmcnt(6)
    v_mfma_f32_32x32x16_bf16 v[16:31], v[128:131], a[64:67], v[16:31]
    ds_read_b128 v[156:159], v2 offset:56320
    buffer_load_dwordx4 a[104:107], v242, s[24:27], s44 offen offset:2048 sc1
    v_permlane32_swap_b32 v160, v162
    s_waitcnt lgkmcnt(6)
    v_mfma_f32_32x32x16_bf16 v[32:47], v[132:135], a[64:67], v[32:47]
    ds_read_b128 v[128:131], v2 offset:57344
    v_permlane32_swap_b32 v161, v163
    s_waitcnt lgkmcnt(6)
    v_mfma_f32_32x32x16_bf16 v[48:63], v[136:139], a[64:67], v[48:63]
    ds_read_b128 v[132:135], v2 offset:58368
    v_add_f32 v160, v160, v162
    s_waitcnt vmcnt(9) lgkmcnt(6)
    v_mfma_f32_32x32x16_bf16 v[16:31], v[140:143], a[68:71], v[16:31]
    ds_read_b128 v[136:139], v2 offset:59392
    buffer_load_dwordx4 a[108:111], v242, s[24:27], s44 offen offset:3072 sc1
    v_add_f32 v161, v161, v163
    s_waitcnt lgkmcnt(6)
    v_mfma_f32_32x32x16_bf16 v[32:47], v[144:147], a[68:71], v[32:47]
    ds_read_b128 v[140:143], v2 offset:60416
    v_mul_f32 v160, -0.001953125, v160
    s_waitcnt lgkmcnt(6)
    v_mfma_f32_32x32x16_bf16 v[48:63], v[148:151], a[68:71], v[48:63]
    ds_read_b128 v[144:147], v2 offset:61440
    v_mul_f32 v161, 0.001953125, v161
    s_waitcnt vmcnt(9) lgkmcnt(6)
    v_mfma_f32_32x32x16_bf16 v[16:31], v[152:155], a[72:75], v[16:31]
    ds_read_b128 v[148:151], v2 offset:62464
    buffer_load_dwordx4 a[112:115], v243, s[24:27], s44 offen offset:0 sc1
    v_fma_f32 v161, -v160, v160, v161
    s_waitcnt lgkmcnt(6)
    v_mfma_f32_32x32x16_bf16 v[32:47], v[156:159], a[72:75], v[32:47]
    ds_read_b128 v[152:155], v2 offset:63488
    v_max_f32 v161, 0, v161
    s_waitcnt lgkmcnt(6)
    v_mfma_f32_32x32x16_bf16 v[48:63], v[128:131], a[72:75], v[48:63]
    ds_read_b128 v[156:159], v2 offset:64512
    v_cvt_pk_bf16_f32 v162, v161, v161
    s_waitcnt vmcnt(9) lgkmcnt(6)
    v_mfma_f32_32x32x16_bf16 v[16:31], v[132:135], a[76:79], v[16:31]
    ds_read_b128 v[128:131], v200 offset:0
    buffer_load_dwordx4 a[116:119], v243, s[24:27], s44 offen offset:1024 sc1
    v_lshlrev_b32 v161, 16, v162
    s_waitcnt lgkmcnt(6)
    v_mfma_f32_32x32x16_bf16 v[32:47], v[136:139], a[76:79], v[32:47]
    ds_read_b128 v[132:135], v200 offset:1024
    v_add_f32 v161, 1e-5, v161
    s_waitcnt lgkmcnt(6)
    v_mfma_f32_32x32x16_bf16 v[48:63], v[140:143], a[76:79], v[48:63]
    ds_read_b128 v[136:139], v200 offset:2048
    v_cvt_pk_bf16_f32 v162, v161, v161
    s_waitcnt vmcnt(9) lgkmcnt(6)
    v_mfma_f32_32x32x16_bf16 v[16:31], v[144:147], a[80:83], v[16:31]
    ds_read_b128 v[140:143], v200 offset:3072
    buffer_load_dwordx4 a[120:123], v243, s[24:27], s44 offen offset:2048 sc1
    v_lshlrev_b32 v161, 16, v162
    s_waitcnt lgkmcnt(6)
    v_mfma_f32_32x32x16_bf16 v[32:47], v[148:151], a[80:83], v[32:47]
    ds_read_b128 v[144:147], v200 offset:4096
    v_sqrt_f32 v161, v161
    s_waitcnt lgkmcnt(6)
    v_mfma_f32_32x32x16_bf16 v[48:63], v[152:155], a[80:83], v[48:63]
    ds_read_b128 v[148:151], v200 offset:5120
    v_cmp_eq_u32 vcc, 0, v4
    s_waitcnt vmcnt(9) lgkmcnt(6)
    v_mfma_f32_32x32x16_bf16 v[16:31], v[156:159], a[84:87], v[16:31]
    ds_read_b128 v[152:155], v200 offset:6144
    buffer_load_dwordx4 a[124:127], v243, s[24:27], s44 offen offset:3072 sc1
    buffer_load_dwordx4 a[144:147], v236, s[24:27], s70 offen offset:2048
    v_cvt_pk_bf16_f32 v162, v161, v161
    s_waitcnt lgkmcnt(6)
    v_mfma_f32_32x32x16_bf16 v[32:47], v[128:131], a[84:87], v[32:47]
    ds_read_b128 v[156:159], v200 offset:7168
    v_lshlrev_b32 v161, 16, v162
    s_waitcnt lgkmcnt(6)
    v_mfma_f32_32x32x16_bf16 v[48:63], v[132:135], a[84:87], v[48:63]
    ds_read_b128 v[128:131], v200 offset:8192
    v_rcp_f32 v12, v161
    s_waitcnt vmcnt(10) lgkmcnt(6)
    v_mfma_f32_32x32x16_bf16 v[16:31], v[136:139], a[88:91], v[16:31]
    ds_read_b128 v[132:135], v200 offset:9216
    buffer_load_dwordx4 a[148:151], v236, s[24:27], s71 offen offset:2048
    v_cvt_pk_bf16_f32 v162, v160, v160
    s_waitcnt lgkmcnt(6)
    v_mfma_f32_32x32x16_bf16 v[32:47], v[140:143], a[88:91], v[32:47]
    ds_read_b128 v[136:139], v200 offset:10240
    v_and_b32 v163, 0xffff, v162
    s_waitcnt lgkmcnt(6)
    v_mfma_f32_32x32x16_bf16 v[48:63], v[144:147], a[88:91], v[48:63]
    ds_read_b128 v[140:143], v200 offset:11264
    v_mov_b32 v178, 0
    s_waitcnt vmcnt(10) lgkmcnt(6)
    v_mfma_f32_32x32x16_bf16 v[16:31], v[148:151], a[92:95], v[16:31]
    ds_read_b128 v[144:147], v200 offset:12288
    buffer_load_dwordx4 a[152:155], v236, s[24:27], s70 offen offset:3072
    v_cndmask_b32 v176, 0, v162, vcc
    s_waitcnt lgkmcnt(6)
    v_mfma_f32_32x32x16_bf16 v[32:47], v[152:155], a[92:95], v[32:47]
    ds_read_b128 v[148:151], v200 offset:13312
    v_cndmask_b32 v177, 0, v163, vcc
    s_waitcnt lgkmcnt(6)
    v_mfma_f32_32x32x16_bf16 v[48:63], v[156:159], a[92:95], v[48:63]
    ds_read_b128 v[152:155], v200 offset:14336
    v_mov_b32 v179, 0
    s_waitcnt vmcnt(10) lgkmcnt(6)
    v_mfma_f32_32x32x16_bf16 v[16:31], v[128:131], a[96:99], v[16:31]
    ds_read_b128 v[156:159], v200 offset:15360
    buffer_load_dwordx4 a[156:159], v236, s[24:27], s71 offen offset:3072
    v_mul_f32 v13, -1.4426950408889634, v12
    s_waitcnt lgkmcnt(6)
    v_mfma_f32_32x32x16_bf16 v[32:47], v[132:135], a[96:99], v[32:47]
    ds_read_b128 v[128:131], v200 offset:16384
    v_mul_f32 v14, v161, v161
    s_waitcnt lgkmcnt(6)
    v_mfma_f32_32x32x16_bf16 v[48:63], v[136:139], a[96:99], v[48:63]
    ds_read_b128 v[132:135], v200 offset:17408
    s_waitcnt vmcnt(10) lgkmcnt(6)
    v_mfma_f32_32x32x16_bf16 v[16:31], v[140:143], a[100:103], v[16:31]
    ds_read_b128 v[136:139], v200 offset:18432
    buffer_load_dwordx4 a[160:163], v237, s[24:27], s70 offen offset:0
    s_waitcnt lgkmcnt(6)
    v_mfma_f32_32x32x16_bf16 v[32:47], v[144:147], a[100:103], v[32:47]
    ds_read_b128 v[140:143], v200 offset:19456
    s_waitcnt lgkmcnt(6)
    v_mfma_f32_32x32x16_bf16 v[48:63], v[148:151], a[100:103], v[48:63]
    ds_read_b128 v[144:147], v200 offset:20480
    s_waitcnt vmcnt(10) lgkmcnt(6)
    v_mfma_f32_32x32x16_bf16 v[16:31], v[152:155], a[104:107], v[16:31]
    ds_read_b128 v[148:151], v200 offset:21504
    buffer_load_dwordx4 a[164:167], v237, s[24:27], s71 offen offset:0
    s_waitcnt lgkmcnt(6)
    v_mfma_f32_32x32x16_bf16 v[32:47], v[156:159], a[104:107], v[32:47]
    ds_read_b128 v[152:155], v200 offset:22528
    s_waitcnt lgkmcnt(6)
    v_mfma_f32_32x32x16_bf16 v[48:63], v[128:131], a[104:107], v[48:63]
    ds_read_b128 v[156:159], v200 offset:23552
    s_waitcnt vmcnt(10) lgkmcnt(6)
    v_mfma_f32_32x32x16_bf16 v[16:31], v[132:135], a[108:111], v[16:31]
    ds_read_b128 v[128:131], v200 offset:24576
    buffer_load_dwordx4 a[168:171], v237, s[24:27], s70 offen offset:3072
    s_waitcnt lgkmcnt(6)
    v_mfma_f32_32x32x16_bf16 v[32:47], v[136:139], a[108:111], v[32:47]
    ds_read_b128 v[132:135], v200 offset:25600
    s_waitcnt lgkmcnt(6)
    v_mfma_f32_32x32x16_bf16 v[48:63], v[140:143], a[108:111], v[48:63]
    ds_read_b128 v[136:139], v200 offset:26624
    s_waitcnt vmcnt(10) lgkmcnt(6)
    v_mfma_f32_32x32x16_bf16 v[16:31], v[144:147], a[112:115], v[16:31]
    ds_read_b128 v[140:143], v200 offset:27648
    buffer_load_dwordx4 a[172:175], v237, s[24:27], s71 offen offset:3072
    s_waitcnt lgkmcnt(6)
    v_mfma_f32_32x32x16_bf16 v[32:47], v[148:151], a[112:115], v[32:47]
    ds_read_b128 v[144:147], v200 offset:28672
    s_waitcnt lgkmcnt(6)
    v_mfma_f32_32x32x16_bf16 v[48:63], v[152:155], a[112:115], v[48:63]
    ds_read_b128 v[148:151], v200 offset:29696
    s_waitcnt vmcnt(10) lgkmcnt(6)
    v_mfma_f32_32x32x16_bf16 v[16:31], v[156:159], a[116:119], v[16:31]
    ds_read_b128 v[152:155], v200 offset:30720
    buffer_load_dwordx4 a[176:179], v238, s[24:27], s70 offen offset:0
    s_waitcnt lgkmcnt(6)
    v_mfma_f32_32x32x16_bf16 v[32:47], v[128:131], a[116:119], v[32:47]
    ds_read_b128 v[156:159], v200 offset:31744
    s_barrier
    s_add_u32 m0, s33, 0
    s_add_u32 s48, s48, 16384
    buffer_load_dwordx4 v2, s[24:27], s48 offen offset:0 lds
    s_waitcnt lgkmcnt(6)
    v_mfma_f32_32x32x16_bf16 v[48:63], v[132:135], a[116:119], v[48:63]
    ds_read_b128 v[128:131], v200 offset:32768
    buffer_load_dwordx4 v2, s[24:27], s48 offen offset:1024 lds
    s_waitcnt vmcnt(12) lgkmcnt(6)
    v_mfma_f32_32x32x16_bf16 v[16:31], v[136:139], a[120:123], v[16:31]
    ds_read_b128 v[132:135], v200 offset:33792
    buffer_load_dwordx4 v2, s[24:27], s48 offen offset:2048 lds
    s_waitcnt lgkmcnt(6)
    v_mfma_f32_32x32x16_bf16 v[32:47], v[140:143], a[120:123], v[32:47]
    ds_read_b128 v[136:139], v200 offset:34816
    buffer_load_dwordx4 v2, s[24:27], s48 offen offset:3072 lds
    s_waitcnt lgkmcnt(6)
    v_mfma_f32_32x32x16_bf16 v[48:63], v[144:147], a[120:123], v[48:63]
    ds_read_b128 v[140:143], v200 offset:36864
    s_waitcnt vmcnt(13) lgkmcnt(6)
    v_mfma_f32_32x32x16_bf16 v[16:31], v[148:151], a[124:127], v[16:31]
    ds_read_b128 v[144:147], v200 offset:37888
    buffer_load_dwordx4 a[180:183], v238, s[24:27], s71 offen offset:0
    s_waitcnt lgkmcnt(6)
    v_mfma_f32_32x32x16_bf16 v[32:47], v[152:155], a[124:127], v[32:47]
    ds_read_b128 v[148:151], v200 offset:38912
    s_waitcnt lgkmcnt(6)
    v_mfma_f32_32x32x16_bf16 v[48:63], v[156:159], a[124:127], v[48:63]
    ds_read_b128 v[152:155], v200 offset:39936
    s_waitcnt lgkmcnt(6)
    v_mfma_f32_32x32x16_bf16 v[16:31], v[128:131], v[176:179], v[16:31]
    ds_read_b128 v[156:159], v200 offset:40960
    buffer_load_dwordx4 a[184:187], v238, s[24:27], s70 offen offset:1024
    s_waitcnt lgkmcnt(6)
    v_mfma_f32_32x32x16_bf16 v[32:47], v[132:135], v[176:179], v[32:47]
    ds_read_b128 v[128:131], v200 offset:41984
    s_waitcnt lgkmcnt(6)
    v_mfma_f32_32x32x16_bf16 v[48:63], v[136:139], v[176:179], v[48:63]
    ds_read_b128 v[132:135], v200 offset:43008
    s_waitcnt lgkmcnt(6)
    v_mfma_f32_32x32x16_bf16 v[64:79], v[140:143], a[0:3], 0
    ds_read_b128 v[136:139], v200 offset:44032
    buffer_load_dwordx4 a[188:191], v238, s[24:27], s71 offen offset:1024
    s_waitcnt lgkmcnt(6)
    v_mfma_f32_32x32x16_bf16 v[80:95], v[144:147], a[0:3], 0
    ds_read_b128 v[140:143], v200 offset:45056
    s_waitcnt lgkmcnt(6)
    v_mfma_f32_32x32x16_bf16 v[64:79], v[148:151], a[4:7], v[64:79]
    ds_read_b128 v[144:147], v200 offset:46080
    s_waitcnt lgkmcnt(6)
    v_mfma_f32_32x32x16_bf16 v[80:95], v[152:155], a[4:7], v[80:95]
    ds_read_b128 v[148:151], v200 offset:47104
    buffer_load_dwordx4 a[192:195], v238, s[24:27], s70 offen offset:2048
    s_waitcnt lgkmcnt(6)
    v_mfma_f32_32x32x16_bf16 v[64:79], v[156:159], a[8:11], v[64:79]
    ds_read_b128 v[152:155], v200 offset:48128
    s_add_u32 m0, s33, 16384
    s_add_u32 s48, s48, 16384
    buffer_load_dwordx4 v2, s[24:27], s48 offen offset:0 lds
    v_mul_f32 v180, v13, v16
    v_mul_f32 v181, v13, v17
    v_mul_f32 v182, v13, v18
    s_waitcnt lgkmcnt(6)
    v_mfma_f32_32x32x16_bf16 v[80:95], v[128:131], a[8:11], v[80:95]
    ds_read_b128 v[156:159], v200 offset:49152
    buffer_load_dwordx4 v2, s[24:27], s48 offen offset:1024 lds
    v_mul_f32 v183, v13, v19
    v_mul_f32 v184, v13, v20
    v_mul_f32 v185, v13, v21
    s_waitcnt lgkmcnt(6)
    v_mfma_f32_32x32x16_bf16 v[64:79], v[132:135], a[12:15], v[64:79]
    ds_read_b128 v[128:131], v200 offset:50176
    buffer_load_dwordx4 v2, s[24:27], s48 offen offset:2048 lds
    v_mul_f32 v186, v13, v22
    v_mul_f32 v187, v13, v23
    v_exp_f32 v180, v180
    s_waitcnt lgkmcnt(6)
    v_mfma_f32_32x32x16_bf16 v[80:95], v[136:139], a[12:15], v[80:95]
    ds_read_b128 v[132:135], v200 offset:51200
    buffer_load_dwordx4 v2, s[24:27], s48 offen offset:3072 lds
    v_exp_f32 v181, v181
    v_exp_f32 v182, v182
    v_exp_f32 v183, v183
    s_waitcnt lgkmcnt(6)
    v_mfma_f32_32x32x16_bf16 v[64:79], v[140:143], a[16:19], v[64:79]
    ds_read_b128 v[136:139], v200 offset:52224
    v_exp_f32 v184, v184
    v_exp_f32 v185, v185
    v_exp_f32 v186, v186
    s_waitcnt lgkmcnt(6)
    v_mfma_f32_32x32x16_bf16 v[80:95], v[144:147], a[16:19], v[80:95]
    ds_read_b128 v[140:143], v200 offset:53248
    buffer_load_dwordx4 a[196:199], v238, s[24:27], s71 offen offset:2048
    v_exp_f32 v187, v187
    v_mul_f32 v188, v16, v24
    v_mul_f32 v189, v17, v25
    s_waitcnt lgkmcnt(6)
    v_mfma_f32_32x32x16_bf16 v[64:79], v[148:151], a[20:23], v[64:79]
    ds_read_b128 v[144:147], v200 offset:54272
    v_mul_f32 v190, v18, v26
    v_mul_f32 v191, v19, v27
    v_mul_f32 v192, v20, v28
    s_waitcnt lgkmcnt(6)
    v_mfma_f32_32x32x16_bf16 v[80:95], v[152:155], a[20:23], v[80:95]
    ds_read_b128 v[148:151], v200 offset:55296
    v_mul_f32 v193, v21, v29
    v_mul_f32 v194, v22, v30
    v_mul_f32 v195, v23, v31
    s_waitcnt lgkmcnt(6)
    v_mfma_f32_32x32x16_bf16 v[64:79], v[156:159], a[24:27], v[64:79]
    ds_read_b128 v[152:155], v200 offset:56320
    buffer_load_dwordx4 a[200:203], v238, s[24:27], s70 offen offset:3072
    v_fma_f32 v180, v180, v14, v14
    v_fma_f32 v181, v181, v14, v14
    v_fma_f32 v182, v182, v14, v14
    s_waitcnt lgkmcnt(6)
    v_mfma_f32_32x32x16_bf16 v[80:95], v[128:131], a[24:27], v[80:95]
    ds_read_b128 v[156:159], v200 offset:57344
    v_fma_f32 v183, v183, v14, v14
    v_fma_f32 v184, v184, v14, v14
    v_fma_f32 v185, v185, v14, v14
    s_waitcnt lgkmcnt(6)
    v_mfma_f32_32x32x16_bf16 v[64:79], v[132:135], a[28:31], v[64:79]
    ds_read_b128 v[128:131], v200 offset:58368
    v_fma_f32 v186, v186, v14, v14
    v_fma_f32 v187, v187, v14, v14
    v_rcp_f32 v180, v180
    s_waitcnt lgkmcnt(6)
    v_mfma_f32_32x32x16_bf16 v[80:95], v[136:139], a[28:31], v[80:95]
    ds_read_b128 v[132:135], v200 offset:59392
    buffer_load_dwordx4 a[204:207], v238, s[24:27], s71 offen offset:3072
    v_rcp_f32 v181, v181
    v_rcp_f32 v182, v182
    v_rcp_f32 v183, v183
    s_waitcnt lgkmcnt(6)
    v_mfma_f32_32x32x16_bf16 v[64:79], v[140:143], a[32:35], v[64:79]
    ds_read_b128 v[136:139], v200 offset:60416
    v_rcp_f32 v184, v184
    v_rcp_f32 v185, v185
    v_rcp_f32 v186, v186
    s_waitcnt lgkmcnt(6)
    v_mfma_f32_32x32x16_bf16 v[80:95], v[144:147], a[32:35], v[80:95]
    ds_read_b128 v[140:143], v200 offset:61440
    v_rcp_f32 v187, v187
    s_nop 0
    v_mul_f32 v188, v188, v180
    s_waitcnt lgkmcnt(6)
    v_mfma_f32_32x32x16_bf16 v[64:79], v[148:151], a[36:39], v[64:79]
    ds_read_b128 v[144:147], v200 offset:62464
    buffer_load_dwordx4 a[208:211], v239, s[24:27], s70 offen offset:2048
    v_mul_f32 v189, v189, v181
    v_mul_f32 v190, v190, v182
    v_mul_f32 v191, v191, v183
    s_waitcnt lgkmcnt(6)
    v_mfma_f32_32x32x16_bf16 v[80:95], v[152:155], a[36:39], v[80:95]
    ds_read_b128 v[148:151], v200 offset:63488
    v_mul_f32 v192, v192, v184
    v_mul_f32 v193, v193, v185
    v_mul_f32 v194, v194, v186
    s_waitcnt lgkmcnt(6)
    v_mfma_f32_32x32x16_bf16 v[64:79], v[156:159], a[40:43], v[64:79]
    ds_read_b128 v[152:155], v200 offset:64512
    s_add_u32 m0, s33, 32768
    s_add_u32 s48, s48, 16384
    buffer_load_dwordx4 v2, s[24:27], s48 offen offset:0 lds
    v_mul_f32 v195, v195, v187
    v_cvt_pk_bf16_f32 v196, v188, v189
    v_cvt_pk_bf16_f32 v197, v190, v191
    s_waitcnt lgkmcnt(6)
    v_mfma_f32_32x32x16_bf16 v[80:95], v[128:131], a[40:43], v[80:95]
    s_barrier
    ds_read_b128 v[156:159], v201 offset:0
    buffer_load_dwordx4 v2, s[24:27], s48 offen offset:1024 lds
    v_cvt_pk_bf16_f32 v198, v192, v193
    v_cvt_pk_bf16_f32 v199, v194, v195
    s_nop 1
    s_waitcnt lgkmcnt(6)
    v_mfma_f32_32x32x16_bf16 v[64:79], v[132:135], a[44:47], v[64:79]
    ds_read_b128 v[128:131], v201 offset:1024
    buffer_load_dwordx4 v2, s[24:27], s48 offen offset:2048 lds
    v_permlane32_swap_b32 v196, v198
    v_permlane32_swap_b32 v197, v199
    buffer_store_dwordx4 v[196:199], v236, s[24:27], s67 offen offset:0 sc1
    s_waitcnt lgkmcnt(6)
    v_mfma_f32_32x32x16_bf16 v[80:95], v[136:139], a[44:47], v[80:95]
    ds_read_b128 v[132:135], v201 offset:2048
    buffer_load_dwordx4 v2, s[24:27], s48 offen offset:3072 lds
    v_mul_f32 v180, v13, v32
    v_mul_f32 v181, v13, v33
    v_mul_f32 v182, v13, v34
    s_waitcnt lgkmcnt(6)
    v_mfma_f32_32x32x16_bf16 v[64:79], v[140:143], a[48:51], v[64:79]
    ds_read_b128 v[136:139], v201 offset:3072
    buffer_load_dwordx4 a[212:215], v239, s[24:27], s71 offen offset:2048
    v_mul_f32 v183, v13, v35
    v_mul_f32 v184, v13, v36
    v_mul_f32 v185, v13, v37
    s_waitcnt lgkmcnt(6)
    v_mfma_f32_32x32x16_bf16 v[80:95], v[144:147], a[48:51], v[80:95]
    ds_read_b128 v[140:143], v201 offset:4096
    v_mul_f32 v186, v13, v38
    v_mul_f32 v187, v13, v39
    v_exp_f32 v180, v180
    s_waitcnt lgkmcnt(6)
    v_mfma_f32_32x32x16_bf16 v[64:79], v[148:151], a[52:55], v[64:79]
    ds_read_b128 v[144:147], v201 offset:5120
    v_exp_f32 v181, v181
    v_exp_f32 v182, v182
    v_exp_f32 v183, v183
    s_waitcnt lgkmcnt(6)
    v_mfma_f32_32x32x16_bf16 v[80:95], v[152:155], a[52:55], v[80:95]
    ds_read_b128 v[148:151], v201 offset:6144
    buffer_load_dwordx4 a[216:219], v239, s[24:27], s70 offen offset:3072
    v_exp_f32 v184, v184
    v_exp_f32 v185, v185
    v_exp_f32 v186, v186
    s_waitcnt lgkmcnt(6)
    v_mfma_f32_32x32x16_bf16 v[64:79], v[156:159], a[56:59], v[64:79]
    ds_read_b128 v[152:155], v201 offset:7168
    v_exp_f32 v187, v187
    v_mul_f32 v188, v32, v40
    v_mul_f32 v189, v33, v41
    s_waitcnt lgkmcnt(6)
    v_mfma_f32_32x32x16_bf16 v[80:95], v[128:131], a[56:59], v[80:95]
    ds_read_b128 v[156:159], v201 offset:8192
    v_mul_f32 v190, v34, v42
    v_mul_f32 v191, v35, v43
    v_mul_f32 v192, v36, v44
    s_waitcnt lgkmcnt(6)
    v_mfma_f32_32x32x16_bf16 v[64:79], v[132:135], a[60:63], v[64:79]
    ds_read_b128 v[128:131], v201 offset:9216
    buffer_load_dwordx4 a[220:223], v239, s[24:27], s71 offen offset:3072
    v_mul_f32 v193, v37, v45
    v_mul_f32 v194, v38, v46
    v_mul_f32 v195, v39, v47
    s_waitcnt lgkmcnt(6)
    v_mfma_f32_32x32x16_bf16 v[80:95], v[136:139], a[60:63], v[80:95]
    ds_read_b128 v[132:135], v201 offset:10240
    v_fma_f32 v180, v180, v14, v14
    v_fma_f32 v181, v181, v14, v14
    v_fma_f32 v182, v182, v14, v14
    s_waitcnt lgkmcnt(6)
    v_mfma_f32_32x32x16_bf16 v[64:79], v[140:143], a[64:67], v[64:79]
    ds_read_b128 v[136:139], v201 offset:11264
    v_fma_f32 v183, v183, v14, v14
    v_fma_f32 v184, v184, v14, v14
    v_fma_f32 v185, v185, v14, v14
    s_waitcnt lgkmcnt(6)
    v_mfma_f32_32x32x16_bf16 v[80:95], v[144:147], a[64:67], v[80:95]
    ds_read_b128 v[140:143], v201 offset:12288
    buffer_load_dwordx4 a[224:227], v240, s[24:27], s70 offen offset:0
    v_fma_f32 v186, v186, v14, v14
    v_fma_f32 v187, v187, v14, v14
    v_rcp_f32 v180, v180
    s_waitcnt lgkmcnt(6)
    v_mfma_f32_32x32x16_bf16 v[64:79], v[148:151], a[68:71], v[64:79]
    ds_read_b128 v[144:147], v201 offset:13312
    v_rcp_f32 v181, v181
    v_rcp_f32 v182, v182
    v_rcp_f32 v183, v183
    s_waitcnt lgkmcnt(6)
    v_mfma_f32_32x32x16_bf16 v[80:95], v[152:155], a[68:71], v[80:95]
    ds_read_b128 v[148:151], v201 offset:14336
    v_rcp_f32 v184, v184
    v_rcp_f32 v185, v185
    v_rcp_f32 v186, v186
    s_waitcnt lgkmcnt(6)
    v_mfma_f32_32x32x16_bf16 v[64:79], v[156:159], a[72:75], v[64:79]
    ds_read_b128 v[152:155], v201 offset:15360
    s_add_u32 m0, s33, 49152
    s_add_u32 s48, s48, 16384
    buffer_load_dwordx4 v2, s[24:27], s48 offen offset:0 lds
    v_rcp_f32 v187, v187
    s_nop 0
    v_mul_f32 v188, v188, v180
    s_waitcnt lgkmcnt(6)
    v_mfma_f32_32x32x16_bf16 v[80:95], v[128:131], a[72:75], v[80:95]
    s_barrier
    ds_read_b128 v[156:159], v201 offset:16384
    buffer_load_dwordx4 v2, s[24:27], s48 offen offset:1024 lds
    v_mul_f32 v189, v189, v181
    v_mul_f32 v190, v190, v182
    v_mul_f32 v191, v191, v183
    s_waitcnt lgkmcnt(6)
    v_mfma_f32_32x32x16_bf16 v[64:79], v[132:135], a[76:79], v[64:79]
    ds_read_b128 v[128:131], v201 offset:17408
    buffer_load_dwordx4 v2, s[24:27], s48 offen offset:2048 lds
    v_mul_f32 v192, v192, v184
    v_mul_f32 v193, v193, v185
    v_mul_f32 v194, v194, v186
    s_waitcnt lgkmcnt(6)
    v_mfma_f32_32x32x16_bf16 v[80:95], v[136:139], a[76:79], v[80:95]
    ds_read_b128 v[132:135], v201 offset:18432
    buffer_load_dwordx4 v2, s[24:27], s48 offen offset:3072 lds
    v_mul_f32 v195, v195, v187
    v_cvt_pk_bf16_f32 v196, v188, v189
    v_cvt_pk_bf16_f32 v197, v190, v191
    s_waitcnt lgkmcnt(6)
    v_mfma_f32_32x32x16_bf16 v[64:79], v[140:143], a[80:83], v[64:79]
    ds_read_b128 v[136:139], v201 offset:19456
    v_cvt_pk_bf16_f32 v198, v192, v193
    v_cvt_pk_bf16_f32 v199, v194, v195
    s_nop 1
    s_waitcnt lgkmcnt(6)
    v_mfma_f32_32x32x16_bf16 v[80:95], v[144:147], a[80:83], v[80:95]
    ds_read_b128 v[140:143], v201 offset:20480
    v_permlane32_swap_b32 v196, v198
    v_permlane32_swap_b32 v197, v199
    buffer_store_dwordx4 v[196:199], v236, s[24:27], s67 offen offset:1024 sc1
    s_waitcnt lgkmcnt(6)
    v_mfma_f32_32x32x16_bf16 v[64:79], v[148:151], a[84:87], v[64:79]
    ds_read_b128 v[144:147], v201 offset:21504
    buffer_load_dwordx4 a[228:231], v240, s[24:27], s71 offen offset:0
    v_mul_f32 v180, v13, v48
    v_mul_f32 v181, v13, v49
    v_mul_f32 v182, v13, v50
    s_waitcnt lgkmcnt(6)
    v_mfma_f32_32x32x16_bf16 v[80:95], v[152:155], a[84:87], v[80:95]
    ds_read_b128 v[148:151], v201 offset:22528
    v_mul_f32 v183, v13, v51
    v_mul_f32 v184, v13, v52
    v_mul_f32 v185, v13, v53
    s_waitcnt lgkmcnt(6)
    v_mfma_f32_32x32x16_bf16 v[64:79], v[156:159], a[88:91], v[64:79]
    ds_read_b128 v[152:155], v201 offset:23552
    v_mul_f32 v186, v13, v54
    v_mul_f32 v187, v13, v55
    v_exp_f32 v180, v180
    s_waitcnt lgkmcnt(6)
    v_mfma_f32_32x32x16_bf16 v[80:95], v[128:131], a[88:91], v[80:95]
    ds_read_b128 v[156:159], v201 offset:24576
    buffer_load_dwordx4 a[232:235], v240, s[24:27], s70 offen offset:1024
    v_exp_f32 v181, v181
    v_exp_f32 v182, v182
    v_exp_f32 v183, v183
    s_waitcnt lgkmcnt(6)
    v_mfma_f32_32x32x16_bf16 v[64:79], v[132:135], a[92:95], v[64:79]
    ds_read_b128 v[128:131], v201 offset:25600
    v_exp_f32 v184, v184
    v_exp_f32 v185, v185
    v_exp_f32 v186, v186
    s_waitcnt lgkmcnt(6)
    v_mfma_f32_32x32x16_bf16 v[80:95], v[136:139], a[92:95], v[80:95]
    ds_read_b128 v[132:135], v201 offset:26624
    v_exp_f32 v187, v187
    v_mul_f32 v188, v48, v56
    v_mul_f32 v189, v49, v57
    s_waitcnt lgkmcnt(6)
    v_mfma_f32_32x32x16_bf16 v[64:79], v[140:143], a[96:99], v[64:79]
    ds_read_b128 v[136:139], v201 offset:27648
    buffer_load_dwordx4 a[236:239], v240, s[24:27], s71 offen offset:1024
    v_mul_f32 v190, v50, v58
    v_mul_f32 v191, v51, v59
    v_mul_f32 v192, v52, v60
    s_waitcnt lgkmcnt(6)
    v_mfma_f32_32x32x16_bf16 v[80:95], v[144:147], a[96:99], v[80:95]
    ds_read_b128 v[140:143], v201 offset:28672
    v_mul_f32 v193, v53, v61
    v_mul_f32 v194, v54, v62
    v_mul_f32 v195, v55, v63
    s_waitcnt lgkmcnt(6)
    v_mfma_f32_32x32x16_bf16 v[64:79], v[148:151], a[100:103], v[64:79]
    ds_read_b128 v[144:147], v201 offset:29696
    v_fma_f32 v180, v180, v14, v14
    v_fma_f32 v181, v181, v14, v14
    v_fma_f32 v182, v182, v14, v14
    s_waitcnt lgkmcnt(6)
    v_mfma_f32_32x32x16_bf16 v[80:95], v[152:155], a[100:103], v[80:95]
    ds_read_b128 v[148:151], v201 offset:30720
    buffer_load_dwordx4 a[240:243], v240, s[24:27], s70 offen offset:2048
    v_fma_f32 v183, v183, v14, v14
    v_fma_f32 v184, v184, v14, v14
    v_fma_f32 v185, v185, v14, v14
    s_waitcnt lgkmcnt(6)
    v_mfma_f32_32x32x16_bf16 v[64:79], v[156:159], a[104:107], v[64:79]
    ds_read_b128 v[152:155], v201 offset:31744
    s_add_u32 m0, s33, 65536
    s_add_u32 s48, s48, 16384
    buffer_load_dwordx4 v2, s[24:27], s48 offen offset:0 lds
    v_fma_f32 v186, v186, v14, v14
    v_fma_f32 v187, v187, v14, v14
    v_rcp_f32 v180, v180
    s_waitcnt lgkmcnt(6)
    v_mfma_f32_32x32x16_bf16 v[80:95], v[128:131], a[104:107], v[80:95]
    s_waitcnt vmcnt(31)
    s_barrier
    ds_read_b128 v[156:159], v2 offset:0
    buffer_load_dwordx4 v2, s[24:27], s48 offen offset:1024 lds
    v_rcp_f32 v181, v181
    v_rcp_f32 v182, v182
    v_rcp_f32 v183, v183
    s_waitcnt lgkmcnt(6)
    v_mfma_f32_32x32x16_bf16 v[64:79], v[132:135], a[108:111], v[64:79]
    ds_read_b128 v[128:131], v2 offset:1024
    buffer_load_dwordx4 v2, s[24:27], s48 offen offset:2048 lds
    v_rcp_f32 v184, v184
    v_rcp_f32 v185, v185
    v_rcp_f32 v186, v186
    s_waitcnt lgkmcnt(6)
    v_mfma_f32_32x32x16_bf16 v[80:95], v[136:139], a[108:111], v[80:95]
    ds_read_b128 v[132:135], v2 offset:2048
    buffer_load_dwordx4 v2, s[24:27], s48 offen offset:3072 lds
    v_rcp_f32 v187, v187
    s_nop 0
    v_mul_f32 v188, v188, v180
    s_waitcnt lgkmcnt(6)
    v_mfma_f32_32x32x16_bf16 v[64:79], v[140:143], a[112:115], v[64:79]
    ds_read_b128 v[136:139], v2 offset:3072
    v_mul_f32 v189, v189, v181
    v_mul_f32 v190, v190, v182
    v_mul_f32 v191, v191, v183
    s_waitcnt lgkmcnt(6)
    v_mfma_f32_32x32x16_bf16 v[80:95], v[144:147], a[112:115], v[80:95]
    ds_read_b128 v[140:143], v2 offset:4096
    buffer_load_dwordx4 a[244:247], v240, s[24:27], s71 offen offset:2048
    v_mul_f32 v192, v192, v184
    v_mul_f32 v193, v193, v185
    v_mul_f32 v194, v194, v186
    s_waitcnt lgkmcnt(6)
    v_mfma_f32_32x32x16_bf16 v[64:79], v[148:151], a[116:119], v[64:79]
    ds_read_b128 v[144:147], v2 offset:5120
    v_mul_f32 v195, v195, v187
    v_cvt_pk_bf16_f32 v196, v188, v189
    v_cvt_pk_bf16_f32 v197, v190, v191
    s_waitcnt lgkmcnt(6)
    v_mfma_f32_32x32x16_bf16 v[80:95], v[152:155], a[116:119], v[80:95]
    ds_read_b128 v[148:151], v2 offset:8192
    v_cvt_pk_bf16_f32 v198, v192, v193
    v_cvt_pk_bf16_f32 v199, v194, v195
    s_nop 1
    s_waitcnt lgkmcnt(6)
    v_mfma_f32_32x32x16_bf16 v[64:79], v[156:159], a[120:123], v[64:79]
    ds_read_b128 v[152:155], v2 offset:9216
    buffer_load_dwordx4 a[248:251], v241, s[24:27], s70 offen offset:1024
    v_permlane32_swap_b32 v196, v198
    v_permlane32_swap_b32 v197, v199
    buffer_store_dwordx4 v[196:199], v236, s[24:27], s67 offen offset:2048 sc1
    s_waitcnt lgkmcnt(6)
    v_mfma_f32_32x32x16_bf16 v[80:95], v[128:131], a[120:123], v[80:95]
    ds_read_b128 v[156:159], v2 offset:10240
    s_waitcnt lgkmcnt(6)
    v_mfma_f32_32x32x16_bf16 v[64:79], v[132:135], a[124:127], v[64:79]
    ds_read_b128 v[128:131], v2 offset:11264
    s_waitcnt lgkmcnt(6)
    v_mfma_f32_32x32x16_bf16 v[80:95], v[136:139], a[124:127], v[80:95]
    ds_read_b128 v[132:135], v2 offset:12288
    buffer_load_dwordx4 a[252:255], v241, s[24:27], s71 offen offset:1024
    s_waitcnt lgkmcnt(6)
    v_mfma_f32_32x32x16_bf16 v[64:79], v[140:143], v[176:179], v[64:79]
    ds_read_b128 v[136:139], v2 offset:13312
    s_waitcnt lgkmcnt(6)
    v_mfma_f32_32x32x16_bf16 v[80:95], v[144:147], v[176:179], v[80:95]
    ds_read_b128 v[140:143], v2 offset:14336
    s_waitcnt lgkmcnt(6)
    v_mfma_f32_32x32x16_bf16 v[96:111], v[148:151], a[0:3], 0
    ds_read_b128 v[144:147], v2 offset:15360
    buffer_load_dwordx4 v[204:207], v241, s[24:27], s70 offen offset:2048
    s_waitcnt lgkmcnt(6)
    v_mfma_f32_32x32x16_bf16 v[112:127], v[152:155], a[0:3], 0
    s_waitcnt vmcnt(31)
    s_barrier
    ds_read_b128 v[148:151], v2 offset:16384
    s_waitcnt lgkmcnt(6)
    v_mfma_f32_32x32x16_bf16 v[96:111], v[156:159], a[4:7], v[96:111]
    ds_read_b128 v[152:155], v2 offset:17408
    s_waitcnt lgkmcnt(6)
    v_mfma_f32_32x32x16_bf16 v[112:127], v[128:131], a[4:7], v[112:127]
    ds_read_b128 v[156:159], v2 offset:18432
    buffer_load_dwordx4 v[208:211], v241, s[24:27], s71 offen offset:2048
    s_waitcnt lgkmcnt(6)
    v_mfma_f32_32x32x16_bf16 v[96:111], v[132:135], a[8:11], v[96:111]
    ds_read_b128 v[128:131], v2 offset:19456
    v_mul_f32 v180, v13, v64
    v_mul_f32 v181, v13, v65
    v_mul_f32 v182, v13, v66
    v_mul_f32 v183, v13, v67
    s_waitcnt lgkmcnt(6)
    v_mfma_f32_32x32x16_bf16 v[112:127], v[136:139], a[8:11], v[112:127]
    ds_read_b128 v[132:135], v2 offset:20480
    v_mul_f32 v184, v13, v68
    v_mul_f32 v185, v13, v69
    v_mul_f32 v186, v13, v70
    v_mul_f32 v187, v13, v71
    s_waitcnt lgkmcnt(6)
    v_mfma_f32_32x32x16_bf16 v[96:111], v[140:143], a[12:15], v[96:111]
    ds_read_b128 v[136:139], v2 offset:21504
    buffer_load_dwordx4 v[212:215], v241, s[24:27], s70 offen offset:3072
    v_exp_f32 v180, v180
    v_exp_f32 v181, v181
    v_exp_f32 v182, v182
    v_exp_f32 v183, v183
    s_waitcnt lgkmcnt(6)
    v_mfma_f32_32x32x16_bf16 v[112:127], v[144:147], a[12:15], v[112:127]
    ds_read_b128 v[140:143], v2 offset:22528
    v_exp_f32 v184, v184
    v_exp_f32 v185, v185
    v_exp_f32 v186, v186
    s_waitcnt lgkmcnt(6)
    v_mfma_f32_32x32x16_bf16 v[96:111], v[148:151], a[16:19], v[96:111]
    ds_read_b128 v[144:147], v2 offset:23552
    v_exp_f32 v187, v187
    v_mul_f32 v188, v64, v72
    v_mul_f32 v189, v65, v73
    s_waitcnt lgkmcnt(6)
    v_mfma_f32_32x32x16_bf16 v[112:127], v[152:155], a[16:19], v[112:127]
    ds_read_b128 v[148:151], v2 offset:24576
    buffer_load_dwordx4 v[216:219], v241, s[24:27], s71 offen offset:3072
    v_mul_f32 v190, v66, v74
    v_mul_f32 v191, v67, v75
    v_mul_f32 v192, v68, v76
    s_waitcnt lgkmcnt(6)
    v_mfma_f32_32x32x16_bf16 v[96:111], v[156:159], a[20:23], v[96:111]
    ds_read_b128 v[152:155], v2 offset:25600
    v_mul_f32 v193, v69, v77
    v_mul_f32 v194, v70, v78
    v_mul_f32 v195, v71, v79
    s_waitcnt lgkmcnt(6)
    v_mfma_f32_32x32x16_bf16 v[112:127], v[128:131], a[20:23], v[112:127]
    ds_read_b128 v[156:159], v2 offset:26624
    v_fma_f32 v180, v180, v14, v14
    v_fma_f32 v181, v181, v14, v14
    v_fma_f32 v182, v182, v14, v14
    s_waitcnt lgkmcnt(6)
    v_mfma_f32_32x32x16_bf16 v[96:111], v[132:135], a[24:27], v[96:111]
    ds_read_b128 v[128:131], v2 offset:27648
    buffer_load_dwordx4 v[220:223], v242, s[24:27], s70 offen offset:0
    v_fma_f32 v183, v183, v14, v14
    v_fma_f32 v184, v184, v14, v14
    v_fma_f32 v185, v185, v14, v14
    s_waitcnt lgkmcnt(6)
    v_mfma_f32_32x32x16_bf16 v[112:127], v[136:139], a[24:27], v[112:127]
    ds_read_b128 v[132:135], v2 offset:28672
    v_fma_f32 v186, v186, v14, v14
    v_fma_f32 v187, v187, v14, v14
    v_rcp_f32 v180, v180
    s_waitcnt lgkmcnt(6)
    v_mfma_f32_32x32x16_bf16 v[96:111], v[140:143], a[28:31], v[96:111]
    ds_read_b128 v[136:139], v2 offset:29696
    v_rcp_f32 v181, v181
    v_rcp_f32 v182, v182
    v_rcp_f32 v183, v183
    s_waitcnt lgkmcnt(6)
    v_mfma_f32_32x32x16_bf16 v[112:127], v[144:147], a[28:31], v[112:127]
    ds_read_b128 v[140:143], v2 offset:30720
    buffer_load_dwordx4 v[224:227], v242, s[24:27], s71 offen offset:0
    v_rcp_f32 v184, v184
    v_rcp_f32 v185, v185
    v_rcp_f32 v186, v186
    s_waitcnt lgkmcnt(6)
    v_mfma_f32_32x32x16_bf16 v[96:111], v[148:151], a[32:35], v[96:111]
    ds_read_b128 v[144:147], v2 offset:31744
    v_rcp_f32 v187, v187
    s_nop 0
    v_mul_f32 v188, v188, v180
    s_waitcnt lgkmcnt(6)
    v_mfma_f32_32x32x16_bf16 v[112:127], v[152:155], a[32:35], v[112:127]
    s_waitcnt vmcnt(27)
    s_barrier
    ds_read_b128 v[148:151], v2 offset:32768
    v_mul_f32 v189, v189, v181
    v_mul_f32 v190, v190, v182
    v_mul_f32 v191, v191, v183
    s_waitcnt lgkmcnt(6)
    v_mfma_f32_32x32x16_bf16 v[96:111], v[156:159], a[36:39], v[96:111]
    ds_read_b128 v[152:155], v2 offset:33792
    buffer_load_dwordx4 v[228:231], v242, s[24:27], s70 offen offset:1024
    v_mul_f32 v192, v192, v184
    v_mul_f32 v193, v193, v185
    v_mul_f32 v194, v194, v186
    s_waitcnt lgkmcnt(6)
    v_mfma_f32_32x32x16_bf16 v[112:127], v[128:131], a[36:39], v[112:127]
    ds_read_b128 v[156:159], v2 offset:34816
    v_mul_f32 v195, v195, v187
    v_cvt_pk_bf16_f32 v196, v188, v189
    v_cvt_pk_bf16_f32 v197, v190, v191
    s_waitcnt lgkmcnt(6)
    v_mfma_f32_32x32x16_bf16 v[96:111], v[132:135], a[40:43], v[96:111]
    ds_read_b128 v[128:131], v2 offset:35840
    v_cvt_pk_bf16_f32 v198, v192, v193
    v_cvt_pk_bf16_f32 v199, v194, v195
    s_nop 1
    s_waitcnt lgkmcnt(6)
    v_mfma_f32_32x32x16_bf16 v[112:127], v[136:139], a[40:43], v[112:127]
    ds_read_b128 v[132:135], v2 offset:36864
    buffer_load_dwordx4 v[232:235], v242, s[24:27], s71 offen offset:1024
    v_permlane32_swap_b32 v196, v198
    v_permlane32_swap_b32 v197, v199
    buffer_store_dwordx4 v[196:199], v236, s[24:27], s67 offen offset:3072 sc1
    s_waitcnt lgkmcnt(6)
    v_mfma_f32_32x32x16_bf16 v[96:111], v[140:143], a[44:47], v[96:111]
    ds_read_b128 v[136:139], v2 offset:37888
    v_mul_f32 v180, v13, v80
    v_mul_f32 v181, v13, v81
    v_mul_f32 v182, v13, v82
    s_waitcnt lgkmcnt(6)
    v_mfma_f32_32x32x16_bf16 v[112:127], v[144:147], a[44:47], v[112:127]
    ds_read_b128 v[140:143], v2 offset:38912
    v_mul_f32 v183, v13, v83
    v_mul_f32 v184, v13, v84
    v_mul_f32 v185, v13, v85
    s_waitcnt lgkmcnt(6)
    v_mfma_f32_32x32x16_bf16 v[96:111], v[148:151], a[48:51], v[96:111]
    ds_read_b128 v[144:147], v2 offset:39936
    buffer_load_dwordx4 v[16:19], v237, s[24:27], s70 offen offset:1024
    v_mul_f32 v186, v13, v86
    v_mul_f32 v187, v13, v87
    v_exp_f32 v180, v180
    s_waitcnt lgkmcnt(6)
    v_mfma_f32_32x32x16_bf16 v[112:127], v[152:155], a[48:51], v[112:127]
    ds_read_b128 v[148:151], v2 offset:40960
    v_exp_f32 v181, v181
    v_exp_f32 v182, v182
    v_exp_f32 v183, v183
    s_waitcnt lgkmcnt(6)
    v_mfma_f32_32x32x16_bf16 v[96:111], v[156:159], a[52:55], v[96:111]
    ds_read_b128 v[152:155], v2 offset:41984
    v_exp_f32 v184, v184
    v_exp_f32 v185, v185
    v_exp_f32 v186, v186
    s_waitcnt lgkmcnt(6)
    v_mfma_f32_32x32x16_bf16 v[112:127], v[128:131], a[52:55], v[112:127]
    ds_read_b128 v[156:159], v2 offset:43008
    buffer_load_dwordx4 v[20:23], v237, s[24:27], s71 offen offset:1024
    v_exp_f32 v187, v187
    v_mul_f32 v188, v80, v88
    v_mul_f32 v189, v81, v89
    s_waitcnt lgkmcnt(6)
    v_mfma_f32_32x32x16_bf16 v[96:111], v[132:135], a[56:59], v[96:111]
    ds_read_b128 v[128:131], v2 offset:44032
    v_mul_f32 v190, v82, v90
    v_mul_f32 v191, v83, v91
    v_mul_f32 v192, v84, v92
    s_waitcnt lgkmcnt(6)
    v_mfma_f32_32x32x16_bf16 v[112:127], v[136:139], a[56:59], v[112:127]
    ds_read_b128 v[132:135], v2 offset:45056
    v_mul_f32 v193, v85, v93
    v_mul_f32 v194, v86, v94
    v_mul_f32 v195, v87, v95
    s_waitcnt lgkmcnt(6)
    v_mfma_f32_32x32x16_bf16 v[96:111], v[140:143], a[60:63], v[96:111]
    ds_read_b128 v[136:139], v2 offset:46080
    buffer_load_dwordx4 v[24:27], v237, s[24:27], s70 offen offset:2048
    v_fma_f32 v180, v180, v14, v14
    v_fma_f32 v181, v181, v14, v14
    v_fma_f32 v182, v182, v14, v14
    s_waitcnt lgkmcnt(6)
    v_mfma_f32_32x32x16_bf16 v[112:127], v[144:147], a[60:63], v[112:127]
    ds_read_b128 v[140:143], v2 offset:47104
    v_fma_f32 v183, v183, v14, v14
    v_fma_f32 v184, v184, v14, v14
    v_fma_f32 v185, v185, v14, v14
    s_waitcnt lgkmcnt(6)
    v_mfma_f32_32x32x16_bf16 v[96:111], v[148:151], a[64:67], v[96:111]
    ds_read_b128 v[144:147], v2 offset:48128
    v_fma_f32 v186, v186, v14, v14
    v_fma_f32 v187, v187, v14, v14
    v_rcp_f32 v180, v180
    s_waitcnt lgkmcnt(6)
    v_mfma_f32_32x32x16_bf16 v[112:127], v[152:155], a[64:67], v[112:127]
    s_waitcnt vmcnt(25)
    s_barrier
    ds_read_b128 v[148:151], v2 offset:49152
    buffer_load_dwordx4 v[28:31], v237, s[24:27], s71 offen offset:2048
    v_rcp_f32 v181, v181
    v_rcp_f32 v182, v182
    v_rcp_f32 v183, v183
    s_waitcnt lgkmcnt(6)
    v_mfma_f32_32x32x16_bf16 v[96:111], v[156:159], a[68:71], v[96:111]
    ds_read_b128 v[152:155], v2 offset:50176
    v_rcp_f32 v184, v184
    v_rcp_f32 v185, v185
    v_rcp_f32 v186, v186
    s_waitcnt lgkmcnt(6)
    v_mfma_f32_32x32x16_bf16 v[112:127], v[128:131], a[68:71], v[112:127]
    ds_read_b128 v[156:159], v2 offset:51200
    v_rcp_f32 v187, v187
    s_nop 0
    v_mul_f32 v188, v188, v180
    s_waitcnt lgkmcnt(6)
    v_mfma_f32_32x32x16_bf16 v[96:111], v[132:135], a[72:75], v[96:111]
    ds_read_b128 v[128:131], v2 offset:52224
    buffer_load_dwordx4 v[32:35], v239, s[24:27], s70 offen offset:0
    v_mul_f32 v189, v189, v181
    v_mul_f32 v190, v190, v182
    v_mul_f32 v191, v191, v183
    s_waitcnt lgkmcnt(6)
    v_mfma_f32_32x32x16_bf16 v[112:127], v[136:139], a[72:75], v[112:127]
    ds_read_b128 v[132:135], v2 offset:53248
    v_mul_f32 v192, v192, v184
    v_mul_f32 v193, v193, v185
    v_mul_f32 v194, v194, v186
    s_waitcnt lgkmcnt(6)
    v_mfma_f32_32x32x16_bf16 v[96:111], v[140:143], a[76:79], v[96:111]
    ds_read_b128 v[136:139], v2 offset:54272
    v_mul_f32 v195, v195, v187
    v_cvt_pk_bf16_f32 v196, v188, v189
    v_cvt_pk_bf16_f32 v197, v190, v191
    s_waitcnt lgkmcnt(6)
    v_mfma_f32_32x32x16_bf16 v[112:127], v[144:147], a[76:79], v[112:127]
    ds_read_b128 v[140:143], v2 offset:55296
    buffer_load_dwordx4 v[36:39], v239, s[24:27], s71 offen offset:0
    v_cvt_pk_bf16_f32 v198, v192, v193
    v_cvt_pk_bf16_f32 v199, v194, v195
    s_nop 1
    s_waitcnt lgkmcnt(6)
    v_mfma_f32_32x32x16_bf16 v[96:111], v[148:151], a[80:83], v[96:111]
    ds_read_b128 v[144:147], v2 offset:56320
    v_permlane32_swap_b32 v196, v198
    v_permlane32_swap_b32 v197, v199
    buffer_store_dwordx4 v[196:199], v237, s[24:27], s67 offen offset:0 sc1
    s_waitcnt lgkmcnt(6)
    v_mfma_f32_32x32x16_bf16 v[112:127], v[152:155], a[80:83], v[112:127]
    ds_read_b128 v[148:151], v2 offset:57344
    s_waitcnt lgkmcnt(6)
    v_mfma_f32_32x32x16_bf16 v[96:111], v[156:159], a[84:87], v[96:111]
    ds_read_b128 v[152:155], v2 offset:58368
    buffer_load_dwordx4 v[40:43], v239, s[24:27], s70 offen offset:1024
    s_waitcnt lgkmcnt(6)
    v_mfma_f32_32x32x16_bf16 v[112:127], v[128:131], a[84:87], v[112:127]
    ds_read_b128 v[156:159], v2 offset:59392
    s_waitcnt lgkmcnt(6)
    v_mfma_f32_32x32x16_bf16 v[96:111], v[132:135], a[88:91], v[96:111]
    ds_read_b128 v[128:131], v2 offset:60416
    s_waitcnt lgkmcnt(6)
    v_mfma_f32_32x32x16_bf16 v[112:127], v[136:139], a[88:91], v[112:127]
    ds_read_b128 v[132:135], v2 offset:61440
    buffer_load_dwordx4 v[44:47], v239, s[24:27], s71 offen offset:1024
    s_waitcnt lgkmcnt(6)
    v_mfma_f32_32x32x16_bf16 v[96:111], v[140:143], a[92:95], v[96:111]
    ds_read_b128 v[136:139], v2 offset:62464
    s_waitcnt lgkmcnt(6)
    v_mfma_f32_32x32x16_bf16 v[112:127], v[144:147], a[92:95], v[112:127]
    ds_read_b128 v[140:143], v2 offset:63488
    s_waitcnt lgkmcnt(6)
    v_mfma_f32_32x32x16_bf16 v[96:111], v[148:151], a[96:99], v[96:111]
    ds_read_b128 v[144:147], v2 offset:64512
    buffer_load_dwordx4 v[48:51], v240, s[24:27], s70 offen offset:3072
    s_waitcnt lgkmcnt(6)
    v_mfma_f32_32x32x16_bf16 v[112:127], v[152:155], a[96:99], v[112:127]
    s_waitcnt vmcnt(23)
    s_barrier
    ds_read_b128 v[148:151], v200 offset:0
    s_waitcnt lgkmcnt(6)
    v_mfma_f32_32x32x16_bf16 v[96:111], v[156:159], a[100:103], v[96:111]
    ds_read_b128 v[152:155], v200 offset:1024
    s_waitcnt lgkmcnt(6)
    v_mfma_f32_32x32x16_bf16 v[112:127], v[128:131], a[100:103], v[112:127]
    ds_read_b128 v[156:159], v200 offset:2048
    buffer_load_dwordx4 v[52:55], v240, s[24:27], s71 offen offset:3072
    s_waitcnt lgkmcnt(6)
    v_mfma_f32_32x32x16_bf16 v[96:111], v[132:135], a[104:107], v[96:111]
    ds_read_b128 v[128:131], v200 offset:3072
    s_waitcnt lgkmcnt(6)
    v_mfma_f32_32x32x16_bf16 v[112:127], v[136:139], a[104:107], v[112:127]
    ds_read_b128 v[132:135], v200 offset:4096
    s_waitcnt lgkmcnt(6)
    v_mfma_f32_32x32x16_bf16 v[96:111], v[140:143], a[108:111], v[96:111]
    ds_read_b128 v[136:139], v200 offset:5120
    buffer_load_dwordx4 v[56:59], v241, s[24:27], s70 offen offset:0
    s_waitcnt lgkmcnt(6)
    v_mfma_f32_32x32x16_bf16 v[112:127], v[144:147], a[108:111], v[112:127]
    ds_read_b128 v[140:143], v200 offset:6144
    s_waitcnt lgkmcnt(6)
    v_mfma_f32_32x32x16_bf16 v[96:111], v[148:151], a[112:115], v[96:111]
    ds_read_b128 v[144:147], v200 offset:7168
    s_waitcnt lgkmcnt(6)
    v_mfma_f32_32x32x16_bf16 v[112:127], v[152:155], a[112:115], v[112:127]
    ds_read_b128 v[148:151], v200 offset:8192
    buffer_load_dwordx4 v[60:63], v241, s[24:27], s71 offen offset:0
    s_waitcnt lgkmcnt(6)
    v_mfma_f32_32x32x16_bf16 v[96:111], v[156:159], a[116:119], v[96:111]
    ds_read_b128 v[152:155], v200 offset:9216
    s_waitcnt lgkmcnt(6)
    v_mfma_f32_32x32x16_bf16 v[112:127], v[128:131], a[116:119], v[112:127]
    s_waitcnt lgkmcnt(5)
    v_mfma_f32_32x32x16_bf16 v[96:111], v[132:135], a[120:123], v[96:111]
    s_waitcnt lgkmcnt(4)
    v_mfma_f32_32x32x16_bf16 v[112:127], v[136:139], a[120:123], v[112:127]
    s_waitcnt lgkmcnt(3)
    v_mfma_f32_32x32x16_bf16 v[96:111], v[140:143], a[124:127], v[96:111]
    s_waitcnt lgkmcnt(2)
    v_mfma_f32_32x32x16_bf16 v[112:127], v[144:147], a[124:127], v[112:127]
    s_waitcnt lgkmcnt(1)
    v_mfma_f32_32x32x16_bf16 v[96:111], v[148:151], v[176:179], v[96:111]
    s_waitcnt lgkmcnt(0)
    v_mfma_f32_32x32x16_bf16 v[112:127], v[152:155], v[176:179], v[112:127]
    s_add_u32 s42, s32, 65536
    s_add_u32 s42, s42, s94
    s_cmp_lg_u32 s3, 0
    s_waitcnt vmcnt(6)
    s_barrier
    s_cbranch_scc1 pk_kernel_sg_59
    s_mov_b64 exec, 1
    buffer_atomic_add v5, v6, s[24:27], s42 offen sc1
    s_mov_b64 exec, -1
pk_kernel_sg_59:
    s_nop 7
    v_mul_f32 v180, v13, v96
    v_mul_f32 v181, v13, v97
    v_mul_f32 v182, v13, v98
    v_mul_f32 v183, v13, v99
    v_mul_f32 v184, v13, v100
    v_mul_f32 v185, v13, v101
    v_mul_f32 v186, v13, v102
    v_mul_f32 v187, v13, v103
    v_exp_f32 v180, v180
    v_exp_f32 v181, v181
    v_exp_f32 v182, v182
    v_exp_f32 v183, v183
    v_exp_f32 v184, v184
    v_exp_f32 v185, v185
    v_exp_f32 v186, v186
    v_exp_f32 v187, v187
    v_mul_f32 v188, v96, v104
    v_mul_f32 v189, v97, v105
    v_mul_f32 v190, v98, v106
    v_mul_f32 v191, v99, v107
    v_mul_f32 v192, v100, v108
    v_mul_f32 v193, v101, v109
    v_mul_f32 v194, v102, v110
    v_mul_f32 v195, v103, v111
    v_fma_f32 v180, v180, v14, v14
    v_fma_f32 v181, v181, v14, v14
    v_fma_f32 v182, v182, v14, v14
    v_fma_f32 v183, v183, v14, v14
    v_fma_f32 v184, v184, v14, v14
    v_fma_f32 v185, v185, v14, v14
    v_fma_f32 v186, v186, v14, v14
    v_fma_f32 v187, v187, v14, v14
    v_rcp_f32 v180, v180
    v_rcp_f32 v181, v181
    v_rcp_f32 v182, v182
    v_rcp_f32 v183, v183
    v_rcp_f32 v184, v184
    v_rcp_f32 v185, v185
    v_rcp_f32 v186, v186
    v_rcp_f32 v187, v187
    s_nop 0
    v_mul_f32 v188, v188, v180
    v_mul_f32 v189, v189, v181
    v_mul_f32 v190, v190, v182
    v_mul_f32 v191, v191, v183
    v_mul_f32 v192, v192, v184
    v_mul_f32 v193, v193, v185
    v_mul_f32 v194, v194, v186
    v_mul_f32 v195, v195, v187
    v_cvt_pk_bf16_f32 v196, v188, v189
    v_cvt_pk_bf16_f32 v197, v190, v191
    v_cvt_pk_bf16_f32 v198, v192, v193
    v_cvt_pk_bf16_f32 v199, v194, v195
    s_nop 1
    v_permlane32_swap_b32 v196, v198
    v_permlane32_swap_b32 v197, v199
    buffer_store_dwordx4 v[196:199], v237, s[24:27], s67 offen offset:1024 sc1
    v_mul_f32 v180, v13, v112
    v_mul_f32 v181, v13, v113
    v_mul_f32 v182, v13, v114
    v_mul_f32 v183, v13, v115
    v_mul_f32 v184, v13, v116
    v_mul_f32 v185, v13, v117
    v_mul_f32 v186, v13, v118
    v_mul_f32 v187, v13, v119
    v_exp_f32 v180, v180
    v_exp_f32 v181, v181
    v_exp_f32 v182, v182
    v_exp_f32 v183, v183
    v_exp_f32 v184, v184
    v_exp_f32 v185, v185
    v_exp_f32 v186, v186
    v_exp_f32 v187, v187
    v_mul_f32 v188, v112, v120
    v_mul_f32 v189, v113, v121
    v_mul_f32 v190, v114, v122
    v_mul_f32 v191, v115, v123
    v_mul_f32 v192, v116, v124
    v_mul_f32 v193, v117, v125
    v_mul_f32 v194, v118, v126
    v_mul_f32 v195, v119, v127
    v_fma_f32 v180, v180, v14, v14
    v_fma_f32 v181, v181, v14, v14
    v_fma_f32 v182, v182, v14, v14
    v_fma_f32 v183, v183, v14, v14
    v_fma_f32 v184, v184, v14, v14
    v_fma_f32 v185, v185, v14, v14
    v_fma_f32 v186, v186, v14, v14
    v_fma_f32 v187, v187, v14, v14
    v_rcp_f32 v180, v180
    v_rcp_f32 v181, v181
    v_rcp_f32 v182, v182
    v_rcp_f32 v183, v183
    v_rcp_f32 v184, v184
    v_rcp_f32 v185, v185
    v_rcp_f32 v186, v186
    v_rcp_f32 v187, v187
    s_nop 0
    v_mul_f32 v188, v188, v180
    v_mul_f32 v189, v189, v181
    v_mul_f32 v190, v190, v182
    v_mul_f32 v191, v191, v183
    v_mul_f32 v192, v192, v184
    v_mul_f32 v193, v193, v185
    v_mul_f32 v194, v194, v186
    v_mul_f32 v195, v195, v187
    v_cvt_pk_bf16_f32 v196, v188, v189
    v_cvt_pk_bf16_f32 v197, v190, v191
    v_cvt_pk_bf16_f32 v198, v192, v193
    v_cvt_pk_bf16_f32 v199, v194, v195
    s_nop 1
    v_permlane32_swap_b32 v196, v198
    v_permlane32_swap_b32 v197, v199
    buffer_store_dwordx4 v[196:199], v237, s[24:27], s67 offen offset:2048 sc1
    s_mul_i32 s40, s3, 28672
    s_add_u32 s40, s40, s30
    s_add_u32 s40, s40, 12582912
    s_mul_i32 s68, s64, 114688
    s_add_u32 s68, s68, s40
    s_xor_b32 s69, s64, 1
    s_mul_i32 s69, s69, 114688
    s_add_u32 s69, s69, s40
    s_mov_b64 exec, 1
    s_add_u32 s42, s97, 50053120
    buffer_load_dword v11, v10, s[24:27], s42 offen sc1
    s_mov_b64 exec, -1
    s_add_u32 s42, s32, 81920
    s_add_u32 s42, s42, s94
    s_cmp_lg_u32 s3, 0
    s_waitcnt vmcnt(0)
    s_barrier
    s_cbranch_scc1 pk_kernel_sg_60
    s_mov_b64 exec, 1
    buffer_atomic_add v5, v6, s[24:27], s42 offen sc1
    s_mov_b64 exec, -1
pk_kernel_sg_60:
    v_cmp_gt_u32 vcc, s99, v11
    s_and_b32 vcc_lo, vcc_lo, 1
    s_cbranch_scc1 pk_kernel_sp_61
pk_kernel_pr_62:
    buffer_load_dwordx4 a[0:3], v236, s[24:27], s68 offen offset:0 sc1
    buffer_load_dwordx4 a[4:7], v236, s[24:27], s69 offen offset:0 sc1
    buffer_load_dwordx4 a[8:11], v236, s[24:27], s68 offen offset:1024 sc1
    buffer_load_dwordx4 a[12:15], v236, s[24:27], s69 offen offset:1024 sc1
    buffer_load_dwordx4 a[16:19], v236, s[24:27], s68 offen offset:2048 sc1
    buffer_load_dwordx4 a[20:23], v236, s[24:27], s69 offen offset:2048 sc1
    buffer_load_dwordx4 a[24:27], v236, s[24:27], s68 offen offset:3072 sc1
    buffer_load_dwordx4 a[28:31], v236, s[24:27], s69 offen offset:3072 sc1
    buffer_load_dwordx4 a[32:35], v237, s[24:27], s68 offen offset:0 sc1
    buffer_load_dwordx4 a[36:39], v237, s[24:27], s69 offen offset:0 sc1
    buffer_load_dwordx4 a[40:43], v237, s[24:27], s68 offen offset:3072 sc1
    buffer_load_dwordx4 a[44:47], v237, s[24:27], s69 offen offset:3072 sc1
    s_waitcnt vmcnt(11)
    v_mfma_f32_32x32x16_bf16 v[128:143], a[128:131], a[0:3], 0
    v_mfma_f32_32x32x16_bf16 v[144:159], a[132:135], a[0:3], 0
    buffer_load_dwordx4 a[48:51], v238, s[24:27], s68 offen offset:0 sc1
    buffer_load_dwordx4 a[52:55], v238, s[24:27], s69 offen offset:0 sc1
    s_waitcnt vmcnt(12)
    v_mfma_f32_32x32x16_bf16 v[160:175], a[128:131], a[4:7], 0
    buffer_load_dwordx4 v[64:67], v242, s[24:27], s70 offen offset:2048
    buffer_load_dwordx4 v[68:71], v242, s[24:27], s71 offen offset:2048
    v_mfma_f32_32x32x16_bf16 v[176:191], a[132:135], a[4:7], 0
    s_waitcnt vmcnt(13)
    v_mfma_f32_32x32x16_bf16 v[128:143], a[136:139], a[8:11], v[128:143]
    v_mfma_f32_32x32x16_bf16 v[144:159], a[140:143], a[8:11], v[144:159]
    buffer_load_dwordx4 a[56:59], v238, s[24:27], s68 offen offset:1024 sc1
    buffer_load_dwordx4 a[60:63], v238, s[24:27], s69 offen offset:1024 sc1
    s_waitcnt vmcnt(14)
    v_mfma_f32_32x32x16_bf16 v[160:175], a[136:139], a[12:15], v[160:175]
    buffer_load_dwordx4 v[72:75], v242, s[24:27], s70 offen offset:3072
    buffer_load_dwordx4 v[76:79], v242, s[24:27], s71 offen offset:3072
    v_mfma_f32_32x32x16_bf16 v[176:191], a[140:143], a[12:15], v[176:191]
    s_waitcnt vmcnt(15)
    v_mfma_f32_32x32x16_bf16 v[128:143], a[144:147], a[16:19], v[128:143]
    v_mfma_f32_32x32x16_bf16 v[144:159], a[148:151], a[16:19], v[144:159]
    buffer_load_dwordx4 a[64:67], v238, s[24:27], s68 offen offset:2048 sc1
    buffer_load_dwordx4 a[68:71], v238, s[24:27], s69 offen offset:2048 sc1
    s_waitcnt vmcnt(16)
    v_mfma_f32_32x32x16_bf16 v[160:175], a[144:147], a[20:23], v[160:175]
    v_mfma_f32_32x32x16_bf16 v[176:191], a[148:151], a[20:23], v[176:191]
    s_waitcnt vmcnt(15)
    v_mfma_f32_32x32x16_bf16 v[128:143], a[152:155], a[24:27], v[128:143]
    v_mfma_f32_32x32x16_bf16 v[144:159], a[156:159], a[24:27], v[144:159]
    buffer_load_dwordx4 a[72:75], v238, s[24:27], s68 offen offset:3072 sc1
    buffer_load_dwordx4 a[76:79], v238, s[24:27], s69 offen offset:3072 sc1
    s_waitcnt vmcnt(16)
    v_mfma_f32_32x32x16_bf16 v[160:175], a[152:155], a[28:31], v[160:175]
    v_mfma_f32_32x32x16_bf16 v[176:191], a[156:159], a[28:31], v[176:191]
    s_waitcnt vmcnt(15)
    v_mfma_f32_32x32x16_bf16 v[128:143], a[160:163], a[32:35], v[128:143]
    v_mfma_f32_32x32x16_bf16 v[144:159], a[164:167], a[32:35], v[144:159]
    buffer_load_dwordx4 a[80:83], v239, s[24:27], s68 offen offset:2048 sc1
    buffer_load_dwordx4 a[84:87], v239, s[24:27], s69 offen offset:2048 sc1
    s_waitcnt vmcnt(16)
    v_mfma_f32_32x32x16_bf16 v[160:175], a[160:163], a[36:39], v[160:175]
    v_mfma_f32_32x32x16_bf16 v[176:191], a[164:167], a[36:39], v[176:191]
    s_waitcnt vmcnt(15)
    v_mfma_f32_32x32x16_bf16 v[128:143], a[168:171], a[40:43], v[128:143]
    v_mfma_f32_32x32x16_bf16 v[144:159], a[172:175], a[40:43], v[144:159]
    buffer_load_dwordx4 a[88:91], v239, s[24:27], s68 offen offset:3072 sc1
    buffer_load_dwordx4 a[92:95], v239, s[24:27], s69 offen offset:3072 sc1
    s_waitcnt vmcnt(16)
    v_mfma_f32_32x32x16_bf16 v[160:175], a[168:171], a[44:47], v[160:175]
    v_mfma_f32_32x32x16_bf16 v[176:191], a[172:175], a[44:47], v[176:191]
    s_waitcnt vmcnt(15)
    v_mfma_f32_32x32x16_bf16 v[128:143], a[176:179], a[48:51], v[128:143]
    v_mfma_f32_32x32x16_bf16 v[144:159], a[180:183], a[48:51], v[144:159]
    buffer_load_dwordx4 a[96:99], v240, s[24:27], s68 offen offset:0 sc1
    buffer_load_dwordx4 a[100:103], v240, s[24:27], s69 offen offset:0 sc1
    s_waitcnt vmcnt(16)
    v_mfma_f32_32x32x16_bf16 v[160:175], a[176:179], a[52:55], v[160:175]
    v_mfma_f32_32x32x16_bf16 v[176:191], a[180:183], a[52:55], v[176:191]
    s_waitcnt vmcnt(13)
    v_mfma_f32_32x32x16_bf16 v[128:143], a[184:187], a[56:59], v[128:143]
    v_mfma_f32_32x32x16_bf16 v[144:159], a[188:191], a[56:59], v[144:159]
    buffer_load_dwordx4 a[104:107], v240, s[24:27], s68 offen offset:1024 sc1
    buffer_load_dwordx4 a[108:111], v240, s[24:27], s69 offen offset:1024 sc1
    s_waitcnt vmcnt(14)
    v_mfma_f32_32x32x16_bf16 v[160:175], a[184:187], a[60:63], v[160:175]
    v_mfma_f32_32x32x16_bf16 v[176:191], a[188:191], a[60:63], v[176:191]
    s_waitcnt vmcnt(11)
    v_mfma_f32_32x32x16_bf16 v[128:143], a[192:195], a[64:67], v[128:143]
    v_mfma_f32_32x32x16_bf16 v[144:159], a[196:199], a[64:67], v[144:159]
    buffer_load_dwordx4 a[112:115], v240, s[24:27], s68 offen offset:2048 sc1
    buffer_load_dwordx4 a[116:119], v240, s[24:27], s69 offen offset:2048 sc1
    s_waitcnt vmcnt(12)
    v_mfma_f32_32x32x16_bf16 v[160:175], a[192:195], a[68:71], v[160:175]
    v_mfma_f32_32x32x16_bf16 v[176:191], a[196:199], a[68:71], v[176:191]
    s_waitcnt vmcnt(11)
    v_mfma_f32_32x32x16_bf16 v[128:143], a[200:203], a[72:75], v[128:143]
    v_mfma_f32_32x32x16_bf16 v[144:159], a[204:207], a[72:75], v[144:159]
    buffer_load_dwordx4 a[120:123], v241, s[24:27], s68 offen offset:1024 sc1
    buffer_load_dwordx4 a[124:127], v241, s[24:27], s69 offen offset:1024 sc1
    s_waitcnt vmcnt(12)
    v_mfma_f32_32x32x16_bf16 v[160:175], a[200:203], a[76:79], v[160:175]
    v_mfma_f32_32x32x16_bf16 v[176:191], a[204:207], a[76:79], v[176:191]
    s_waitcnt vmcnt(11)
    v_mfma_f32_32x32x16_bf16 v[128:143], a[208:211], a[80:83], v[128:143]
    s_mov_b64 exec, 1
    s_add_u32 s42, s97, 50069504
    buffer_load_dword v11, v10, s[24:27], s42 offen sc1
    s_mov_b64 exec, -1
    v_mfma_f32_32x32x16_bf16 v[144:159], a[212:215], a[80:83], v[144:159]
    buffer_load_dwordx4 a[0:3], v241, s[24:27], s68 offen offset:2048 sc1
    buffer_load_dwordx4 a[4:7], v241, s[24:27], s69 offen offset:2048 sc1
    s_waitcnt vmcnt(13)
    v_mfma_f32_32x32x16_bf16 v[160:175], a[208:211], a[84:87], v[160:175]
    v_mfma_f32_32x32x16_bf16 v[176:191], a[212:215], a[84:87], v[176:191]
    s_waitcnt vmcnt(12)
    v_mfma_f32_32x32x16_bf16 v[128:143], a[216:219], a[88:91], v[128:143]
    v_mfma_f32_32x32x16_bf16 v[144:159], a[220:223], a[88:91], v[144:159]
    buffer_load_dwordx4 a[8:11], v241, s[24:27], s68 offen offset:3072 sc1
    buffer_load_dwordx4 a[12:15], v241, s[24:27], s69 offen offset:3072 sc1
    s_waitcnt vmcnt(13)
    v_mfma_f32_32x32x16_bf16 v[160:175], a[216:219], a[92:95], v[160:175]
    v_mfma_f32_32x32x16_bf16 v[176:191], a[220:223], a[92:95], v[176:191]
    s_waitcnt vmcnt(12)
    v_mfma_f32_32x32x16_bf16 v[128:143], a[224:227], a[96:99], v[128:143]
    v_mfma_f32_32x32x16_bf16 v[144:159], a[228:231], a[96:99], v[144:159]
    buffer_load_dwordx4 a[16:19], v242, s[24:27], s68 offen offset:0 sc1
    buffer_load_dwordx4 a[20:23], v242, s[24:27], s69 offen offset:0 sc1
    s_waitcnt vmcnt(13)
    v_mfma_f32_32x32x16_bf16 v[160:175], a[224:227], a[100:103], v[160:175]
    v_mfma_f32_32x32x16_bf16 v[176:191], a[228:231], a[100:103], v[176:191]
    s_waitcnt vmcnt(12)
    v_mfma_f32_32x32x16_bf16 v[128:143], a[232:235], a[104:107], v[128:143]
    v_mfma_f32_32x32x16_bf16 v[144:159], a[236:239], a[104:107], v[144:159]
    buffer_load_dwordx4 a[24:27], v242, s[24:27], s68 offen offset:1024 sc1
    buffer_load_dwordx4 a[28:31], v242, s[24:27], s69 offen offset:1024 sc1
    s_waitcnt vmcnt(13)
    v_mfma_f32_32x32x16_bf16 v[160:175], a[232:235], a[108:111], v[160:175]
    v_mfma_f32_32x32x16_bf16 v[176:191], a[236:239], a[108:111], v[176:191]
    s_waitcnt vmcnt(12)
    v_mfma_f32_32x32x16_bf16 v[128:143], a[240:243], a[112:115], v[128:143]
    s_waitcnt vmcnt(8)
    v_cmp_gt_u32 vcc, s99, v11
    s_and_b32 vcc_lo, vcc_lo, 1
    s_cbranch_scc1 pk_kernel_sp_65
pk_kernel_pr_66:
    v_mfma_f32_32x32x16_bf16 v[144:159], a[244:247], a[112:115], v[144:159]
    buffer_load_dwordx4 a[32:35], v237, s[24:27], s68 offen offset:1024 sc1
    buffer_load_dwordx4 a[36:39], v237, s[24:27], s69 offen offset:1024 sc1
    v_mfma_f32_32x32x16_bf16 v[160:175], a[240:243], a[116:119], v[160:175]
    v_mfma_f32_32x32x16_bf16 v[176:191], a[244:247], a[116:119], v[176:191]
    v_mfma_f32_32x32x16_bf16 v[128:143], a[248:251], a[120:123], v[128:143]
    v_mfma_f32_32x32x16_bf16 v[144:159], a[252:255], a[120:123], v[144:159]
    buffer_load_dwordx4 a[40:43], v237, s[24:27], s68 offen offset:2048 sc1
    buffer_load_dwordx4 a[44:47], v237, s[24:27], s69 offen offset:2048 sc1
    v_mfma_f32_32x32x16_bf16 v[160:175], a[248:251], a[124:127], v[160:175]
    v_mfma_f32_32x32x16_bf16 v[176:191], a[252:255], a[124:127], v[176:191]
    s_waitcnt vmcnt(11)
    v_mfma_f32_32x32x16_bf16 v[128:143], v[204:207], a[0:3], v[128:143]
    v_mfma_f32_32x32x16_bf16 v[144:159], v[208:211], a[0:3], v[144:159]
    buffer_load_dwordx4 a[48:51], v239, s[24:27], s68 offen offset:0 sc1
    buffer_load_dwordx4 a[52:55], v239, s[24:27], s69 offen offset:0 sc1
    s_waitcnt vmcnt(12)
    v_mfma_f32_32x32x16_bf16 v[160:175], v[204:207], a[4:7], v[160:175]
    v_mfma_f32_32x32x16_bf16 v[176:191], v[208:211], a[4:7], v[176:191]
    s_waitcnt vmcnt(11)
    v_mfma_f32_32x32x16_bf16 v[128:143], v[212:215], a[8:11], v[128:143]
    v_mfma_f32_32x32x16_bf16 v[144:159], v[216:219], a[8:11], v[144:159]
    buffer_load_dwordx4 a[56:59], v239, s[24:27], s68 offen offset:1024 sc1
    buffer_load_dwordx4 a[60:63], v239, s[24:27], s69 offen offset:1024 sc1
    s_waitcnt vmcnt(12)
    v_mfma_f32_32x32x16_bf16 v[160:175], v[212:215], a[12:15], v[160:175]
    v_mfma_f32_32x32x16_bf16 v[176:191], v[216:219], a[12:15], v[176:191]
    s_waitcnt vmcnt(11)
    v_mfma_f32_32x32x16_bf16 v[128:143], v[220:223], a[16:19], v[128:143]
    v_mfma_f32_32x32x16_bf16 v[144:159], v[224:227], a[16:19], v[144:159]
    buffer_load_dwordx4 a[64:67], v240, s[24:27], s68 offen offset:3072 sc1
    buffer_load_dwordx4 a[68:71], v240, s[24:27], s69 offen offset:3072 sc1
    s_waitcnt vmcnt(12)
    v_mfma_f32_32x32x16_bf16 v[160:175], v[220:223], a[20:23], v[160:175]
    v_mfma_f32_32x32x16_bf16 v[176:191], v[224:227], a[20:23], v[176:191]
    s_waitcnt vmcnt(11)
    v_mfma_f32_32x32x16_bf16 v[128:143], v[228:231], a[24:27], v[128:143]
    v_mfma_f32_32x32x16_bf16 v[144:159], v[232:235], a[24:27], v[144:159]
    buffer_load_dwordx4 a[72:75], v241, s[24:27], s68 offen offset:0 sc1
    buffer_load_dwordx4 a[76:79], v241, s[24:27], s69 offen offset:0 sc1
    s_waitcnt vmcnt(12)
    v_mfma_f32_32x32x16_bf16 v[160:175], v[228:231], a[28:31], v[160:175]
    v_mfma_f32_32x32x16_bf16 v[176:191], v[232:235], a[28:31], v[176:191]
    s_waitcnt vmcnt(11)
    v_mfma_f32_32x32x16_bf16 v[128:143], v[16:19], a[32:35], v[128:143]
    v_mfma_f32_32x32x16_bf16 v[144:159], v[20:23], a[32:35], v[144:159]
    buffer_load_dwordx4 a[80:83], v242, s[24:27], s68 offen offset:2048 sc1
    buffer_load_dwordx4 a[84:87], v242, s[24:27], s69 offen offset:2048 sc1
    s_waitcnt vmcnt(12)
    v_mfma_f32_32x32x16_bf16 v[160:175], v[16:19], a[36:39], v[160:175]
    v_mfma_f32_32x32x16_bf16 v[176:191], v[20:23], a[36:39], v[176:191]
    s_waitcnt vmcnt(11)
    v_mfma_f32_32x32x16_bf16 v[128:143], v[24:27], a[40:43], v[128:143]
    v_mfma_f32_32x32x16_bf16 v[144:159], v[28:31], a[40:43], v[144:159]
    buffer_load_dwordx4 a[88:91], v242, s[24:27], s68 offen offset:3072 sc1
    buffer_load_dwordx4 a[92:95], v242, s[24:27], s69 offen offset:3072 sc1
    s_waitcnt vmcnt(12)
    v_mfma_f32_32x32x16_bf16 v[160:175], v[24:27], a[44:47], v[160:175]
    v_mfma_f32_32x32x16_bf16 v[176:191], v[28:31], a[44:47], v[176:191]
    s_waitcnt vmcnt(11)
    v_mfma_f32_32x32x16_bf16 v[128:143], v[32:35], a[48:51], v[128:143]
    v_mfma_f32_32x32x16_bf16 v[144:159], v[36:39], a[48:51], v[144:159]
    s_waitcnt vmcnt(10)
    v_mfma_f32_32x32x16_bf16 v[160:175], v[32:35], a[52:55], v[160:175]
    v_mfma_f32_32x32x16_bf16 v[176:191], v[36:39], a[52:55], v[176:191]
    s_waitcnt vmcnt(9)
    v_mfma_f32_32x32x16_bf16 v[128:143], v[40:43], a[56:59], v[128:143]
    v_mfma_f32_32x32x16_bf16 v[144:159], v[44:47], a[56:59], v[144:159]
    s_waitcnt vmcnt(8)
    v_mfma_f32_32x32x16_bf16 v[160:175], v[40:43], a[60:63], v[160:175]
    v_mfma_f32_32x32x16_bf16 v[176:191], v[44:47], a[60:63], v[176:191]
    s_waitcnt vmcnt(7)
    v_mfma_f32_32x32x16_bf16 v[128:143], v[48:51], a[64:67], v[128:143]
    v_mfma_f32_32x32x16_bf16 v[144:159], v[52:55], a[64:67], v[144:159]
    s_waitcnt vmcnt(6)
    v_mfma_f32_32x32x16_bf16 v[160:175], v[48:51], a[68:71], v[160:175]
    v_mfma_f32_32x32x16_bf16 v[176:191], v[52:55], a[68:71], v[176:191]
    s_xor_b32 s40, s3, 1
    s_mul_i32 s40, s40, 12288
    s_add_u32 s40, s40, 0
    v_add_u32 v201, s40, v2
    s_xor_b32 s40, s3, 2
    s_mul_i32 s40, s40, 12288
    s_add_u32 s40, s40, 4096
    v_add_u32 v202, s40, v2
    s_xor_b32 s40, s3, 3
    s_mul_i32 s40, s40, 12288
    s_add_u32 s40, s40, 8192
    v_add_u32 v203, s40, v2
    s_waitcnt vmcnt(4)
    v_mfma_f32_32x32x16_bf16 v[176:191], v[60:63], a[76:79], v[176:191]
    s_waitcnt vmcnt(2)
    v_mfma_f32_32x32x16_bf16 v[176:191], v[68:71], a[84:87], v[176:191]
    s_waitcnt vmcnt(0)
    v_mfma_f32_32x32x16_bf16 v[176:191], v[76:79], a[92:95], v[176:191]
    s_nop 4
    v_mfma_f32_32x32x16_bf16 v[160:175], v[56:59], a[76:79], v[160:175]
    v_mfma_f32_32x32x16_bf16 v[160:175], v[64:67], a[84:87], v[160:175]
    v_mfma_f32_32x32x16_bf16 v[160:175], v[72:75], a[92:95], v[160:175]
    s_nop 4
    v_mfma_f32_32x32x16_bf16 v[144:159], v[60:63], a[72:75], v[144:159]
    ds_write_b128 v203, v[176:179] offset:0
    ds_write_b128 v203, v[180:183] offset:1024
    v_mfma_f32_32x32x16_bf16 v[144:159], v[68:71], a[80:83], v[144:159]
    ds_write_b128 v203, v[184:187] offset:2048
    ds_write_b128 v203, v[188:191] offset:3072
    v_mfma_f32_32x32x16_bf16 v[144:159], v[76:79], a[88:91], v[144:159]
    ds_write_b128 v202, v[160:163] offset:0
    ds_write_b128 v202, v[164:167] offset:1024
    v_mfma_f32_32x32x16_bf16 v[128:143], v[56:59], a[72:75], v[128:143]
    ds_write_b128 v202, v[168:171] offset:2048
    ds_write_b128 v202, v[172:175] offset:3072
    v_mfma_f32_32x32x16_bf16 v[128:143], v[64:67], a[80:83], v[128:143]
    v_mfma_f32_32x32x16_bf16 v[128:143], v[72:75], a[88:91], v[128:143]
    s_nop 5
    ds_write_b128 v201, v[144:147] offset:0
    ds_write_b128 v201, v[148:151] offset:1024
    ds_write_b128 v201, v[152:155] offset:2048
    ds_write_b128 v201, v[156:159] offset:3072
    s_mul_i32 s40, s3, 12288
    s_add_u32 s40, s40, 0
    v_add_u32 v200, s40, v2
    s_waitcnt lgkmcnt(0)
    s_barrier
    ds_read_b128 v[16:19], v200 offset:0
    ds_read_b128 v[20:23], v200 offset:1024
    ds_read_b128 v[24:27], v200 offset:2048
    ds_read_b128 v[28:31], v200 offset:3072
    ds_read_b128 v[32:35], v200 offset:4096
    ds_read_b128 v[36:39], v200 offset:5120
    ds_read_b128 v[40:43], v200 offset:6144
    ds_read_b128 v[44:47], v200 offset:7168
    ds_read_b128 v[48:51], v200 offset:8192
    ds_read_b128 v[52:55], v200 offset:9216
    ds_read_b128 v[56:59], v200 offset:10240
    ds_read_b128 v[60:63], v200 offset:11264
    s_waitcnt lgkmcnt(8)
    v_pk_add_f32 v[128:129], v[128:129], v[16:17]
    v_pk_add_f32 v[130:131], v[130:131], v[18:19]
    v_pk_add_f32 v[132:133], v[132:133], v[20:21]
    v_pk_add_f32 v[134:135], v[134:135], v[22:23]
    v_pk_add_f32 v[136:137], v[136:137], v[24:25]
    v_pk_add_f32 v[138:139], v[138:139], v[26:27]
    v_pk_add_f32 v[140:141], v[140:141], v[28:29]
    v_pk_add_f32 v[142:143], v[142:143], v[30:31]
    s_waitcnt lgkmcnt(4)
    v_pk_add_f32 v[128:129], v[128:129], v[32:33]
    v_pk_add_f32 v[130:131], v[130:131], v[34:35]
    v_pk_add_f32 v[132:133], v[132:133], v[36:37]
    v_pk_add_f32 v[134:135], v[134:135], v[38:39]
    v_pk_add_f32 v[136:137], v[136:137], v[40:41]
    v_pk_add_f32 v[138:139], v[138:139], v[42:43]
    v_pk_add_f32 v[140:141], v[140:141], v[44:45]
    v_pk_add_f32 v[142:143], v[142:143], v[46:47]
    s_waitcnt lgkmcnt(0)
    v_pk_add_f32 v[128:129], v[128:129], v[48:49]
    v_pk_add_f32 v[130:131], v[130:131], v[50:51]
    v_pk_add_f32 v[132:133], v[132:133], v[52:53]
    v_pk_add_f32 v[134:135], v[134:135], v[54:55]
    v_pk_add_f32 v[136:137], v[136:137], v[56:57]
    v_pk_add_f32 v[138:139], v[138:139], v[58:59]
    v_pk_add_f32 v[140:141], v[140:141], v[60:61]
    v_pk_add_f32 v[142:143], v[142:143], v[62:63]
    s_add_u32 s40, s66, 20971520
    s_nop 0
    v_permlane32_swap_b32 v128, v132
    v_permlane32_swap_b32 v129, v133
    v_permlane32_swap_b32 v130, v134
    v_permlane32_swap_b32 v131, v135
    v_permlane32_swap_b32 v136, v140
    v_permlane32_swap_b32 v137, v141
    v_permlane32_swap_b32 v138, v142
    v_permlane32_swap_b32 v139, v143
    v_lshlrev_b32 v8, 16, v248
    v_and_b32 v9, 0xffff0000, v248
    v_pk_add_f32 v[128:129], v[128:129], v[8:9]
    v_cvt_pk_bf16_f32 v192, v128, v129
    v_lshlrev_b32 v8, 16, v249
    v_and_b32 v9, 0xffff0000, v249
    v_pk_add_f32 v[130:131], v[130:131], v[8:9]
    v_cvt_pk_bf16_f32 v193, v130, v131
    v_lshlrev_b32 v8, 16, v250
    v_and_b32 v9, 0xffff0000, v250
    v_pk_add_f32 v[132:133], v[132:133], v[8:9]
    v_cvt_pk_bf16_f32 v194, v132, v133
    v_lshlrev_b32 v8, 16, v251
    v_and_b32 v9, 0xffff0000, v251
    v_pk_add_f32 v[134:135], v[134:135], v[8:9]
    v_cvt_pk_bf16_f32 v195, v134, v135
    v_lshlrev_b32 v8, 16, v252
    v_and_b32 v9, 0xffff0000, v252
    v_pk_add_f32 v[136:137], v[136:137], v[8:9]
    v_cvt_pk_bf16_f32 v196, v136, v137
    v_lshlrev_b32 v8, 16, v253
    v_and_b32 v9, 0xffff0000, v253
    v_pk_add_f32 v[138:139], v[138:139], v[8:9]
    v_cvt_pk_bf16_f32 v197, v138, v139
    v_lshlrev_b32 v8, 16, v254
    v_and_b32 v9, 0xffff0000, v254
    v_pk_add_f32 v[140:141], v[140:141], v[8:9]
    v_cvt_pk_bf16_f32 v198, v140, v141
    v_lshlrev_b32 v8, 16, v255
    v_and_b32 v9, 0xffff0000, v255
    v_pk_add_f32 v[142:143], v[142:143], v[8:9]
    v_cvt_pk_bf16_f32 v199, v142, v143
    s_cmp_lg_u32 s30, 0
    s_cbranch_scc1 pk_kernel_last_69
    buffer_store_dwordx4 v[192:195], v2, s[24:27], s40 offen sc1
    buffer_store_dwordx4 v[196:199], v2, s[24:27], s40 offen offset:1024 sc1
    v_pk_mul_f32 v[82:83], v[128:129], v[128:129]
    v_pk_add_f32 v[80:81], v[128:129], v[130:131]
    v_pk_fma_f32 v[82:83], v[130:131], v[130:131], v[82:83]
    v_pk_fma_f32 v[82:83], v[132:133], v[132:133], v[82:83]
    v_pk_add_f32 v[80:81], v[80:81], v[132:133]
    v_pk_fma_f32 v[82:83], v[134:135], v[134:135], v[82:83]
    v_pk_add_f32 v[80:81], v[80:81], v[134:135]
    v_pk_fma_f32 v[82:83], v[136:137], v[136:137], v[82:83]
    v_pk_add_f32 v[80:81], v[80:81], v[136:137]
    v_pk_fma_f32 v[82:83], v[138:139], v[138:139], v[82:83]
    v_pk_add_f32 v[80:81], v[80:81], v[138:139]
    v_pk_fma_f32 v[82:83], v[140:141], v[140:141], v[82:83]
    v_pk_add_f32 v[80:81], v[80:81], v[140:141]
    v_pk_fma_f32 v[82:83], v[142:143], v[142:143], v[82:83]
    v_pk_add_f32 v[80:81], v[80:81], v[142:143]
    v_add_f32 v80, v80, v81
    v_add_f32 v81, v82, v83
    v_mov_b32 v82, v80
    v_mov_b32 v83, v81
    s_add_u32 s40, s82, s30
    s_add_u32 s40, s40, 40894464
    v_permlane32_swap_b32 v80, v82
    v_permlane32_swap_b32 v81, v83
    v_pk_add_f32 v[80:81], v[80:81], v[82:83]
    s_mov_b64 exec, 0xffffffff
    buffer_store_dwordx2 v[80:81], v15, s[24:27], s40 offen sc1
    s_mov_b64 exec, -1
    s_add_u32 s42, s32, 98304
    s_add_u32 s42, s42, s93
    s_cmp_lg_u32 s3, 0
    s_waitcnt vmcnt(0)
    s_barrier
    s_cbranch_scc1 pk_kernel_sg_70
    s_mov_b64 exec, 1
    buffer_atomic_add v5, v6, s[24:27], s42 offen sc1
    s_mov_b64 exec, -1
pk_kernel_sg_70:
    s_mov_b32 s30, 20971520
    s_mov_b32 s98, 4
    s_mov_b32 s99, 8
    s_mov_b32 s100, 16
    s_add_u32 m0, s33, 49152
    s_add_u32 s49, s80, 0
    buffer_load_dwordx4 v2, s[84:87], s49 offen offset:0 lds
    buffer_load_dwordx4 v2, s[84:87], s49 offen offset:1024 lds
    buffer_load_dwordx4 v2, s[84:87], s49 offen offset:2048 lds
    buffer_load_dwordx4 v2, s[84:87], s49 offen offset:3072 lds
    s_add_u32 m0, s33, 65536
    s_add_u32 s49, s80, 16384
    buffer_load_dwordx4 v2, s[84:87], s49 offen offset:0 lds
    buffer_load_dwordx4 v2, s[84:87], s49 offen offset:1024 lds
    buffer_load_dwordx4 v2, s[84:87], s49 offen offset:2048 lds
    buffer_load_dwordx4 v2, s[84:87], s49 offen offset:3072 lds
    s_add_u32 m0, s33, 81920
    s_add_u32 s49, s80, 32768
    buffer_load_dwordx4 v2, s[84:87], s49 offen offset:0 lds
    buffer_load_dwordx4 v2, s[84:87], s49 offen offset:1024 lds
    buffer_load_dwordx4 v2, s[84:87], s49 offen offset:2048 lds
    buffer_load_dwordx4 v2, s[84:87], s49 offen offset:3072 lds
    s_add_u32 m0, s33, 98304
    s_add_u32 s49, s80, 49152
    buffer_load_dwordx4 v2, s[84:87], s49 offen offset:0 lds
    buffer_load_dwordx4 v2, s[84:87], s49 offen offset:1024 lds
    buffer_load_dwordx4 v2, s[84:87], s49 offen offset:2048 lds
    buffer_load_dwordx4 v2, s[84:87], s49 offen offset:3072 lds
    s_add_u32 m0, s33, 114688
    s_add_u32 s49, s80, 65536
    buffer_load_dwordx4 v2, s[84:87], s49 offen offset:0 lds
    buffer_load_dwordx4 v2, s[84:87], s49 offen offset:1024 lds
    buffer_load_dwordx4 v2, s[84:87], s49 offen offset:2048 lds
    buffer_load_dwordx4 v2, s[84:87], s49 offen offset:3072 lds
    s_add_u32 m0, s33, 131072
    s_add_u32 s49, s80, 81920
    buffer_load_dwordx4 v2, s[84:87], s49 offen offset:0 lds
    buffer_load_dwordx4 v2, s[84:87], s49 offen offset:1024 lds
    buffer_load_dwordx4 v2, s[84:87], s49 offen offset:2048 lds
    buffer_load_dwordx4 v2, s[84:87], s49 offen offset:3072 lds
    s_add_u32 m0, s33, 147456
    s_add_u32 s49, s80, 98304
    buffer_load_dwordx4 v2, s[84:87], s49 offen offset:0 lds
    buffer_load_dwordx4 v2, s[84:87], s49 offen offset:1024 lds
    buffer_load_dwordx4 v2, s[84:87], s49 offen offset:2048 lds
    buffer_load_dwordx4 v2, s[84:87], s49 offen offset:3072 lds
    s_mov_b64 exec, 1
    s_add_u32 s42, s96, 50085888
    buffer_load_dword v11, v10, s[24:27], s42 offen sc1
    s_mov_b64 exec, -1
    s_waitcnt vmcnt(0)
    s_add_u32 s42, s100, -8
    v_cmp_gt_u32 vcc, s42, v11
    s_and_b32 vcc_lo, vcc_lo, 1
    s_cbranch_scc1 pk_kernel_sp_71
pk_kernel_pr_72:
    s_lshl_b32 s44, s43, 15
    s_add_u32 s44, s44, s30
    s_add_u32 s44, s44, 0
    buffer_load_dwordx4 a[0:3], v236, s[24:27], s44 offen offset:0 sc1
    buffer_load_dwordx4 a[4:7], v236, s[24:27], s44 offen offset:1024 sc1
    buffer_load_dwordx4 a[8:11], v236, s[24:27], s44 offen offset:2048 sc1
    buffer_load_dwordx4 a[12:15], v236, s[24:27], s44 offen offset:3072 sc1
    buffer_load_dwordx4 a[16:19], v237, s[24:27], s44 offen offset:0 sc1
    buffer_load_dwordx4 a[20:23], v237, s[24:27], s44 offen offset:1024 sc1
    s_lshl_b32 s40, s43, 8
    s_add_u32 s40, s40, s30
    s_add_u32 s40, s40, 19922944
    buffer_load_dwordx2 v[100:101], v15, s[24:27], s40 offen sc1
    s_add_u32 s40, s40, 16384
    buffer_load_dwordx2 v[102:103], v15, s[24:27], s40 offen sc1
    s_add_u32 s40, s40, 16384
    buffer_load_dwordx2 v[104:105], v15, s[24:27], s40 offen sc1
    s_add_u32 s40, s40, 16384
    buffer_load_dwordx2 v[106:107], v15, s[24:27], s40 offen sc1
    s_add_u32 s40, s40, 16384
    buffer_load_dwordx2 v[108:109], v15, s[24:27], s40 offen sc1
    s_add_u32 s40, s40, 16384
    buffer_load_dwordx2 v[110:111], v15, s[24:27], s40 offen sc1
    s_add_u32 s40, s40, 16384
    buffer_load_dwordx2 v[112:113], v15, s[24:27], s40 offen sc1
    s_add_u32 s40, s40, 16384
    buffer_load_dwordx2 v[114:115], v15, s[24:27], s40 offen sc1
    buffer_load_dwordx4 a[24:27], v237, s[24:27], s44 offen offset:2048 sc1
    buffer_load_dwordx4 a[28:31], v237, s[24:27], s44 offen offset:3072 sc1
    buffer_load_dwordx4 a[32:35], v238, s[24:27], s44 offen offset:0 sc1
    buffer_load_dwordx4 a[36:39], v238, s[24:27], s44 offen offset:1024 sc1
    v_add_u32 v144, 49152, v2
    v_add_u32 v146, 114688, v2
    s_barrier
    ds_read_b128 v[64:67], v144 offset:0
    ds_read_b128 v[68:71], v144 offset:1024
    ds_read_b128 v[72:75], v144 offset:2048
    ds_read_b128 v[76:79], v144 offset:3072
    ds_read_b128 v[80:83], v144 offset:4096
    ds_read_b128 v[84:87], v144 offset:5120
    ds_read_b128 v[88:91], v144 offset:6144
    s_waitcnt vmcnt(17) lgkmcnt(6)
    v_mfma_f32_32x32x16_bf16 v[16:31], v[64:67], a[0:3], 0
    ds_read_b128 v[92:95], v144 offset:7168
    buffer_load_dwordx4 a[40:43], v238, s[24:27], s44 offen offset:2048 sc1
    s_waitcnt lgkmcnt(6)
    v_mfma_f32_32x32x16_bf16 v[32:47], v[68:71], a[0:3], 0
    ds_read_b128 v[64:67], v144 offset:8192
    s_waitcnt vmcnt(17) lgkmcnt(6)
    v_mfma_f32_32x32x16_bf16 v[16:31], v[72:75], a[4:7], v[16:31]
    ds_read_b128 v[68:71], v144 offset:9216
    buffer_load_dwordx4 a[44:47], v238, s[24:27], s44 offen offset:3072 sc1
    s_waitcnt lgkmcnt(6)
    v_mfma_f32_32x32x16_bf16 v[32:47], v[76:79], a[4:7], v[32:47]
    ds_read_b128 v[72:75], v144 offset:10240
    s_waitcnt vmcnt(17) lgkmcnt(6)
    v_mfma_f32_32x32x16_bf16 v[16:31], v[80:83], a[8:11], v[16:31]
    ds_read_b128 v[76:79], v144 offset:11264
    buffer_load_dwordx4 a[48:51], v239, s[24:27], s44 offen offset:0 sc1
    s_waitcnt lgkmcnt(6)
    v_mfma_f32_32x32x16_bf16 v[32:47], v[84:87], a[8:11], v[32:47]
    ds_read_b128 v[80:83], v144 offset:12288
    s_waitcnt vmcnt(17) lgkmcnt(6)
    v_mfma_f32_32x32x16_bf16 v[16:31], v[88:91], a[12:15], v[16:31]
    ds_read_b128 v[84:87], v144 offset:13312
    buffer_load_dwordx4 a[52:55], v239, s[24:27], s44 offen offset:1024 sc1
    s_waitcnt lgkmcnt(6)
    v_mfma_f32_32x32x16_bf16 v[32:47], v[92:95], a[12:15], v[32:47]
    ds_read_b128 v[88:91], v144 offset:14336
    s_waitcnt vmcnt(17) lgkmcnt(6)
    v_mfma_f32_32x32x16_bf16 v[16:31], v[64:67], a[16:19], v[16:31]
    ds_read_b128 v[92:95], v144 offset:15360
    buffer_load_dwordx4 a[56:59], v239, s[24:27], s44 offen offset:2048 sc1
    s_waitcnt lgkmcnt(6)
    v_mfma_f32_32x32x16_bf16 v[32:47], v[68:71], a[16:19], v[32:47]
    ds_read_b128 v[64:67], v144 offset:16384
    s_waitcnt vmcnt(17) lgkmcnt(6)
    v_mfma_f32_32x32x16_bf16 v[16:31], v[72:75], a[20:23], v[16:31]
    ds_read_b128 v[68:71], v144 offset:17408
    buffer_load_dwordx4 a[60:63], v239, s[24:27], s44 offen offset:3072 sc1
    s_waitcnt lgkmcnt(6)
    v_mfma_f32_32x32x16_bf16 v[32:47], v[76:79], a[20:23], v[32:47]
    ds_read_b128 v[72:75], v144 offset:18432
    s_waitcnt vmcnt(9) lgkmcnt(6)
    v_mfma_f32_32x32x16_bf16 v[16:31], v[80:83], a[24:27], v[16:31]
    ds_read_b128 v[76:79], v144 offset:19456
    buffer_load_dwordx4 a[64:67], v240, s[24:27], s44 offen offset:0 sc1
    s_waitcnt lgkmcnt(6)
    v_mfma_f32_32x32x16_bf16 v[32:47], v[84:87], a[24:27], v[32:47]
    ds_read_b128 v[80:83], v144 offset:20480
    s_waitcnt vmcnt(9) lgkmcnt(6)
    v_mfma_f32_32x32x16_bf16 v[16:31], v[88:91], a[28:31], v[16:31]
    ds_read_b128 v[84:87], v144 offset:21504
    buffer_load_dwordx4 a[68:71], v240, s[24:27], s44 offen offset:1024 sc1
    s_waitcnt lgkmcnt(6)
    v_mfma_f32_32x32x16_bf16 v[32:47], v[92:95], a[28:31], v[32:47]
    ds_read_b128 v[88:91], v144 offset:22528
    s_waitcnt vmcnt(9) lgkmcnt(6)
    v_mfma_f32_32x32x16_bf16 v[16:31], v[64:67], a[32:35], v[16:31]
    ds_read_b128 v[92:95], v144 offset:23552
    buffer_load_dwordx4 a[72:75], v240, s[24:27], s44 offen offset:2048 sc1
    s_waitcnt lgkmcnt(6)
    v_mfma_f32_32x32x16_bf16 v[32:47], v[68:71], a[32:35], v[32:47]
    ds_read_b128 v[64:67], v144 offset:24576
    s_waitcnt vmcnt(9) lgkmcnt(6)
    v_mfma_f32_32x32x16_bf16 v[16:31], v[72:75], a[36:39], v[16:31]
    ds_read_b128 v[68:71], v144 offset:25600
    buffer_load_dwordx4 a[76:79], v240, s[24:27], s44 offen offset:3072 sc1
    s_waitcnt lgkmcnt(6)
    v_mfma_f32_32x32x16_bf16 v[32:47], v[76:79], a[36:39], v[32:47]
    ds_read_b128 v[72:75], v144 offset:26624
    s_waitcnt vmcnt(9) lgkmcnt(6)
    v_mfma_f32_32x32x16_bf16 v[16:31], v[80:83], a[40:43], v[16:31]
    ds_read_b128 v[76:79], v144 offset:27648
    buffer_load_dwordx4 a[80:83], v241, s[24:27], s44 offen offset:0 sc1
    s_waitcnt lgkmcnt(6)
    v_mfma_f32_32x32x16_bf16 v[32:47], v[84:87], a[40:43], v[32:47]
    ds_read_b128 v[80:83], v144 offset:28672
    s_waitcnt vmcnt(9) lgkmcnt(6)
    v_mfma_f32_32x32x16_bf16 v[16:31], v[88:91], a[44:47], v[16:31]
    ds_read_b128 v[84:87], v144 offset:29696
    buffer_load_dwordx4 a[84:87], v241, s[24:27], s44 offen offset:1024 sc1
    s_waitcnt lgkmcnt(6)
    v_mfma_f32_32x32x16_bf16 v[32:47], v[92:95], a[44:47], v[32:47]
    ds_read_b128 v[88:91], v144 offset:30720
    s_waitcnt vmcnt(9) lgkmcnt(6)
    v_mfma_f32_32x32x16_bf16 v[16:31], v[64:67], a[48:51], v[16:31]
    ds_read_b128 v[92:95], v144 offset:31744
    buffer_load_dwordx4 a[88:91], v241, s[24:27], s44 offen offset:2048 sc1
    v_add_f32 v100, v100, v102
    s_waitcnt lgkmcnt(6)
    v_mfma_f32_32x32x16_bf16 v[32:47], v[68:71], a[48:51], v[32:47]
    ds_read_b128 v[64:67], v144 offset:32768
    v_add_f32 v101, v101, v103
    v_add_f32 v100, v100, v104
    s_waitcnt vmcnt(9) lgkmcnt(6)
    v_mfma_f32_32x32x16_bf16 v[16:31], v[72:75], a[52:55], v[16:31]
    ds_read_b128 v[68:71], v144 offset:33792
    buffer_load_dwordx4 a[92:95], v241, s[24:27], s44 offen offset:3072 sc1
    v_add_f32 v101, v101, v105
    v_add_f32 v100, v100, v106
    s_waitcnt lgkmcnt(6)
    v_mfma_f32_32x32x16_bf16 v[32:47], v[76:79], a[52:55], v[32:47]
    ds_read_b128 v[72:75], v144 offset:34816
    v_add_f32 v101, v101, v107
    v_add_f32 v100, v100, v108
    s_waitcnt vmcnt(9) lgkmcnt(6)
    v_mfma_f32_32x32x16_bf16 v[16:31], v[80:83], a[56:59], v[16:31]
    ds_read_b128 v[76:79], v144 offset:35840
    buffer_load_dwordx4 a[96:99], v242, s[24:27], s44 offen offset:0 sc1
    v_add_f32 v101, v101, v109
    v_add_f32 v100, v100, v110
    s_waitcnt lgkmcnt(6)
    v_mfma_f32_32x32x16_bf16 v[32:47], v[84:87], a[56:59], v[32:47]
    ds_read_b128 v[80:83], v144 offset:36864
    v_add_f32 v101, v101, v111
    v_add_f32 v100, v100, v112
    s_waitcnt vmcnt(9) lgkmcnt(6)
    v_mfma_f32_32x32x16_bf16 v[16:31], v[88:91], a[60:63], v[16:31]
    ds_read_b128 v[84:87], v144 offset:37888
    buffer_load_dwordx4 a[100:103], v242, s[24:27], s44 offen offset:1024 sc1
    v_add_f32 v101, v101, v113
    v_add_f32 v100, v100, v114
    s_waitcnt lgkmcnt(6)
    v_mfma_f32_32x32x16_bf16 v[32:47], v[92:95], a[60:63], v[32:47]
    ds_read_b128 v[88:91], v144 offset:38912
    v_add_f32 v101, v101, v115
    v_mov_b32 v102, v100
    s_waitcnt vmcnt(9) lgkmcnt(6)
    v_mfma_f32_32x32x16_bf16 v[16:31], v[64:67], a[64:67], v[16:31]
    ds_read_b128 v[92:95], v144 offset:39936
    buffer_load_dwordx4 a[104:107], v242, s[24:27], s44 offen offset:2048 sc1
    v_mov_b32 v103, v101
    s_nop 1
    s_waitcnt lgkmcnt(6)
    v_mfma_f32_32x32x16_bf16 v[32:47], v[68:71], a[64:67], v[32:47]
    ds_read_b128 v[64:67], v144 offset:40960
    v_permlane32_swap_b32 v100, v102
    v_permlane32_swap_b32 v101, v103
    s_waitcnt vmcnt(9) lgkmcnt(6)
    v_mfma_f32_32x32x16_bf16 v[16:31], v[72:75], a[68:71], v[16:31]
    ds_read_b128 v[68:71], v144 offset:41984
    buffer_load_dwordx4 a[108:111], v242, s[24:27], s44 offen offset:3072 sc1
    v_add_f32 v100, v100, v102
    v_add_f32 v101, v101, v103
    s_waitcnt lgkmcnt(6)
    v_mfma_f32_32x32x16_bf16 v[32:47], v[76:79], a[68:71], v[32:47]
    ds_read_b128 v[72:75], v144 offset:43008
    v_mul_f32 v100, -0.001953125, v100
    v_mul_f32 v101, 0.001953125, v101
    s_waitcnt vmcnt(9) lgkmcnt(6)
    v_mfma_f32_32x32x16_bf16 v[16:31], v[80:83], a[72:75], v[16:31]
    ds_read_b128 v[76:79], v144 offset:44032
    buffer_load_dwordx4 a[112:115], v243, s[24:27], s44 offen offset:0 sc1
    v_fma_f32 v101, -v100, v100, v101
    v_max_f32 v101, 0, v101
    s_waitcnt lgkmcnt(6)
    v_mfma_f32_32x32x16_bf16 v[32:47], v[84:87], a[72:75], v[32:47]
    ds_read_b128 v[80:83], v144 offset:45056
    v_cvt_pk_bf16_f32 v102, v101, v101
    v_lshlrev_b32 v101, 16, v102
    s_waitcnt vmcnt(9) lgkmcnt(6)
    v_mfma_f32_32x32x16_bf16 v[16:31], v[88:91], a[76:79], v[16:31]
    ds_read_b128 v[84:87], v144 offset:46080
    buffer_load_dwordx4 a[116:119], v243, s[24:27], s44 offen offset:1024 sc1
    v_add_f32 v101, 1e-5, v101
    v_cvt_pk_bf16_f32 v102, v101, v101
    s_waitcnt lgkmcnt(6)
    v_mfma_f32_32x32x16_bf16 v[32:47], v[92:95], a[76:79], v[32:47]
    ds_read_b128 v[88:91], v144 offset:47104
    v_lshlrev_b32 v101, 16, v102
    v_sqrt_f32 v101, v101
    s_waitcnt vmcnt(9) lgkmcnt(6)
    v_mfma_f32_32x32x16_bf16 v[16:31], v[64:67], a[80:83], v[16:31]
    ds_read_b128 v[92:95], v144 offset:48128
    buffer_load_dwordx4 a[120:123], v243, s[24:27], s44 offen offset:2048 sc1
    v_cmp_eq_u32 vcc, 0, v4
    v_cvt_pk_bf16_f32 v102, v101, v101
    s_waitcnt lgkmcnt(6)
    v_mfma_f32_32x32x16_bf16 v[32:47], v[68:71], a[80:83], v[32:47]
    ds_read_b128 v[64:67], v144 offset:49152
    v_lshlrev_b32 v101, 16, v102
    v_rcp_f32 v12, v101
    s_waitcnt vmcnt(9) lgkmcnt(6)
    v_mfma_f32_32x32x16_bf16 v[16:31], v[72:75], a[84:87], v[16:31]
    ds_read_b128 v[68:71], v144 offset:50176
    buffer_load_dwordx4 a[124:127], v243, s[24:27], s44 offen offset:3072 sc1
    buffer_load_dwordx4 a[128:131], v236, s[24:27], s81 offen offset:0
    v_cvt_pk_bf16_f32 v102, v100, v100
    v_and_b32 v103, 0xffff, v102
    s_waitcnt lgkmcnt(6)
    v_mfma_f32_32x32x16_bf16 v[32:47], v[76:79], a[84:87], v[32:47]
    ds_read_b128 v[72:75], v144 offset:51200
    v_mov_b32 v118, 0
    v_cndmask_b32 v116, 0, v102, vcc
    s_waitcnt vmcnt(10) lgkmcnt(6)
    v_mfma_f32_32x32x16_bf16 v[16:31], v[80:83], a[88:91], v[16:31]
    ds_read_b128 v[76:79], v144 offset:52224
    buffer_load_dwordx4 a[132:135], v236, s[24:27], s81 offen offset:1024
    v_cndmask_b32 v117, 0, v103, vcc
    v_mov_b32 v119, 0
    s_waitcnt lgkmcnt(6)
    v_mfma_f32_32x32x16_bf16 v[32:47], v[84:87], a[88:91], v[32:47]
    ds_read_b128 v[80:83], v144 offset:53248
    s_lshl_b32 s40, s3, 7
    s_add_u32 s40, s40, 0
    s_waitcnt vmcnt(10) lgkmcnt(6)
    v_mfma_f32_32x32x16_bf16 v[16:31], v[88:91], a[92:95], v[16:31]
    ds_read_b128 v[84:87], v144 offset:54272
    buffer_load_dwordx4 a[136:139], v236, s[24:27], s81 offen offset:2048
    v_lshl_add_u32 v7, v3, 2, s40
    ds_write_b32 v7, v12
    s_waitcnt lgkmcnt(7)
    v_mfma_f32_32x32x16_bf16 v[32:47], v[92:95], a[92:95], v[32:47]
    ds_read_b128 v[88:91], v144 offset:55296
    v_lshl_add_u32 v7, v4, 4, s40
    ds_read_b128 v[120:123], v7 offset:0
    s_waitcnt vmcnt(10) lgkmcnt(8)
    v_mfma_f32_32x32x16_bf16 v[16:31], v[64:67], a[96:99], v[16:31]
    ds_read_b128 v[92:95], v144 offset:56320
    buffer_load_dwordx4 a[140:143], v236, s[24:27], s81 offen offset:3072
    ds_read_b128 v[124:127], v7 offset:32
    ds_read_b128 v[128:131], v7 offset:64
    s_waitcnt lgkmcnt(10)
    v_mfma_f32_32x32x16_bf16 v[32:47], v[68:71], a[96:99], v[32:47]
    ds_read_b128 v[64:67], v144 offset:57344
    ds_read_b128 v[132:135], v7 offset:96
    v_mul_f32 v13, 0.36067376022224085, v12
    s_waitcnt vmcnt(10) lgkmcnt(11)
    v_mfma_f32_32x32x16_bf16 v[16:31], v[72:75], a[100:103], v[16:31]
    ds_read_b128 v[68:71], v144 offset:58368
    buffer_load_dwordx4 a[144:147], v237, s[24:27], s81 offen offset:0
    s_waitcnt lgkmcnt(11)
    v_mfma_f32_32x32x16_bf16 v[32:47], v[76:79], a[100:103], v[32:47]
    ds_read_b128 v[72:75], v144 offset:59392
    s_waitcnt vmcnt(10) lgkmcnt(11)
    v_mfma_f32_32x32x16_bf16 v[16:31], v[80:83], a[104:107], v[16:31]
    ds_read_b128 v[76:79], v144 offset:60416
    buffer_load_dwordx4 a[148:151], v237, s[24:27], s81 offen offset:1024
    s_waitcnt lgkmcnt(11)
    v_mfma_f32_32x32x16_bf16 v[32:47], v[84:87], a[104:107], v[32:47]
    ds_read_b128 v[80:83], v144 offset:61440
    s_waitcnt vmcnt(10) lgkmcnt(10)
    v_mfma_f32_32x32x16_bf16 v[16:31], v[88:91], a[108:111], v[16:31]
    ds_read_b128 v[84:87], v144 offset:62464
    buffer_load_dwordx4 a[152:155], v237, s[24:27], s81 offen offset:2048
    s_waitcnt lgkmcnt(9)
    v_mfma_f32_32x32x16_bf16 v[32:47], v[92:95], a[108:111], v[32:47]
    ds_read_b128 v[88:91], v144 offset:63488
    s_waitcnt vmcnt(10) lgkmcnt(7)
    v_mfma_f32_32x32x16_bf16 v[16:31], v[64:67], a[112:115], v[16:31]
    ds_read_b128 v[92:95], v144 offset:64512
    buffer_load_dwordx4 a[156:159], v237, s[24:27], s81 offen offset:3072
    s_waitcnt lgkmcnt(6)
    v_mfma_f32_32x32x16_bf16 v[32:47], v[68:71], a[112:115], v[32:47]
    ds_read_b128 v[64:67], v146 offset:0
    s_waitcnt vmcnt(10) lgkmcnt(6)
    v_mfma_f32_32x32x16_bf16 v[16:31], v[72:75], a[116:119], v[16:31]
    ds_read_b128 v[68:71], v146 offset:1024
    buffer_load_dwordx4 a[160:163], v238, s[24:27], s81 offen offset:0
    s_waitcnt lgkmcnt(6)
    v_mfma_f32_32x32x16_bf16 v[32:47], v[76:79], a[116:119], v[32:47]
    ds_read_b128 v[72:75], v146 offset:2048
    s_waitcnt vmcnt(10) lgkmcnt(6)
    v_mfma_f32_32x32x16_bf16 v[16:31], v[80:83], a[120:123], v[16:31]
    ds_read_b128 v[76:79], v146 offset:3072
    buffer_load_dwordx4 a[164:167], v238, s[24:27], s81 offen offset:1024
    s_waitcnt lgkmcnt(6)
    v_mfma_f32_32x32x16_bf16 v[32:47], v[84:87], a[120:123], v[32:47]
    ds_read_b128 v[80:83], v146 offset:4096
    s_waitcnt vmcnt(10) lgkmcnt(6)
    v_mfma_f32_32x32x16_bf16 v[16:31], v[88:91], a[124:127], v[16:31]
    ds_read_b128 v[84:87], v146 offset:5120
    buffer_load_dwordx4 a[168:171], v238, s[24:27], s81 offen offset:2048
    s_waitcnt lgkmcnt(6)
    v_mfma_f32_32x32x16_bf16 v[32:47], v[92:95], a[124:127], v[32:47]
    ds_read_b128 v[88:91], v146 offset:6144
    s_nop 1
    s_waitcnt lgkmcnt(6)
    v_mfma_f32_32x32x16_bf16 v[16:31], v[64:67], v[116:119], v[16:31]
    ds_read_b128 v[92:95], v146 offset:7168
    buffer_load_dwordx4 a[172:175], v238, s[24:27], s81 offen offset:3072
    s_waitcnt lgkmcnt(6)
    v_mfma_f32_32x32x16_bf16 v[32:47], v[68:71], v[116:119], v[32:47]
    ds_read_b128 v[64:67], v146 offset:8192
    s_waitcnt lgkmcnt(6)
    v_mfma_f32_32x32x16_bf16 v[48:63], a[0:3], v[72:75], 0
    ds_read_b128 v[68:71], v146 offset:9216
    buffer_load_dwordx4 a[176:179], v239, s[24:27], s81 offen offset:0
    s_waitcnt lgkmcnt(6)
    v_mfma_f32_32x32x16_bf16 v[48:63], a[4:7], v[76:79], v[48:63]
    ds_read_b128 v[72:75], v146 offset:10240
    s_waitcnt lgkmcnt(6)
    v_mfma_f32_32x32x16_bf16 v[48:63], a[8:11], v[80:83], v[48:63]
    ds_read_b128 v[76:79], v146 offset:11264
    buffer_load_dwordx4 a[180:183], v239, s[24:27], s81 offen offset:1024
    s_waitcnt lgkmcnt(6)
    v_mfma_f32_32x32x16_bf16 v[48:63], a[12:15], v[84:87], v[48:63]
    ds_read_b128 v[80:83], v146 offset:12288
    s_lshl_b32 s40, s29, 17
    s_lshl_b32 s41, s43, 10
    s_add_u32 s44, s40, s41
    s_add_u32 s44, s44, s30
    v_mul_f32 v16, v13, v16
    v_mul_f32 v17, v13, v17
    s_waitcnt lgkmcnt(6)
    v_mfma_f32_32x32x16_bf16 v[48:63], a[16:19], v[88:91], v[48:63]
    ds_read_b128 v[84:87], v146 offset:13312
    buffer_load_dwordx4 a[184:187], v239, s[24:27], s81 offen offset:2048
    v_mul_f32 v18, v13, v18
    v_mul_f32 v19, v13, v19
    v_mul_f32 v20, v13, v20
    v_mul_f32 v21, v13, v21
    v_mul_f32 v22, v13, v22
    v_mul_f32 v23, v13, v23
    s_waitcnt lgkmcnt(6)
    v_mfma_f32_32x32x16_bf16 v[48:63], a[20:23], v[92:95], v[48:63]
    ds_read_b128 v[88:91], v146 offset:14336
    v_mul_f32 v24, v13, v24
    v_mul_f32 v25, v13, v25
    v_mul_f32 v26, v13, v26
    v_mul_f32 v27, v13, v27
    v_mul_f32 v28, v13, v28
    v_mul_f32 v29, v13, v29
    s_waitcnt lgkmcnt(6)
    v_mfma_f32_32x32x16_bf16 v[48:63], a[24:27], v[64:67], v[48:63]
    ds_read_b128 v[92:95], v146 offset:15360
    buffer_load_dwordx4 a[188:191], v239, s[24:27], s81 offen offset:3072
    v_mul_f32 v30, v13, v30
    v_mul_f32 v31, v13, v31
    v_cvt_pk_bf16_f32 v136, v16, v17
    v_cvt_pk_bf16_f32 v137, v18, v19
    v_cvt_pk_bf16_f32 v138, v20, v21
    v_cvt_pk_bf16_f32 v139, v22, v23
    s_waitcnt lgkmcnt(6)
    v_mfma_f32_32x32x16_bf16 v[48:63], a[28:31], v[68:71], v[48:63]
    ds_read_b128 v[64:67], v146 offset:16384
    v_cvt_pk_bf16_f32 v140, v24, v25
    v_cvt_pk_bf16_f32 v141, v26, v27
    v_cvt_pk_bf16_f32 v142, v28, v29
    v_cvt_pk_bf16_f32 v143, v30, v31
    s_add_u32 s40, s44, 2097152
    s_add_u32 s41, s40, 65536
    s_waitcnt lgkmcnt(6)
    v_mfma_f32_32x32x16_bf16 v[48:63], a[32:35], v[72:75], v[48:63]
    ds_read_b128 v[68:71], v146 offset:17408
    v_permlane32_swap_b32 v136, v138
    v_permlane32_swap_b32 v137, v139
    v_permlane32_swap_b32 v140, v142
    v_permlane32_swap_b32 v141, v143
    buffer_store_dwordx4 v[136:139], v2, s[24:27], s40 offen sc1
    buffer_store_dwordx4 v[140:143], v2, s[24:27], s41 offen sc1
    s_waitcnt lgkmcnt(6)
    v_mfma_f32_32x32x16_bf16 v[48:63], a[36:39], v[76:79], v[48:63]
    ds_read_b128 v[72:75], v146 offset:18432
    v_mul_f32 v32, v12, v32
    v_mul_f32 v33, v12, v33
    v_mul_f32 v34, v12, v34
    v_mul_f32 v35, v12, v35
    v_mul_f32 v36, v12, v36
    v_mul_f32 v37, v12, v37
    s_waitcnt lgkmcnt(6)
    v_mfma_f32_32x32x16_bf16 v[48:63], a[40:43], v[80:83], v[48:63]
    ds_read_b128 v[76:79], v146 offset:19456
    v_mul_f32 v38, v12, v38
    v_mul_f32 v39, v12, v39
    v_mul_f32 v40, v12, v40
    v_mul_f32 v41, v12, v41
    v_mul_f32 v42, v12, v42
    v_mul_f32 v43, v12, v43
    s_waitcnt lgkmcnt(6)
    v_mfma_f32_32x32x16_bf16 v[48:63], a[44:47], v[84:87], v[48:63]
    ds_read_b128 v[80:83], v146 offset:20480
    v_mul_f32 v44, v12, v44
    v_mul_f32 v45, v12, v45
    v_mul_f32 v46, v12, v46
    v_mul_f32 v47, v12, v47
    v_cvt_pk_bf16_f32 v100, v32, v33
    v_cvt_pk_bf16_f32 v101, v34, v35
    s_waitcnt lgkmcnt(6)
    v_mfma_f32_32x32x16_bf16 v[48:63], a[48:51], v[88:91], v[48:63]
    ds_read_b128 v[84:87], v146 offset:21504
    v_cvt_pk_bf16_f32 v102, v36, v37
    v_cvt_pk_bf16_f32 v103, v38, v39
    v_cvt_pk_bf16_f32 v104, v40, v41
    v_cvt_pk_bf16_f32 v105, v42, v43
    v_cvt_pk_bf16_f32 v106, v44, v45
    v_cvt_pk_bf16_f32 v107, v46, v47
    s_waitcnt lgkmcnt(6)
    v_mfma_f32_32x32x16_bf16 v[48:63], a[52:55], v[92:95], v[48:63]
    ds_read_b128 v[88:91], v146 offset:22528
    s_add_u32 s40, s44, 4194304
    s_add_u32 s41, s40, 65536
    v_permlane32_swap_b32 v100, v102
    v_permlane32_swap_b32 v101, v103
    v_permlane32_swap_b32 v104, v106
    v_permlane32_swap_b32 v105, v107
    s_waitcnt lgkmcnt(6)
    v_mfma_f32_32x32x16_bf16 v[48:63], a[56:59], v[64:67], v[48:63]
    ds_read_b128 v[92:95], v146 offset:23552
    buffer_store_dwordx4 v[100:103], v2, s[24:27], s40 offen sc1
    buffer_store_dwordx4 v[104:107], v2, s[24:27], s41 offen sc1
    v_lshrrev_b32 v145, 4, v3
    v_lshlrev_b32 v145, 16, v145
    v_lshl_add_u32 v145, v4, 8, v145
    v_and_b32 v8, 15, v3
    s_waitcnt lgkmcnt(6)
    v_mfma_f32_32x32x16_bf16 v[48:63], a[60:63], v[68:71], v[48:63]
    ds_read_b128 v[64:67], v146 offset:24576
    v_lshl_add_u32 v145, v8, 4, v145
    s_add_u32 s40, s44, 6291456
    s_waitcnt lgkmcnt(6)
    v_mfma_f32_32x32x16_bf16 v[48:63], a[64:67], v[72:75], v[48:63]
    ds_read_b128 v[68:71], v146 offset:25600
    s_waitcnt lgkmcnt(6)
    v_mfma_f32_32x32x16_bf16 v[48:63], a[68:71], v[76:79], v[48:63]
    ds_read_b128 v[72:75], v146 offset:26624
    s_waitcnt lgkmcnt(6)
    v_mfma_f32_32x32x16_bf16 v[48:63], a[72:75], v[80:83], v[48:63]
    ds_read_b128 v[76:79], v146 offset:27648
    s_waitcnt lgkmcnt(6)
    v_mfma_f32_32x32x16_bf16 v[48:63], a[76:79], v[84:87], v[48:63]
    ds_read_b128 v[80:83], v146 offset:28672
    s_waitcnt lgkmcnt(6)
    v_mfma_f32_32x32x16_bf16 v[48:63], a[80:83], v[88:91], v[48:63]
    ds_read_b128 v[84:87], v146 offset:29696
    s_waitcnt lgkmcnt(6)
    v_mfma_f32_32x32x16_bf16 v[48:63], a[84:87], v[92:95], v[48:63]
    ds_read_b128 v[88:91], v146 offset:30720
    s_waitcnt lgkmcnt(6)
    v_mfma_f32_32x32x16_bf16 v[48:63], a[88:91], v[64:67], v[48:63]
    ds_read_b128 v[92:95], v146 offset:31744
    s_waitcnt lgkmcnt(6)
    v_mfma_f32_32x32x16_bf16 v[48:63], a[92:95], v[68:71], v[48:63]
    ds_read_b128 v[64:67], v146 offset:32768
    s_waitcnt lgkmcnt(6)
    v_mfma_f32_32x32x16_bf16 v[48:63], a[96:99], v[72:75], v[48:63]
    ds_read_b128 v[68:71], v146 offset:33792
    s_waitcnt lgkmcnt(6)
    v_mfma_f32_32x32x16_bf16 v[48:63], a[100:103], v[76:79], v[48:63]
    ds_read_b128 v[72:75], v146 offset:34816
    s_waitcnt lgkmcnt(6)
    v_mfma_f32_32x32x16_bf16 v[48:63], a[104:107], v[80:83], v[48:63]
    s_waitcnt lgkmcnt(5)
    v_mfma_f32_32x32x16_bf16 v[48:63], a[108:111], v[84:87], v[48:63]
    s_waitcnt lgkmcnt(4)
    v_mfma_f32_32x32x16_bf16 v[48:63], a[112:115], v[88:91], v[48:63]
    s_waitcnt lgkmcnt(3)
    v_mfma_f32_32x32x16_bf16 v[48:63], a[116:119], v[92:95], v[48:63]
    s_add_u32 s42, s32, 0
    s_add_u32 s42, s42, s92
    s_cmp_lg_u32 s3, 0
    s_waitcnt vmcnt(0)
    s_barrier
    s_cbranch_scc1 pk_kernel_sg_75
    s_mov_b64 exec, 1
    buffer_atomic_add v5, v6, s[24:27], s42 offen sc1
    s_mov_b64 exec, -1
pk_kernel_sg_75:
    s_waitcnt lgkmcnt(2)
    v_mfma_f32_32x32x16_bf16 v[48:63], a[120:123], v[64:67], v[48:63]
    s_waitcnt lgkmcnt(1)
    v_mfma_f32_32x32x16_bf16 v[48:63], a[124:127], v[68:71], v[48:63]
    s_waitcnt lgkmcnt(0)
    v_mfma_f32_32x32x16_bf16 v[48:63], v[116:119], v[72:75], v[48:63]
    s_nop 7
    s_nop 3
    v_mul_f32 v48, v120, v48
    v_mul_f32 v49, v121, v49
    v_mul_f32 v50, v122, v50
    v_mul_f32 v51, v123, v51
    v_mul_f32 v52, v124, v52
    v_mul_f32 v53, v125, v53
    v_mul_f32 v54, v126, v54
    v_mul_f32 v55, v127, v55
    v_mul_f32 v56, v128, v56
    v_mul_f32 v57, v129, v57
    v_mul_f32 v58, v130, v58
    v_mul_f32 v59, v131, v59
    v_mul_f32 v60, v132, v60
    v_mul_f32 v61, v133, v61
    v_mul_f32 v62, v134, v62
    v_mul_f32 v63, v135, v63
    v_cvt_pk_bf16_f32 v64, v48, v49
    v_cvt_pk_bf16_f32 v65, v50, v51
    v_cvt_pk_bf16_f32 v66, v52, v53
    v_cvt_pk_bf16_f32 v67, v54, v55
    v_cvt_pk_bf16_f32 v68, v56, v57
    v_cvt_pk_bf16_f32 v69, v58, v59
    v_cvt_pk_bf16_f32 v70, v60, v61
    v_cvt_pk_bf16_f32 v71, v62, v63
    buffer_store_dwordx4 v[64:67], v145, s[24:27], s40 offen sc1
    buffer_store_dwordx4 v[68:71], v145, s[24:27], s40 offen offset:512 sc1
    v_lshlrev_b32 v7, 2, v4
    v_sub_u32 v8, v3, v7
    v_mov_b32 v234, 0xf149f2ca
    v_cmp_le_i32 s[74:75], 0, v8
    v_cmp_le_i32 s[76:77], 1, v8
    v_cmp_le_i32 s[78:79], 2, v8
    s_nop 1
    v_cndmask_b32 v32, v234, 0, s[74:75]
    v_cndmask_b32 v16, 0, v234, s[74:75]
    v_cndmask_b32 v33, v234, 0, s[76:77]
    v_cndmask_b32 v17, 0, v234, s[76:77]
    v_cndmask_b32 v34, v234, 0, s[78:79]
    v_cndmask_b32 v18, 0, v234, s[78:79]
    v_cmp_le_i32 s[74:75], 3, v8
    v_cmp_le_i32 s[76:77], 8, v8
    v_cmp_le_i32 s[78:79], 9, v8
    s_nop 1
    v_cndmask_b32 v35, v234, 0, s[74:75]
    v_cndmask_b32 v19, 0, v234, s[74:75]
    v_cndmask_b32 v36, v234, 0, s[76:77]
    v_cndmask_b32 v20, 0, v234, s[76:77]
    v_cndmask_b32 v37, v234, 0, s[78:79]
    v_cndmask_b32 v21, 0, v234, s[78:79]
    v_cmp_le_i32 s[74:75], 10, v8
    v_cmp_le_i32 s[76:77], 11, v8
    v_cmp_le_i32 s[78:79], 16, v8
    s_nop 1
    v_cndmask_b32 v38, v234, 0, s[74:75]
    v_cndmask_b32 v22, 0, v234, s[74:75]
    v_cndmask_b32 v39, v234, 0, s[76:77]
    v_cndmask_b32 v23, 0, v234, s[76:77]
    v_cndmask_b32 v40, v234, 0, s[78:79]
    v_cndmask_b32 v24, 0, v234, s[78:79]
    v_cmp_le_i32 s[74:75], 17, v8
    v_cmp_le_i32 s[76:77], 18, v8
    v_cmp_le_i32 s[78:79], 19, v8
    s_nop 1
    v_cndmask_b32 v41, v234, 0, s[74:75]
    v_cndmask_b32 v25, 0, v234, s[74:75]
    v_cndmask_b32 v42, v234, 0, s[76:77]
    v_cndmask_b32 v26, 0, v234, s[76:77]
    v_cndmask_b32 v43, v234, 0, s[78:79]
    v_cndmask_b32 v27, 0, v234, s[78:79]
    v_cmp_le_i32 s[74:75], 24, v8
    v_cmp_le_i32 s[76:77], 25, v8
    v_cmp_le_i32 s[78:79], 26, v8
    s_nop 1
    v_cndmask_b32 v44, v234, 0, s[74:75]
    v_cndmask_b32 v28, 0, v234, s[74:75]
    v_cndmask_b32 v45, v234, 0, s[76:77]
    v_cndmask_b32 v29, 0, v234, s[76:77]
    v_cndmask_b32 v46, v234, 0, s[78:79]
    v_cndmask_b32 v30, 0, v234, s[78:79]
    v_cmp_le_i32 s[74:75], 27, v8
    s_nop 1
    v_cndmask_b32 v47, v234, 0, s[74:75]
    v_cndmask_b32 v31, 0, v234, s[74:75]
    v_lshlrev_b32 v235, 4, v3
    v_lshl_add_u32 v235, v4, 8, v235
    s_lshl_b32 s41, s62, 16
    s_add_u32 s41, s41, s30
    s_add_u32 s41, s41, 4194304
    s_sub_i32 s40, s63, 8
    s_max_i32 s40, s40, 0
    s_lshl_b32 s40, s40, 10
    s_add_u32 s52, s40, s41
    s_sub_i32 s40, s63, 7
    s_max_i32 s40, s40, 0
    s_lshl_b32 s40, s40, 10
    s_add_u32 s53, s40, s41
    s_sub_i32 s40, s63, 6
    s_max_i32 s40, s40, 0
    s_lshl_b32 s40, s40, 10
    s_add_u32 s54, s40, s41
    s_sub_i32 s40, s63, 5
    s_max_i32 s40, s40, 0
    s_lshl_b32 s40, s40, 10
    s_add_u32 s55, s40, s41
    s_sub_i32 s40, s63, 4
    s_max_i32 s40, s40, 0
    s_lshl_b32 s40, s40, 10
    s_add_u32 s56, s40, s41
    s_sub_i32 s40, s63, 3
    s_max_i32 s40, s40, 0
    s_lshl_b32 s40, s40, 10
    s_add_u32 s57, s40, s41
    s_sub_i32 s40, s63, 2
    s_max_i32 s40, s40, 0
    s_lshl_b32 s40, s40, 10
    s_add_u32 s58, s40, s41
    s_sub_i32 s40, s63, 1
    s_max_i32 s40, s40, 0
    s_lshl_b32 s40, s40, 10
    s_add_u32 s59, s40, s41
    s_sub_i32 s40, s63, 0
    s_max_i32 s40, s40, 0
    s_lshl_b32 s40, s40, 10
    s_add_u32 s60, s40, s41
    s_sub_i32 s40, s63, -1
    s_max_i32 s40, s40, 0
    s_lshl_b32 s40, s40, 10
    s_add_u32 s61, s40, s41
    v_add_u32 v235, 2097152, v235
    s_mov_b64 exec, 7
    s_add_u32 s42, s95, 49987584
    buffer_load_dword v11, v10, s[24:27], s42 offen sc1
    s_mov_b64 exec, -1
    s_add_u32 s42, s32, 16384
    s_add_u32 s42, s42, s92
    s_cmp_lg_u32 s3, 0
    s_waitcnt vmcnt(0)
    s_barrier
    s_cbranch_scc1 pk_kernel_sg_76
    s_mov_b64 exec, 1
    buffer_atomic_add v5, v6, s[24:27], s42 offen sc1
    s_mov_b64 exec, -1
pk_kernel_sg_76:
    s_branch pk_kernel_loop
pk_kernel_last_69:
    v_lshlrev_b32 v7, 10, v3
    v_lshl_add_u32 v7, v4, 4, v7
    s_lshl_b32 s40, s64, 15
    s_lshl_b32 s41, s65, 6
    s_add_u32 s40, s40, s41
    buffer_store_dwordx4 v[192:195], v7, s[36:39], s40 offen
    buffer_store_dwordx4 v[196:199], v7, s[36:39], s40 offen offset:32
pk_kernel_fin:
pk_kernel_end:
    s_endpgm
pk_kernel_edge_7:
    s_waitcnt vmcnt(10)
    v_mfma_f32_32x32x16_bf16 v[48:63], a[0:3], v[224:227], v[16:31]
    s_waitcnt vmcnt(9)
    v_mfma_f32_32x32x16_bf16 v[64:79], a[4:7], v[224:227], 0
    s_waitcnt vmcnt(8)
    v_mfma_f32_32x32x16_bf16 v[80:95], a[8:11], v[224:227], 0
    s_nop 7
    s_nop 1
    s_cmp_ge_i32 s63, 8
    s_cbranch_scc1 pk_kernel_fx_13
    v_mov_b32 v48, v234
    v_mov_b32 v49, v234
    v_mov_b32 v50, v234
    v_mov_b32 v51, v234
    v_mov_b32 v52, v234
    v_mov_b32 v53, v234
    v_mov_b32 v54, v234
    v_mov_b32 v55, v234
    v_mov_b32 v56, v234
    v_mov_b32 v57, v234
    v_mov_b32 v58, v234
    v_mov_b32 v59, v234
    v_mov_b32 v60, v234
    v_mov_b32 v61, v234
    v_mov_b32 v62, v234
    v_mov_b32 v63, v234
pk_kernel_fx_13:
    v_max3_f32 v232, v48, v49, v50
    v_max3_f32 v233, v51, v52, v53
    v_max3_f32 v232, v232, v54, v55
    v_max3_f32 v233, v233, v56, v57
    v_max3_f32 v232, v232, v58, v59
    v_max3_f32 v233, v233, v60, v61
    v_max3_f32 v232, v232, v62, v63
    s_waitcnt vmcnt(7)
    v_mfma_f32_32x32x16_bf16 v[96:111], a[12:15], v[224:227], 0
    s_cmp_ge_i32 s63, 7
    s_cbranch_scc1 pk_kernel_fx_14
    v_mov_b32 v64, v234
    v_mov_b32 v65, v234
    v_mov_b32 v66, v234
    v_mov_b32 v67, v234
    v_mov_b32 v68, v234
    v_mov_b32 v69, v234
    v_mov_b32 v70, v234
    v_mov_b32 v71, v234
    v_mov_b32 v72, v234
    v_mov_b32 v73, v234
    v_mov_b32 v74, v234
    v_mov_b32 v75, v234
    v_mov_b32 v76, v234
    v_mov_b32 v77, v234
    v_mov_b32 v78, v234
    v_mov_b32 v79, v234
pk_kernel_fx_14:
    v_max3_f32 v232, v232, v64, v65
    v_max3_f32 v233, v233, v66, v67
    v_max3_f32 v232, v232, v68, v69
    v_max3_f32 v233, v233, v70, v71
    v_max3_f32 v232, v232, v72, v73
    v_max3_f32 v233, v233, v74, v75
    v_max3_f32 v232, v232, v76, v77
    v_max3_f32 v233, v233, v78, v79
    s_waitcnt vmcnt(6)
    v_mfma_f32_32x32x16_bf16 v[48:63], a[16:19], v[224:227], 0
    s_cmp_ge_i32 s63, 6
    s_cbranch_scc1 pk_kernel_fx_15
    v_mov_b32 v80, v234
    v_mov_b32 v81, v234
    v_mov_b32 v82, v234
    v_mov_b32 v83, v234
    v_mov_b32 v84, v234
    v_mov_b32 v85, v234
    v_mov_b32 v86, v234
    v_mov_b32 v87, v234
    v_mov_b32 v88, v234
    v_mov_b32 v89, v234
    v_mov_b32 v90, v234
    v_mov_b32 v91, v234
    v_mov_b32 v92, v234
    v_mov_b32 v93, v234
    v_mov_b32 v94, v234
    v_mov_b32 v95, v234
pk_kernel_fx_15:
    v_max3_f32 v232, v232, v80, v81
    v_max3_f32 v233, v233, v82, v83
    v_max3_f32 v232, v232, v84, v85
    v_max3_f32 v233, v233, v86, v87
    v_max3_f32 v232, v232, v88, v89
    v_max3_f32 v233, v233, v90, v91
    v_max3_f32 v232, v232, v92, v93
    v_max3_f32 v233, v233, v94, v95
    s_waitcnt vmcnt(5)
    v_mfma_f32_32x32x16_bf16 v[64:79], a[20:23], v[224:227], 0
    s_cmp_ge_i32 s63, 5
    s_cbranch_scc1 pk_kernel_fx_16
    v_mov_b32 v96, v234
    v_mov_b32 v97, v234
    v_mov_b32 v98, v234
    v_mov_b32 v99, v234
    v_mov_b32 v100, v234
    v_mov_b32 v101, v234
    v_mov_b32 v102, v234
    v_mov_b32 v103, v234
    v_mov_b32 v104, v234
    v_mov_b32 v105, v234
    v_mov_b32 v106, v234
    v_mov_b32 v107, v234
    v_mov_b32 v108, v234
    v_mov_b32 v109, v234
    v_mov_b32 v110, v234
    v_mov_b32 v111, v234
pk_kernel_fx_16:
    v_max3_f32 v232, v232, v96, v97
    v_max3_f32 v233, v233, v98, v99
    v_max3_f32 v232, v232, v100, v101
    v_max3_f32 v233, v233, v102, v103
    v_max3_f32 v232, v232, v104, v105
    v_max3_f32 v233, v233, v106, v107
    v_max3_f32 v232, v232, v108, v109
    v_max3_f32 v233, v233, v110, v111
    s_waitcnt vmcnt(4)
    v_mfma_f32_32x32x16_bf16 v[80:95], a[24:27], v[224:227], 0
    s_cmp_ge_i32 s63, 4
    s_cbranch_scc1 pk_kernel_fx_17
    v_mov_b32 v48, v234
    v_mov_b32 v49, v234
    v_mov_b32 v50, v234
    v_mov_b32 v51, v234
    v_mov_b32 v52, v234
    v_mov_b32 v53, v234
    v_mov_b32 v54, v234
    v_mov_b32 v55, v234
    v_mov_b32 v56, v234
    v_mov_b32 v57, v234
    v_mov_b32 v58, v234
    v_mov_b32 v59, v234
    v_mov_b32 v60, v234
    v_mov_b32 v61, v234
    v_mov_b32 v62, v234
    v_mov_b32 v63, v234
pk_kernel_fx_17:
    v_max3_f32 v232, v232, v48, v49
    v_max3_f32 v233, v233, v50, v51
    v_max3_f32 v232, v232, v52, v53
    v_max3_f32 v233, v233, v54, v55
    v_max3_f32 v232, v232, v56, v57
    v_max3_f32 v233, v233, v58, v59
    v_max3_f32 v232, v232, v60, v61
    v_max3_f32 v233, v233, v62, v63
    s_waitcnt vmcnt(3)
    v_mfma_f32_32x32x16_bf16 v[96:111], a[28:31], v[224:227], 0
    s_cmp_ge_i32 s63, 3
    s_cbranch_scc1 pk_kernel_fx_18
    v_mov_b32 v64, v234
    v_mov_b32 v65, v234
    v_mov_b32 v66, v234
    v_mov_b32 v67, v234
    v_mov_b32 v68, v234
    v_mov_b32 v69, v234
    v_mov_b32 v70, v234
    v_mov_b32 v71, v234
    v_mov_b32 v72, v234
    v_mov_b32 v73, v234
    v_mov_b32 v74, v234
    v_mov_b32 v75, v234
    v_mov_b32 v76, v234
    v_mov_b32 v77, v234
    v_mov_b32 v78, v234
    v_mov_b32 v79, v234
pk_kernel_fx_18:
    v_max3_f32 v232, v232, v64, v65
    v_max3_f32 v233, v233, v66, v67
    v_max3_f32 v232, v232, v68, v69
    v_max3_f32 v233, v233, v70, v71
    v_max3_f32 v232, v232, v72, v73
    v_max3_f32 v233, v233, v74, v75
    v_max3_f32 v232, v232, v76, v77
    v_max3_f32 v233, v233, v78, v79
    s_waitcnt vmcnt(2)
    v_mfma_f32_32x32x16_bf16 v[48:63], a[32:35], v[224:227], v[32:47]
    s_cmp_ge_i32 s63, 2
    s_cbranch_scc1 pk_kernel_fx_19
    v_mov_b32 v80, v234
    v_mov_b32 v81, v234
    v_mov_b32 v82, v234
    v_mov_b32 v83, v234
    v_mov_b32 v84, v234
    v_mov_b32 v85, v234
    v_mov_b32 v86, v234
    v_mov_b32 v87, v234
    v_mov_b32 v88, v234
    v_mov_b32 v89, v234
    v_mov_b32 v90, v234
    v_mov_b32 v91, v234
    v_mov_b32 v92, v234
    v_mov_b32 v93, v234
    v_mov_b32 v94, v234
    v_mov_b32 v95, v234
pk_kernel_fx_19:
    v_max3_f32 v232, v232, v80, v81
    v_max3_f32 v233, v233, v82, v83
    v_max3_f32 v232, v232, v84, v85
    v_max3_f32 v233, v233, v86, v87
    v_max3_f32 v232, v232, v88, v89
    v_max3_f32 v233, v233, v90, v91
    v_max3_f32 v232, v232, v92, v93
    v_max3_f32 v233, v233, v94, v95
    s_nop 3
    s_cmp_ge_i32 s63, 1
    s_cbranch_scc1 pk_kernel_fx_20
    v_mov_b32 v96, v234
    v_mov_b32 v97, v234
    v_mov_b32 v98, v234
    v_mov_b32 v99, v234
    v_mov_b32 v100, v234
    v_mov_b32 v101, v234
    v_mov_b32 v102, v234
    v_mov_b32 v103, v234
    v_mov_b32 v104, v234
    v_mov_b32 v105, v234
    v_mov_b32 v106, v234
    v_mov_b32 v107, v234
    v_mov_b32 v108, v234
    v_mov_b32 v109, v234
    v_mov_b32 v110, v234
    v_mov_b32 v111, v234
pk_kernel_fx_20:
    v_max3_f32 v232, v232, v96, v97
    v_max3_f32 v233, v233, v98, v99
    v_max3_f32 v232, v232, v100, v101
    v_max3_f32 v233, v233, v102, v103
    v_max3_f32 v232, v232, v104, v105
    v_max3_f32 v233, v233, v106, v107
    v_max3_f32 v232, v232, v108, v109
    v_max3_f32 v233, v233, v110, v111
    s_nop 3
    v_max3_f32 v232, v232, v48, v49
    v_max3_f32 v233, v233, v50, v51
    v_max3_f32 v232, v232, v52, v53
    v_max3_f32 v233, v233, v54, v55
    v_max3_f32 v232, v232, v56, v57
    v_max3_f32 v233, v233, v58, v59
    v_max3_f32 v232, v232, v60, v61
    v_max3_f32 v233, v233, v62, v63
    v_max_f32 v232, v232, v233
    v_mov_b32 v233, v232
    s_nop 1
    v_permlane32_swap_b32 v232, v233
    v_max_f32 v232, v232, v233
    v_sub_f32 v232, 0, v232
    v_pk_add_f32 v[128:129], v[16:17], v[232:233] op_sel_hi:[1,0]
    v_pk_add_f32 v[144:145], v[32:33], v[232:233] op_sel_hi:[1,0]
    v_pk_mov_b32 v[112:113], v[232:233], v[232:233] op_sel:[0,0]
    v_pk_add_f32 v[130:131], v[18:19], v[232:233] op_sel_hi:[1,0]
    v_pk_add_f32 v[146:147], v[34:35], v[232:233] op_sel_hi:[1,0]
    v_pk_mov_b32 v[114:115], v[232:233], v[232:233] op_sel:[0,0]
    v_pk_add_f32 v[132:133], v[20:21], v[232:233] op_sel_hi:[1,0]
    v_pk_add_f32 v[148:149], v[36:37], v[232:233] op_sel_hi:[1,0]
    v_pk_mov_b32 v[116:117], v[232:233], v[232:233] op_sel:[0,0]
    v_pk_add_f32 v[134:135], v[22:23], v[232:233] op_sel_hi:[1,0]
    v_pk_add_f32 v[150:151], v[38:39], v[232:233] op_sel_hi:[1,0]
    v_pk_mov_b32 v[118:119], v[232:233], v[232:233] op_sel:[0,0]
    v_pk_add_f32 v[136:137], v[24:25], v[232:233] op_sel_hi:[1,0]
    v_pk_add_f32 v[152:153], v[40:41], v[232:233] op_sel_hi:[1,0]
    v_pk_mov_b32 v[120:121], v[232:233], v[232:233] op_sel:[0,0]
    v_pk_add_f32 v[138:139], v[26:27], v[232:233] op_sel_hi:[1,0]
    v_pk_add_f32 v[154:155], v[42:43], v[232:233] op_sel_hi:[1,0]
    v_pk_mov_b32 v[122:123], v[232:233], v[232:233] op_sel:[0,0]
    v_pk_add_f32 v[140:141], v[28:29], v[232:233] op_sel_hi:[1,0]
    v_pk_add_f32 v[156:157], v[44:45], v[232:233] op_sel_hi:[1,0]
    v_pk_mov_b32 v[124:125], v[232:233], v[232:233] op_sel:[0,0]
    v_pk_add_f32 v[142:143], v[30:31], v[232:233] op_sel_hi:[1,0]
    v_pk_add_f32 v[158:159], v[46:47], v[232:233] op_sel_hi:[1,0]
    v_pk_mov_b32 v[126:127], v[232:233], v[232:233] op_sel:[0,0]
    s_waitcnt vmcnt(0)
    v_cmp_gt_u32 vcc, s98, v11
    s_and_b32 vcc_lo, vcc_lo, 7
    s_cbranch_scc1 pk_kernel_sp_21
pk_kernel_pr_22:
    s_mov_b64 exec, s[72:73]
    buffer_load_dwordx4 a[40:43], v235, s[24:27], s52 offen offset:0 sc1
    buffer_load_dwordx4 a[44:47], v235, s[24:27], s52 offen offset:512 sc1
    buffer_load_dwordx4 a[48:51], v235, s[24:27], s53 offen offset:0 sc1
    buffer_load_dwordx4 a[52:55], v235, s[24:27], s53 offen offset:512 sc1
    buffer_load_dwordx4 a[56:59], v235, s[24:27], s54 offen offset:0 sc1
    buffer_load_dwordx4 a[60:63], v235, s[24:27], s54 offen offset:512 sc1
    buffer_load_dwordx4 a[64:67], v235, s[24:27], s55 offen offset:0 sc1
    buffer_load_dwordx4 a[68:71], v235, s[24:27], s55 offen offset:512 sc1
    buffer_load_dwordx4 a[72:75], v235, s[24:27], s56 offen offset:0 sc1
    buffer_load_dwordx4 a[76:79], v235, s[24:27], s56 offen offset:512 sc1
    buffer_load_dwordx4 a[80:83], v235, s[24:27], s57 offen offset:0 sc1
    buffer_load_dwordx4 a[84:87], v235, s[24:27], s57 offen offset:512 sc1
    buffer_load_dwordx4 a[88:91], v235, s[24:27], s58 offen offset:0 sc1
    buffer_load_dwordx4 a[92:95], v235, s[24:27], s58 offen offset:512 sc1
    buffer_load_dwordx4 a[96:99], v235, s[24:27], s59 offen offset:0 sc1
    buffer_load_dwordx4 a[100:103], v235, s[24:27], s59 offen offset:512 sc1
    buffer_load_dwordx4 a[104:107], v235, s[24:27], s60 offen offset:0 sc1
    buffer_load_dwordx4 a[108:111], v235, s[24:27], s60 offen offset:512 sc1
    buffer_load_dwordx4 a[112:115], v235, s[24:27], s61 offen offset:0 sc1
    buffer_load_dwordx4 a[116:119], v235, s[24:27], s61 offen offset:512 sc1
    s_mov_b64 exec, -1
    v_mfma_f32_32x32x16_bf16 v[48:63], a[4:7], v[228:231], v[16:31]
    v_mfma_f32_32x32x16_bf16 v[64:79], a[8:11], v[228:231], 0
    v_mfma_f32_32x32x16_bf16 v[80:95], a[12:15], v[228:231], 0
    s_nop 7
    s_nop 1
    s_cmp_ge_i32 s63, 7
    s_cbranch_scc1 pk_kernel_fx_25
    v_mov_b32 v48, v234
    v_mov_b32 v49, v234
    v_mov_b32 v50, v234
    v_mov_b32 v51, v234
    v_mov_b32 v52, v234
    v_mov_b32 v53, v234
    v_mov_b32 v54, v234
    v_mov_b32 v55, v234
    v_mov_b32 v56, v234
    v_mov_b32 v57, v234
    v_mov_b32 v58, v234
    v_mov_b32 v59, v234
    v_mov_b32 v60, v234
    v_mov_b32 v61, v234
    v_mov_b32 v62, v234
    v_mov_b32 v63, v234
pk_kernel_fx_25:
    v_max3_f32 v232, v48, v49, v50
    v_max3_f32 v233, v51, v52, v53
    v_max3_f32 v232, v232, v54, v55
    v_max3_f32 v233, v233, v56, v57
    v_max3_f32 v232, v232, v58, v59
    v_max3_f32 v233, v233, v60, v61
    v_max3_f32 v232, v232, v62, v63
    v_mfma_f32_32x32x16_bf16 v[96:111], a[16:19], v[228:231], 0
    s_cmp_ge_i32 s63, 6
    s_cbranch_scc1 pk_kernel_fx_26
    v_mov_b32 v64, v234
    v_mov_b32 v65, v234
    v_mov_b32 v66, v234
    v_mov_b32 v67, v234
    v_mov_b32 v68, v234
    v_mov_b32 v69, v234
    v_mov_b32 v70, v234
    v_mov_b32 v71, v234
    v_mov_b32 v72, v234
    v_mov_b32 v73, v234
    v_mov_b32 v74, v234
    v_mov_b32 v75, v234
    v_mov_b32 v76, v234
    v_mov_b32 v77, v234
    v_mov_b32 v78, v234
    v_mov_b32 v79, v234
pk_kernel_fx_26:
    v_max3_f32 v232, v232, v64, v65
    v_max3_f32 v233, v233, v66, v67
    v_max3_f32 v232, v232, v68, v69
    v_max3_f32 v233, v233, v70, v71
    v_max3_f32 v232, v232, v72, v73
    v_max3_f32 v233, v233, v74, v75
    v_max3_f32 v232, v232, v76, v77
    v_max3_f32 v233, v233, v78, v79
    v_mfma_f32_32x32x16_bf16 v[48:63], a[20:23], v[228:231], 0
    s_cmp_ge_i32 s63, 5
    s_cbranch_scc1 pk_kernel_fx_27
    v_mov_b32 v80, v234
    v_mov_b32 v81, v234
    v_mov_b32 v82, v234
    v_mov_b32 v83, v234
    v_mov_b32 v84, v234
    v_mov_b32 v85, v234
    v_mov_b32 v86, v234
    v_mov_b32 v87, v234
    v_mov_b32 v88, v234
    v_mov_b32 v89, v234
    v_mov_b32 v90, v234
    v_mov_b32 v91, v234
    v_mov_b32 v92, v234
    v_mov_b32 v93, v234
    v_mov_b32 v94, v234
    v_mov_b32 v95, v234
pk_kernel_fx_27:
    v_max3_f32 v232, v232, v80, v81
    v_max3_f32 v233, v233, v82, v83
    v_max3_f32 v232, v232, v84, v85
    v_max3_f32 v233, v233, v86, v87
    v_max3_f32 v232, v232, v88, v89
    v_max3_f32 v233, v233, v90, v91
    v_max3_f32 v232, v232, v92, v93
    v_max3_f32 v233, v233, v94, v95
    v_mfma_f32_32x32x16_bf16 v[64:79], a[24:27], v[228:231], 0
    s_cmp_ge_i32 s63, 4
    s_cbranch_scc1 pk_kernel_fx_28
    v_mov_b32 v96, v234
    v_mov_b32 v97, v234
    v_mov_b32 v98, v234
    v_mov_b32 v99, v234
    v_mov_b32 v100, v234
    v_mov_b32 v101, v234
    v_mov_b32 v102, v234
    v_mov_b32 v103, v234
    v_mov_b32 v104, v234
    v_mov_b32 v105, v234
    v_mov_b32 v106, v234
    v_mov_b32 v107, v234
    v_mov_b32 v108, v234
    v_mov_b32 v109, v234
    v_mov_b32 v110, v234
    v_mov_b32 v111, v234
pk_kernel_fx_28:
    v_max3_f32 v232, v232, v96, v97
    v_max3_f32 v233, v233, v98, v99
    v_max3_f32 v232, v232, v100, v101
    v_max3_f32 v233, v233, v102, v103
    v_max3_f32 v232, v232, v104, v105
    v_max3_f32 v233, v233, v106, v107
    v_max3_f32 v232, v232, v108, v109
    v_max3_f32 v233, v233, v110, v111
    v_mfma_f32_32x32x16_bf16 v[80:95], a[28:31], v[228:231], 0
    s_cmp_ge_i32 s63, 3
    s_cbranch_scc1 pk_kernel_fx_29
    v_mov_b32 v48, v234
    v_mov_b32 v49, v234
    v_mov_b32 v50, v234
    v_mov_b32 v51, v234
    v_mov_b32 v52, v234
    v_mov_b32 v53, v234
    v_mov_b32 v54, v234
    v_mov_b32 v55, v234
    v_mov_b32 v56, v234
    v_mov_b32 v57, v234
    v_mov_b32 v58, v234
    v_mov_b32 v59, v234
    v_mov_b32 v60, v234
    v_mov_b32 v61, v234
    v_mov_b32 v62, v234
    v_mov_b32 v63, v234
pk_kernel_fx_29:
    v_max3_f32 v232, v232, v48, v49
    v_max3_f32 v233, v233, v50, v51
    v_max3_f32 v232, v232, v52, v53
    v_max3_f32 v233, v233, v54, v55
    v_max3_f32 v232, v232, v56, v57
    v_max3_f32 v233, v233, v58, v59
    v_max3_f32 v232, v232, v60, v61
    v_max3_f32 v233, v233, v62, v63
    v_mfma_f32_32x32x16_bf16 v[96:111], a[32:35], v[228:231], 0
    s_cmp_ge_i32 s63, 2
    s_cbranch_scc1 pk_kernel_fx_30
    v_mov_b32 v64, v234
    v_mov_b32 v65, v234
    v_mov_b32 v66, v234
    v_mov_b32 v67, v234
    v_mov_b32 v68, v234
    v_mov_b32 v69, v234
    v_mov_b32 v70, v234
    v_mov_b32 v71, v234
    v_mov_b32 v72, v234
    v_mov_b32 v73, v234
    v_mov_b32 v74, v234
    v_mov_b32 v75, v234
    v_mov_b32 v76, v234
    v_mov_b32 v77, v234
    v_mov_b32 v78, v234
    v_mov_b32 v79, v234
pk_kernel_fx_30:
    v_max3_f32 v232, v232, v64, v65
    v_max3_f32 v233, v233, v66, v67
    v_max3_f32 v232, v232, v68, v69
    v_max3_f32 v233, v233, v70, v71
    v_max3_f32 v232, v232, v72, v73
    v_max3_f32 v233, v233, v74, v75
    v_max3_f32 v232, v232, v76, v77
    v_max3_f32 v233, v233, v78, v79
    v_mfma_f32_32x32x16_bf16 v[48:63], a[36:39], v[228:231], v[32:47]
    s_cmp_ge_i32 s63, 1
    s_cbranch_scc1 pk_kernel_fx_31
    v_mov_b32 v80, v234
    v_mov_b32 v81, v234
    v_mov_b32 v82, v234
    v_mov_b32 v83, v234
    v_mov_b32 v84, v234
    v_mov_b32 v85, v234
    v_mov_b32 v86, v234
    v_mov_b32 v87, v234
    v_mov_b32 v88, v234
    v_mov_b32 v89, v234
    v_mov_b32 v90, v234
    v_mov_b32 v91, v234
    v_mov_b32 v92, v234
    v_mov_b32 v93, v234
    v_mov_b32 v94, v234
    v_mov_b32 v95, v234
pk_kernel_fx_31:
    v_max3_f32 v232, v232, v80, v81
    v_max3_f32 v233, v233, v82, v83
    v_max3_f32 v232, v232, v84, v85
    v_max3_f32 v233, v233, v86, v87
    v_max3_f32 v232, v232, v88, v89
    v_max3_f32 v233, v233, v90, v91
    v_max3_f32 v232, v232, v92, v93
    v_max3_f32 v233, v233, v94, v95
    s_nop 3
    s_cmp_ge_i32 s63, 0
    s_cbranch_scc1 pk_kernel_fx_32
    v_mov_b32 v96, v234
    v_mov_b32 v97, v234
    v_mov_b32 v98, v234
    v_mov_b32 v99, v234
    v_mov_b32 v100, v234
    v_mov_b32 v101, v234
    v_mov_b32 v102, v234
    v_mov_b32 v103, v234
    v_mov_b32 v104, v234
    v_mov_b32 v105, v234
    v_mov_b32 v106, v234
    v_mov_b32 v107, v234
    v_mov_b32 v108, v234
    v_mov_b32 v109, v234
    v_mov_b32 v110, v234
    v_mov_b32 v111, v234
pk_kernel_fx_32:
    v_max3_f32 v232, v232, v96, v97
    v_max3_f32 v233, v233, v98, v99
    v_max3_f32 v232, v232, v100, v101
    v_max3_f32 v233, v233, v102, v103
    v_max3_f32 v232, v232, v104, v105
    v_max3_f32 v233, v233, v106, v107
    v_max3_f32 v232, v232, v108, v109
    v_max3_f32 v233, v233, v110, v111
    s_nop 3
    v_max3_f32 v232, v232, v48, v49
    v_max3_f32 v233, v233, v50, v51
    v_max3_f32 v232, v232, v52, v53
    v_max3_f32 v233, v233, v54, v55
    v_max3_f32 v232, v232, v56, v57
    v_max3_f32 v233, v233, v58, v59
    v_max3_f32 v232, v232, v60, v61
    v_max3_f32 v233, v233, v62, v63
    v_max_f32 v232, v232, v233
    v_mov_b32 v233, v232
    s_nop 1
    v_permlane32_swap_b32 v232, v233
    v_max_f32 v232, v232, v233
    v_sub_f32 v232, 0, v232
    v_pk_add_f32 v[176:177], v[16:17], v[232:233] op_sel_hi:[1,0]
    v_pk_add_f32 v[192:193], v[32:33], v[232:233] op_sel_hi:[1,0]
    v_pk_mov_b32 v[160:161], v[232:233], v[232:233] op_sel:[0,0]
    v_pk_add_f32 v[178:179], v[18:19], v[232:233] op_sel_hi:[1,0]
    v_pk_add_f32 v[194:195], v[34:35], v[232:233] op_sel_hi:[1,0]
    v_pk_mov_b32 v[162:163], v[232:233], v[232:233] op_sel:[0,0]
    v_pk_add_f32 v[180:181], v[20:21], v[232:233] op_sel_hi:[1,0]
    v_pk_add_f32 v[196:197], v[36:37], v[232:233] op_sel_hi:[1,0]
    v_pk_mov_b32 v[164:165], v[232:233], v[232:233] op_sel:[0,0]
    v_pk_add_f32 v[182:183], v[22:23], v[232:233] op_sel_hi:[1,0]
    v_pk_add_f32 v[198:199], v[38:39], v[232:233] op_sel_hi:[1,0]
    v_pk_mov_b32 v[166:167], v[232:233], v[232:233] op_sel:[0,0]
    v_pk_add_f32 v[184:185], v[24:25], v[232:233] op_sel_hi:[1,0]
    v_pk_add_f32 v[200:201], v[40:41], v[232:233] op_sel_hi:[1,0]
    v_pk_mov_b32 v[168:169], v[232:233], v[232:233] op_sel:[0,0]
    v_pk_add_f32 v[186:187], v[26:27], v[232:233] op_sel_hi:[1,0]
    v_pk_add_f32 v[202:203], v[42:43], v[232:233] op_sel_hi:[1,0]
    v_pk_mov_b32 v[170:171], v[232:233], v[232:233] op_sel:[0,0]
    v_pk_add_f32 v[188:189], v[28:29], v[232:233] op_sel_hi:[1,0]
    v_pk_add_f32 v[204:205], v[44:45], v[232:233] op_sel_hi:[1,0]
    v_pk_mov_b32 v[172:173], v[232:233], v[232:233] op_sel:[0,0]
    v_pk_add_f32 v[190:191], v[30:31], v[232:233] op_sel_hi:[1,0]
    v_pk_add_f32 v[206:207], v[46:47], v[232:233] op_sel_hi:[1,0]
    v_pk_mov_b32 v[174:175], v[232:233], v[232:233] op_sel:[0,0]
    s_nop 1
    v_mfma_f32_32x32x16_bf16 v[48:63], a[0:3], v[224:227], v[128:143]
    v_mfma_f32_32x32x16_bf16 v[64:79], a[4:7], v[224:227], v[112:127]
    v_mfma_f32_32x32x16_bf16 v[80:95], a[8:11], v[224:227], v[112:127]
    s_nop 7
    s_nop 1
    s_cmp_ge_i32 s63, 8
    s_cbranch_scc1 pk_kernel_fx_33
    v_mov_b32 v48, v234
    v_mov_b32 v49, v234
    v_mov_b32 v50, v234
    v_mov_b32 v51, v234
    v_mov_b32 v52, v234
    v_mov_b32 v53, v234
    v_mov_b32 v54, v234
    v_mov_b32 v55, v234
    v_mov_b32 v56, v234
    v_mov_b32 v57, v234
    v_mov_b32 v58, v234
    v_mov_b32 v59, v234
    v_mov_b32 v60, v234
    v_mov_b32 v61, v234
    v_mov_b32 v62, v234
    v_mov_b32 v63, v234
pk_kernel_fx_33:
    v_exp_f32 v48, v48
    v_exp_f32 v49, v49
    v_exp_f32 v50, v50
    v_exp_f32 v51, v51
    buffer_load_dwordx4 a[192:195], v240, s[24:27], s81 offen offset:0
    v_exp_f32 v52, v52
    v_exp_f32 v53, v53
    v_exp_f32 v54, v54
    v_exp_f32 v55, v55
    v_exp_f32 v56, v56
    v_exp_f32 v57, v57
    v_exp_f32 v58, v58
    v_exp_f32 v59, v59
    v_exp_f32 v60, v60
    v_exp_f32 v61, v61
    buffer_load_dwordx4 a[196:199], v240, s[24:27], s81 offen offset:1024
    v_exp_f32 v62, v62
    v_exp_f32 v63, v63
    v_cvt_pk_bf16_f32 v48, v48, v49
    v_cvt_pk_bf16_f32 v49, v50, v51
    v_cvt_pk_bf16_f32 v50, v52, v53
    v_cvt_pk_bf16_f32 v51, v54, v55
    v_cvt_pk_bf16_f32 v52, v56, v57
    v_cvt_pk_bf16_f32 v53, v58, v59
    v_cvt_pk_bf16_f32 v54, v60, v61
    v_cvt_pk_bf16_f32 v55, v62, v63
    s_cmp_ge_i32 s63, 7
    s_cbranch_scc1 pk_kernel_fx_34
    v_mov_b32 v64, v234
    v_mov_b32 v65, v234
    v_mov_b32 v66, v234
    v_mov_b32 v67, v234
    v_mov_b32 v68, v234
    v_mov_b32 v69, v234
    v_mov_b32 v70, v234
    v_mov_b32 v71, v234
    v_mov_b32 v72, v234
    v_mov_b32 v73, v234
    v_mov_b32 v74, v234
    v_mov_b32 v75, v234
    v_mov_b32 v76, v234
    v_mov_b32 v77, v234
    v_mov_b32 v78, v234
    v_mov_b32 v79, v234
pk_kernel_fx_34:
    v_exp_f32 v64, v64
    v_exp_f32 v65, v65
    s_waitcnt vmcnt(21)
    v_mfma_f32_32x32x16_bf16 v[208:223], a[40:43], v[48:51], 0
    v_exp_f32 v66, v66
    v_exp_f32 v67, v67
    buffer_load_dwordx4 a[200:203], v240, s[24:27], s81 offen offset:2048
    v_exp_f32 v68, v68
    v_exp_f32 v69, v69
    v_exp_f32 v70, v70
    s_waitcnt vmcnt(21)
    v_mfma_f32_32x32x16_bf16 v[208:223], a[44:47], v[52:55], v[208:223]
    v_exp_f32 v71, v71
    v_exp_f32 v72, v72
    v_exp_f32 v73, v73
    v_exp_f32 v74, v74
    v_exp_f32 v75, v75
    v_mfma_f32_32x32x16_bf16 v[96:111], a[12:15], v[224:227], v[112:127]
    v_exp_f32 v76, v76
    v_exp_f32 v77, v77
    buffer_load_dwordx4 a[204:207], v240, s[24:27], s81 offen offset:3072
    v_exp_f32 v78, v78
    v_exp_f32 v79, v79
    v_cvt_pk_bf16_f32 v64, v64, v65
    v_cvt_pk_bf16_f32 v65, v66, v67
    v_cvt_pk_bf16_f32 v66, v68, v69
    v_cvt_pk_bf16_f32 v67, v70, v71
    v_cvt_pk_bf16_f32 v68, v72, v73
    v_cvt_pk_bf16_f32 v69, v74, v75
    v_cvt_pk_bf16_f32 v70, v76, v77
    v_cvt_pk_bf16_f32 v71, v78, v79
    s_cmp_ge_i32 s63, 6
    s_cbranch_scc1 pk_kernel_fx_35
    v_mov_b32 v80, v234
    v_mov_b32 v81, v234
    v_mov_b32 v82, v234
    v_mov_b32 v83, v234
    v_mov_b32 v84, v234
    v_mov_b32 v85, v234
    v_mov_b32 v86, v234
    v_mov_b32 v87, v234
    v_mov_b32 v88, v234
    v_mov_b32 v89, v234
    v_mov_b32 v90, v234
    v_mov_b32 v91, v234
    v_mov_b32 v92, v234
    v_mov_b32 v93, v234
    v_mov_b32 v94, v234
    v_mov_b32 v95, v234
pk_kernel_fx_35:
    v_exp_f32 v80, v80
    v_exp_f32 v81, v81
    s_waitcnt vmcnt(21)
    v_mfma_f32_32x32x16_bf16 v[208:223], a[48:51], v[64:67], v[208:223]
    v_exp_f32 v82, v82
    v_exp_f32 v83, v83
    buffer_load_dwordx4 a[208:211], v241, s[24:27], s81 offen offset:0
    v_exp_f32 v84, v84
    v_exp_f32 v85, v85
    v_exp_f32 v86, v86
    s_waitcnt vmcnt(21)
    v_mfma_f32_32x32x16_bf16 v[208:223], a[52:55], v[68:71], v[208:223]
    v_exp_f32 v87, v87
    v_exp_f32 v88, v88
    v_exp_f32 v89, v89
    v_exp_f32 v90, v90
    v_exp_f32 v91, v91
    v_mfma_f32_32x32x16_bf16 v[48:63], a[16:19], v[224:227], v[112:127]
    v_exp_f32 v92, v92
    v_exp_f32 v93, v93
    buffer_load_dwordx4 a[212:215], v241, s[24:27], s81 offen offset:1024
    v_exp_f32 v94, v94
    v_exp_f32 v95, v95
    v_cvt_pk_bf16_f32 v80, v80, v81
    v_cvt_pk_bf16_f32 v81, v82, v83
    v_cvt_pk_bf16_f32 v82, v84, v85
    v_cvt_pk_bf16_f32 v83, v86, v87
    v_cvt_pk_bf16_f32 v84, v88, v89
    v_cvt_pk_bf16_f32 v85, v90, v91
    v_cvt_pk_bf16_f32 v86, v92, v93
    v_cvt_pk_bf16_f32 v87, v94, v95
    s_cmp_ge_i32 s63, 5
    s_cbranch_scc1 pk_kernel_fx_36
    v_mov_b32 v96, v234
    v_mov_b32 v97, v234
    v_mov_b32 v98, v234
    v_mov_b32 v99, v234
    v_mov_b32 v100, v234
    v_mov_b32 v101, v234
    v_mov_b32 v102, v234
    v_mov_b32 v103, v234
    v_mov_b32 v104, v234
    v_mov_b32 v105, v234
    v_mov_b32 v106, v234
    v_mov_b32 v107, v234
    v_mov_b32 v108, v234
    v_mov_b32 v109, v234
    v_mov_b32 v110, v234
    v_mov_b32 v111, v234
pk_kernel_fx_36:
    v_exp_f32 v96, v96
    v_exp_f32 v97, v97
    s_waitcnt vmcnt(21)
    v_mfma_f32_32x32x16_bf16 v[208:223], a[56:59], v[80:83], v[208:223]
    v_exp_f32 v98, v98
    v_exp_f32 v99, v99
    buffer_load_dwordx4 a[216:219], v241, s[24:27], s81 offen offset:2048
    v_exp_f32 v100, v100
    v_exp_f32 v101, v101
    v_exp_f32 v102, v102
    s_waitcnt vmcnt(21)
    v_mfma_f32_32x32x16_bf16 v[208:223], a[60:63], v[84:87], v[208:223]
    v_exp_f32 v103, v103
    v_exp_f32 v104, v104
    v_exp_f32 v105, v105
    v_exp_f32 v106, v106
    v_exp_f32 v107, v107
    v_mfma_f32_32x32x16_bf16 v[64:79], a[20:23], v[224:227], v[112:127]
    v_exp_f32 v108, v108
    v_exp_f32 v109, v109
    buffer_load_dwordx4 a[220:223], v241, s[24:27], s81 offen offset:3072
    v_exp_f32 v110, v110
    v_exp_f32 v111, v111
    v_cvt_pk_bf16_f32 v96, v96, v97
    v_cvt_pk_bf16_f32 v97, v98, v99
    v_cvt_pk_bf16_f32 v98, v100, v101
    v_cvt_pk_bf16_f32 v99, v102, v103
    v_cvt_pk_bf16_f32 v100, v104, v105
    v_cvt_pk_bf16_f32 v101, v106, v107
    v_cvt_pk_bf16_f32 v102, v108, v109
    v_cvt_pk_bf16_f32 v103, v110, v111
    s_cmp_ge_i32 s63, 4
    s_cbranch_scc1 pk_kernel_fx_37
    v_mov_b32 v48, v234
    v_mov_b32 v49, v234
    v_mov_b32 v50, v234
    v_mov_b32 v51, v234
    v_mov_b32 v52, v234
    v_mov_b32 v53, v234
    v_mov_b32 v54, v234
    v_mov_b32 v55, v234
    v_mov_b32 v56, v234
    v_mov_b32 v57, v234
    v_mov_b32 v58, v234
    v_mov_b32 v59, v234
    v_mov_b32 v60, v234
    v_mov_b32 v61, v234
    v_mov_b32 v62, v234
    v_mov_b32 v63, v234
pk_kernel_fx_37:
    v_exp_f32 v48, v48
    v_exp_f32 v49, v49
    s_waitcnt vmcnt(21)
    v_mfma_f32_32x32x16_bf16 v[208:223], a[64:67], v[96:99], v[208:223]
    v_exp_f32 v50, v50
    v_exp_f32 v51, v51
    buffer_load_dwordx4 a[224:227], v242, s[24:27], s81 offen offset:0
    v_exp_f32 v52, v52
    v_exp_f32 v53, v53
    v_exp_f32 v54, v54
    s_waitcnt vmcnt(21)
    v_mfma_f32_32x32x16_bf16 v[208:223], a[68:71], v[100:103], v[208:223]
    v_exp_f32 v55, v55
    v_exp_f32 v56, v56
    v_exp_f32 v57, v57
    v_exp_f32 v58, v58
    v_exp_f32 v59, v59
    v_mfma_f32_32x32x16_bf16 v[80:95], a[24:27], v[224:227], v[112:127]
    v_exp_f32 v60, v60
    v_exp_f32 v61, v61
    buffer_load_dwordx4 a[228:231], v242, s[24:27], s81 offen offset:1024
    v_exp_f32 v62, v62
    v_exp_f32 v63, v63
    v_cvt_pk_bf16_f32 v48, v48, v49
    v_cvt_pk_bf16_f32 v49, v50, v51
    v_cvt_pk_bf16_f32 v50, v52, v53
    v_cvt_pk_bf16_f32 v51, v54, v55
    v_cvt_pk_bf16_f32 v52, v56, v57
    v_cvt_pk_bf16_f32 v53, v58, v59
    v_cvt_pk_bf16_f32 v54, v60, v61
    v_cvt_pk_bf16_f32 v55, v62, v63
    s_cmp_ge_i32 s63, 3
    s_cbranch_scc1 pk_kernel_fx_38
    v_mov_b32 v64, v234
    v_mov_b32 v65, v234
    v_mov_b32 v66, v234
    v_mov_b32 v67, v234
    v_mov_b32 v68, v234
    v_mov_b32 v69, v234
    v_mov_b32 v70, v234
    v_mov_b32 v71, v234
    v_mov_b32 v72, v234
    v_mov_b32 v73, v234
    v_mov_b32 v74, v234
    v_mov_b32 v75, v234
    v_mov_b32 v76, v234
    v_mov_b32 v77, v234
    v_mov_b32 v78, v234
    v_mov_b32 v79, v234
pk_kernel_fx_38:
    v_exp_f32 v64, v64
    v_exp_f32 v65, v65
    s_waitcnt vmcnt(21)
    v_mfma_f32_32x32x16_bf16 v[208:223], a[72:75], v[48:51], v[208:223]
    v_exp_f32 v66, v66
    v_exp_f32 v67, v67
    buffer_load_dwordx4 a[232:235], v242, s[24:27], s81 offen offset:2048
    v_exp_f32 v68, v68
    v_exp_f32 v69, v69
    v_exp_f32 v70, v70
    s_waitcnt vmcnt(21)
    v_mfma_f32_32x32x16_bf16 v[208:223], a[76:79], v[52:55], v[208:223]
    v_exp_f32 v71, v71
    v_exp_f32 v72, v72
    v_exp_f32 v73, v73
    v_exp_f32 v74, v74
    v_exp_f32 v75, v75
    v_mfma_f32_32x32x16_bf16 v[96:111], a[28:31], v[224:227], v[112:127]
    v_exp_f32 v76, v76
    v_exp_f32 v77, v77
    buffer_load_dwordx4 a[236:239], v242, s[24:27], s81 offen offset:3072
    v_exp_f32 v78, v78
    v_exp_f32 v79, v79
    v_cvt_pk_bf16_f32 v64, v64, v65
    v_cvt_pk_bf16_f32 v65, v66, v67
    v_cvt_pk_bf16_f32 v66, v68, v69
    v_cvt_pk_bf16_f32 v67, v70, v71
    v_cvt_pk_bf16_f32 v68, v72, v73
    v_cvt_pk_bf16_f32 v69, v74, v75
    v_cvt_pk_bf16_f32 v70, v76, v77
    v_cvt_pk_bf16_f32 v71, v78, v79
    s_cmp_ge_i32 s63, 2
    s_cbranch_scc1 pk_kernel_fx_39
    v_mov_b32 v80, v234
    v_mov_b32 v81, v234
    v_mov_b32 v82, v234
    v_mov_b32 v83, v234
    v_mov_b32 v84, v234
    v_mov_b32 v85, v234
    v_mov_b32 v86, v234
    v_mov_b32 v87, v234
    v_mov_b32 v88, v234
    v_mov_b32 v89, v234
    v_mov_b32 v90, v234
    v_mov_b32 v91, v234
    v_mov_b32 v92, v234
    v_mov_b32 v93, v234
    v_mov_b32 v94, v234
    v_mov_b32 v95, v234
pk_kernel_fx_39:
    v_exp_f32 v80, v80
    v_exp_f32 v81, v81
    s_waitcnt vmcnt(21)
    v_mfma_f32_32x32x16_bf16 v[208:223], a[80:83], v[64:67], v[208:223]
    v_exp_f32 v82, v82
    v_exp_f32 v83, v83
    buffer_load_dwordx4 a[240:243], v243, s[24:27], s81 offen offset:0
    v_exp_f32 v84, v84
    v_exp_f32 v85, v85
    v_exp_f32 v86, v86
    s_waitcnt vmcnt(21)
    v_mfma_f32_32x32x16_bf16 v[208:223], a[84:87], v[68:71], v[208:223]
    v_exp_f32 v87, v87
    v_exp_f32 v88, v88
    v_exp_f32 v89, v89
    v_exp_f32 v90, v90
    v_exp_f32 v91, v91
    v_mfma_f32_32x32x16_bf16 v[48:63], a[32:35], v[224:227], v[144:159]
    v_exp_f32 v92, v92
    v_exp_f32 v93, v93
    buffer_load_dwordx4 a[244:247], v243, s[24:27], s81 offen offset:1024
    v_exp_f32 v94, v94
    v_exp_f32 v95, v95
    v_cvt_pk_bf16_f32 v80, v80, v81
    v_cvt_pk_bf16_f32 v81, v82, v83
    v_cvt_pk_bf16_f32 v82, v84, v85
    v_cvt_pk_bf16_f32 v83, v86, v87
    v_cvt_pk_bf16_f32 v84, v88, v89
    v_cvt_pk_bf16_f32 v85, v90, v91
    v_cvt_pk_bf16_f32 v86, v92, v93
    v_cvt_pk_bf16_f32 v87, v94, v95
    s_cmp_ge_i32 s63, 1
    s_cbranch_scc1 pk_kernel_fx_40
    v_mov_b32 v96, v234
    v_mov_b32 v97, v234
    v_mov_b32 v98, v234
    v_mov_b32 v99, v234
    v_mov_b32 v100, v234
    v_mov_b32 v101, v234
    v_mov_b32 v102, v234
    v_mov_b32 v103, v234
    v_mov_b32 v104, v234
    v_mov_b32 v105, v234
    v_mov_b32 v106, v234
    v_mov_b32 v107, v234
    v_mov_b32 v108, v234
    v_mov_b32 v109, v234
    v_mov_b32 v110, v234
    v_mov_b32 v111, v234
pk_kernel_fx_40:
    v_exp_f32 v96, v96
    v_exp_f32 v97, v97
    s_waitcnt vmcnt(21)
    v_mfma_f32_32x32x16_bf16 v[208:223], a[88:91], v[80:83], v[208:223]
    v_exp_f32 v98, v98
    v_exp_f32 v99, v99
    buffer_load_dwordx4 a[248:251], v243, s[24:27], s81 offen offset:2048
    v_exp_f32 v100, v100
    v_exp_f32 v101, v101
    v_exp_f32 v102, v102
    s_waitcnt vmcnt(21)
    v_mfma_f32_32x32x16_bf16 v[208:223], a[92:95], v[84:87], v[208:223]
    v_exp_f32 v103, v103
    v_exp_f32 v104, v104
    v_exp_f32 v105, v105
    v_exp_f32 v106, v106
    v_exp_f32 v107, v107
    v_exp_f32 v108, v108
    v_exp_f32 v109, v109
    buffer_load_dwordx4 a[252:255], v243, s[24:27], s81 offen offset:3072
    v_exp_f32 v110, v110
    v_exp_f32 v111, v111
    v_cvt_pk_bf16_f32 v96, v96, v97
    v_cvt_pk_bf16_f32 v97, v98, v99
    v_cvt_pk_bf16_f32 v98, v100, v101
    v_cvt_pk_bf16_f32 v99, v102, v103
    v_cvt_pk_bf16_f32 v100, v104, v105
    v_cvt_pk_bf16_f32 v101, v106, v107
    v_cvt_pk_bf16_f32 v102, v108, v109
    v_cvt_pk_bf16_f32 v103, v110, v111
    v_exp_f32 v48, v48
    v_exp_f32 v49, v49
    s_waitcnt vmcnt(21)
    v_mfma_f32_32x32x16_bf16 v[208:223], a[96:99], v[96:99], v[208:223]
    v_exp_f32 v50, v50
    v_exp_f32 v51, v51
    s_add_u32 m0, s33, 0
    s_mul_i32 s48, s29, 253952
    s_add_u32 s48, s48, s33
    s_add_u32 s48, s48, 45924352
    buffer_load_dwordx4 v2, s[24:27], s48 offen offset:0 lds
    v_exp_f32 v52, v52
    v_exp_f32 v53, v53
    v_exp_f32 v54, v54
    s_waitcnt vmcnt(21)
    v_mfma_f32_32x32x16_bf16 v[208:223], a[100:103], v[100:103], v[208:223]
    v_exp_f32 v55, v55
    v_exp_f32 v56, v56
    v_exp_f32 v57, v57
    v_exp_f32 v58, v58
    v_exp_f32 v59, v59
    v_exp_f32 v60, v60
    v_exp_f32 v61, v61
    buffer_load_dwordx4 v2, s[24:27], s48 offen offset:1024 lds
    v_exp_f32 v62, v62
    v_exp_f32 v63, v63
    v_cvt_pk_bf16_f32 v48, v48, v49
    v_cvt_pk_bf16_f32 v49, v50, v51
    v_cvt_pk_bf16_f32 v50, v52, v53
    v_cvt_pk_bf16_f32 v51, v54, v55
    v_cvt_pk_bf16_f32 v52, v56, v57
    v_cvt_pk_bf16_f32 v53, v58, v59
    v_cvt_pk_bf16_f32 v54, v60, v61
    v_cvt_pk_bf16_f32 v55, v62, v63
    s_add_u32 s40, s63, 0
    s_waitcnt vmcnt(21)
    v_mfma_f32_32x32x16_bf16 v[208:223], a[104:107], v[48:51], v[208:223]
    s_lshl_b32 s40, s40, 15
    s_lshl_b32 s41, s62, 10
    s_waitcnt vmcnt(20)
    v_mfma_f32_32x32x16_bf16 v[208:223], a[108:111], v[52:55], v[208:223]
    s_add_u32 s40, s40, s41
    s_add_u32 s40, s40, s30
    s_add_u32 s40, s40, 8388608
    v_mfma_f32_32x32x16_bf16 v[64:79], a[8:11], v[228:231], v[160:175]
    v_mfma_f32_32x32x16_bf16 v[80:95], a[12:15], v[228:231], v[160:175]
    v_mfma_f32_32x32x16_bf16 v[48:63], a[4:7], v[228:231], v[176:191]
    s_nop 6
    v_rcp_f32 v7, v216
    s_nop 0
    v_mul_f32 v208, v208, v7
    v_mul_f32 v209, v209, v7
    v_mul_f32 v210, v210, v7
    v_mul_f32 v211, v211, v7
    v_mul_f32 v212, v212, v7
    v_mul_f32 v213, v213, v7
    v_mul_f32 v214, v214, v7
    v_mul_f32 v215, v215, v7
    v_cvt_pk_bf16_f32 v112, v208, v209
    v_cvt_pk_bf16_f32 v113, v210, v211
    v_cvt_pk_bf16_f32 v114, v212, v213
    v_cvt_pk_bf16_f32 v115, v214, v215
    s_nop 1
    v_permlane32_swap_b32 v112, v114
    v_permlane32_swap_b32 v113, v115
    buffer_store_dwordx4 v[112:115], v2, s[24:27], s40 offen sc1
    s_cmp_ge_i32 s63, 7
    s_cbranch_scc1 pk_kernel_fx_41
    v_mov_b32 v48, v234
    v_mov_b32 v49, v234
    v_mov_b32 v50, v234
    v_mov_b32 v51, v234
    v_mov_b32 v52, v234
    v_mov_b32 v53, v234
    v_mov_b32 v54, v234
    v_mov_b32 v55, v234
    v_mov_b32 v56, v234
    v_mov_b32 v57, v234
    v_mov_b32 v58, v234
    v_mov_b32 v59, v234
    v_mov_b32 v60, v234
    v_mov_b32 v61, v234
    v_mov_b32 v62, v234
    v_mov_b32 v63, v234
pk_kernel_fx_41:
    v_exp_f32 v48, v48
    v_exp_f32 v49, v49
    v_exp_f32 v50, v50
    v_exp_f32 v51, v51
    buffer_load_dwordx4 v2, s[24:27], s48 offen offset:2048 lds
    v_exp_f32 v52, v52
    v_exp_f32 v53, v53
    v_exp_f32 v54, v54
    v_exp_f32 v55, v55
    v_exp_f32 v56, v56
    v_exp_f32 v57, v57
    v_exp_f32 v58, v58
    v_exp_f32 v59, v59
    v_exp_f32 v60, v60
    v_exp_f32 v61, v61
    buffer_load_dwordx4 v2, s[24:27], s48 offen offset:3072 lds
    v_exp_f32 v62, v62
    v_exp_f32 v63, v63
    v_cvt_pk_bf16_f32 v48, v48, v49
    v_cvt_pk_bf16_f32 v49, v50, v51
    v_cvt_pk_bf16_f32 v50, v52, v53
    v_cvt_pk_bf16_f32 v51, v54, v55
    v_cvt_pk_bf16_f32 v52, v56, v57
    v_cvt_pk_bf16_f32 v53, v58, v59
    v_cvt_pk_bf16_f32 v54, v60, v61
    v_cvt_pk_bf16_f32 v55, v62, v63
    s_cmp_ge_i32 s63, 6
    s_cbranch_scc1 pk_kernel_fx_42
    v_mov_b32 v64, v234
    v_mov_b32 v65, v234
    v_mov_b32 v66, v234
    v_mov_b32 v67, v234
    v_mov_b32 v68, v234
    v_mov_b32 v69, v234
    v_mov_b32 v70, v234
    v_mov_b32 v71, v234
    v_mov_b32 v72, v234
    v_mov_b32 v73, v234
    v_mov_b32 v74, v234
    v_mov_b32 v75, v234
    v_mov_b32 v76, v234
    v_mov_b32 v77, v234
    v_mov_b32 v78, v234
    v_mov_b32 v79, v234
pk_kernel_fx_42:
    v_exp_f32 v64, v64
    v_exp_f32 v65, v65
    v_mfma_f32_32x32x16_bf16 v[208:223], a[48:51], v[48:51], 0
    v_exp_f32 v66, v66
    v_exp_f32 v67, v67
    s_add_u32 m0, s33, 16384
    s_add_u32 s48, s48, 16384
    buffer_load_dwordx4 v2, s[24:27], s48 offen offset:0 lds
    v_exp_f32 v68, v68
    v_exp_f32 v69, v69
    v_exp_f32 v70, v70
    v_mfma_f32_32x32x16_bf16 v[208:223], a[52:55], v[52:55], v[208:223]
    v_exp_f32 v71, v71
    v_exp_f32 v72, v72
    v_exp_f32 v73, v73
    v_exp_f32 v74, v74
    v_exp_f32 v75, v75
    v_mfma_f32_32x32x16_bf16 v[96:111], a[16:19], v[228:231], v[160:175]
    v_exp_f32 v76, v76
    v_exp_f32 v77, v77
    buffer_load_dwordx4 v2, s[24:27], s48 offen offset:1024 lds
    v_exp_f32 v78, v78
    v_exp_f32 v79, v79
    v_cvt_pk_bf16_f32 v64, v64, v65
    v_cvt_pk_bf16_f32 v65, v66, v67
    v_cvt_pk_bf16_f32 v66, v68, v69
    v_cvt_pk_bf16_f32 v67, v70, v71
    v_cvt_pk_bf16_f32 v68, v72, v73
    v_cvt_pk_bf16_f32 v69, v74, v75
    v_cvt_pk_bf16_f32 v70, v76, v77
    v_cvt_pk_bf16_f32 v71, v78, v79
    s_cmp_ge_i32 s63, 5
    s_cbranch_scc1 pk_kernel_fx_43
    v_mov_b32 v80, v234
    v_mov_b32 v81, v234
    v_mov_b32 v82, v234
    v_mov_b32 v83, v234
    v_mov_b32 v84, v234
    v_mov_b32 v85, v234
    v_mov_b32 v86, v234
    v_mov_b32 v87, v234
    v_mov_b32 v88, v234
    v_mov_b32 v89, v234
    v_mov_b32 v90, v234
    v_mov_b32 v91, v234
    v_mov_b32 v92, v234
    v_mov_b32 v93, v234
    v_mov_b32 v94, v234
    v_mov_b32 v95, v234
pk_kernel_fx_43:
    v_exp_f32 v80, v80
    v_exp_f32 v81, v81
    v_mfma_f32_32x32x16_bf16 v[208:223], a[56:59], v[64:67], v[208:223]
    v_exp_f32 v82, v82
    v_exp_f32 v83, v83
    buffer_load_dwordx4 v2, s[24:27], s48 offen offset:2048 lds
    v_exp_f32 v84, v84
    v_exp_f32 v85, v85
    v_exp_f32 v86, v86
    v_mfma_f32_32x32x16_bf16 v[208:223], a[60:63], v[68:71], v[208:223]
    v_exp_f32 v87, v87
    v_exp_f32 v88, v88
    v_exp_f32 v89, v89
    v_exp_f32 v90, v90
    v_exp_f32 v91, v91
    v_mfma_f32_32x32x16_bf16 v[48:63], a[20:23], v[228:231], v[160:175]
    v_exp_f32 v92, v92
    v_exp_f32 v93, v93
    buffer_load_dwordx4 v2, s[24:27], s48 offen offset:3072 lds
    v_exp_f32 v94, v94
    v_exp_f32 v95, v95
    v_cvt_pk_bf16_f32 v80, v80, v81
    v_cvt_pk_bf16_f32 v81, v82, v83
    v_cvt_pk_bf16_f32 v82, v84, v85
    v_cvt_pk_bf16_f32 v83, v86, v87
    v_cvt_pk_bf16_f32 v84, v88, v89
    v_cvt_pk_bf16_f32 v85, v90, v91
    v_cvt_pk_bf16_f32 v86, v92, v93
    v_cvt_pk_bf16_f32 v87, v94, v95
    s_cmp_ge_i32 s63, 4
    s_cbranch_scc1 pk_kernel_fx_44
    v_mov_b32 v96, v234
    v_mov_b32 v97, v234
    v_mov_b32 v98, v234
    v_mov_b32 v99, v234
    v_mov_b32 v100, v234
    v_mov_b32 v101, v234
    v_mov_b32 v102, v234
    v_mov_b32 v103, v234
    v_mov_b32 v104, v234
    v_mov_b32 v105, v234
    v_mov_b32 v106, v234
    v_mov_b32 v107, v234
    v_mov_b32 v108, v234
    v_mov_b32 v109, v234
    v_mov_b32 v110, v234
    v_mov_b32 v111, v234
pk_kernel_fx_44:
    v_exp_f32 v96, v96
    v_exp_f32 v97, v97
    v_mfma_f32_32x32x16_bf16 v[208:223], a[64:67], v[80:83], v[208:223]
    v_exp_f32 v98, v98
    v_exp_f32 v99, v99
    v_exp_f32 v100, v100
    v_exp_f32 v101, v101
    v_exp_f32 v102, v102
    v_mfma_f32_32x32x16_bf16 v[208:223], a[68:71], v[84:87], v[208:223]
    v_exp_f32 v103, v103
    v_exp_f32 v104, v104
    v_exp_f32 v105, v105
    v_exp_f32 v106, v106
    v_exp_f32 v107, v107
    v_mfma_f32_32x32x16_bf16 v[64:79], a[24:27], v[228:231], v[160:175]
    v_exp_f32 v108, v108
    v_exp_f32 v109, v109
    v_exp_f32 v110, v110
    v_exp_f32 v111, v111
    v_cvt_pk_bf16_f32 v96, v96, v97
    v_cvt_pk_bf16_f32 v97, v98, v99
    v_cvt_pk_bf16_f32 v98, v100, v101
    v_cvt_pk_bf16_f32 v99, v102, v103
    v_cvt_pk_bf16_f32 v100, v104, v105
    v_cvt_pk_bf16_f32 v101, v106, v107
    v_cvt_pk_bf16_f32 v102, v108, v109
    v_cvt_pk_bf16_f32 v103, v110, v111
    s_cmp_ge_i32 s63, 3
    s_cbranch_scc1 pk_kernel_fx_45
    v_mov_b32 v48, v234
    v_mov_b32 v49, v234
    v_mov_b32 v50, v234
    v_mov_b32 v51, v234
    v_mov_b32 v52, v234
    v_mov_b32 v53, v234
    v_mov_b32 v54, v234
    v_mov_b32 v55, v234
    v_mov_b32 v56, v234
    v_mov_b32 v57, v234
    v_mov_b32 v58, v234
    v_mov_b32 v59, v234
    v_mov_b32 v60, v234
    v_mov_b32 v61, v234
    v_mov_b32 v62, v234
    v_mov_b32 v63, v234
pk_kernel_fx_45:
    v_exp_f32 v48, v48
    v_exp_f32 v49, v49
    v_mfma_f32_32x32x16_bf16 v[208:223], a[72:75], v[96:99], v[208:223]
    v_exp_f32 v50, v50
    v_exp_f32 v51, v51
    v_exp_f32 v52, v52
    v_exp_f32 v53, v53
    v_exp_f32 v54, v54
    v_mfma_f32_32x32x16_bf16 v[208:223], a[76:79], v[100:103], v[208:223]
    v_exp_f32 v55, v55
    v_exp_f32 v56, v56
    v_exp_f32 v57, v57
    v_exp_f32 v58, v58
    v_exp_f32 v59, v59
    v_mfma_f32_32x32x16_bf16 v[80:95], a[28:31], v[228:231], v[160:175]
    v_exp_f32 v60, v60
    v_exp_f32 v61, v61
    v_exp_f32 v62, v62
    v_exp_f32 v63, v63
    v_cvt_pk_bf16_f32 v48, v48, v49
    v_cvt_pk_bf16_f32 v49, v50, v51
    v_cvt_pk_bf16_f32 v50, v52, v53
    v_cvt_pk_bf16_f32 v51, v54, v55
    v_cvt_pk_bf16_f32 v52, v56, v57
    v_cvt_pk_bf16_f32 v53, v58, v59
    v_cvt_pk_bf16_f32 v54, v60, v61
    v_cvt_pk_bf16_f32 v55, v62, v63
    s_cmp_ge_i32 s63, 2
    s_cbranch_scc1 pk_kernel_fx_46
    v_mov_b32 v64, v234
    v_mov_b32 v65, v234
    v_mov_b32 v66, v234
    v_mov_b32 v67, v234
    v_mov_b32 v68, v234
    v_mov_b32 v69, v234
    v_mov_b32 v70, v234
    v_mov_b32 v71, v234
    v_mov_b32 v72, v234
    v_mov_b32 v73, v234
    v_mov_b32 v74, v234
    v_mov_b32 v75, v234
    v_mov_b32 v76, v234
    v_mov_b32 v77, v234
    v_mov_b32 v78, v234
    v_mov_b32 v79, v234
pk_kernel_fx_46:
    v_exp_f32 v64, v64
    v_exp_f32 v65, v65
    v_mfma_f32_32x32x16_bf16 v[208:223], a[80:83], v[48:51], v[208:223]
    v_exp_f32 v66, v66
    v_exp_f32 v67, v67
    v_exp_f32 v68, v68
    v_exp_f32 v69, v69
    v_exp_f32 v70, v70
    v_mfma_f32_32x32x16_bf16 v[208:223], a[84:87], v[52:55], v[208:223]
    v_exp_f32 v71, v71
    v_exp_f32 v72, v72
    v_exp_f32 v73, v73
    v_exp_f32 v74, v74
    v_exp_f32 v75, v75
    v_mfma_f32_32x32x16_bf16 v[96:111], a[32:35], v[228:231], v[160:175]
    v_exp_f32 v76, v76
    v_exp_f32 v77, v77
    v_exp_f32 v78, v78
    v_exp_f32 v79, v79
    v_cvt_pk_bf16_f32 v64, v64, v65
    v_cvt_pk_bf16_f32 v65, v66, v67
    v_cvt_pk_bf16_f32 v66, v68, v69
    v_cvt_pk_bf16_f32 v67, v70, v71
    v_cvt_pk_bf16_f32 v68, v72, v73
    v_cvt_pk_bf16_f32 v69, v74, v75
    v_cvt_pk_bf16_f32 v70, v76, v77
    v_cvt_pk_bf16_f32 v71, v78, v79
    s_cmp_ge_i32 s63, 1
    s_cbranch_scc1 pk_kernel_fx_47
    v_mov_b32 v80, v234
    v_mov_b32 v81, v234
    v_mov_b32 v82, v234
    v_mov_b32 v83, v234
    v_mov_b32 v84, v234
    v_mov_b32 v85, v234
    v_mov_b32 v86, v234
    v_mov_b32 v87, v234
    v_mov_b32 v88, v234
    v_mov_b32 v89, v234
    v_mov_b32 v90, v234
    v_mov_b32 v91, v234
    v_mov_b32 v92, v234
    v_mov_b32 v93, v234
    v_mov_b32 v94, v234
    v_mov_b32 v95, v234
pk_kernel_fx_47:
    v_exp_f32 v80, v80
    v_exp_f32 v81, v81
    v_mfma_f32_32x32x16_bf16 v[208:223], a[88:91], v[64:67], v[208:223]
    v_exp_f32 v82, v82
    v_exp_f32 v83, v83
    v_exp_f32 v84, v84
    v_exp_f32 v85, v85
    v_exp_f32 v86, v86
    v_mfma_f32_32x32x16_bf16 v[208:223], a[92:95], v[68:71], v[208:223]
    v_exp_f32 v87, v87
    v_exp_f32 v88, v88
    v_exp_f32 v89, v89
    v_exp_f32 v90, v90
    v_exp_f32 v91, v91
    v_mfma_f32_32x32x16_bf16 v[48:63], a[36:39], v[228:231], v[192:207]
    v_exp_f32 v92, v92
    v_exp_f32 v93, v93
    v_exp_f32 v94, v94
    v_exp_f32 v95, v95
    v_cvt_pk_bf16_f32 v80, v80, v81
    v_cvt_pk_bf16_f32 v81, v82, v83
    v_cvt_pk_bf16_f32 v82, v84, v85
    v_cvt_pk_bf16_f32 v83, v86, v87
    v_cvt_pk_bf16_f32 v84, v88, v89
    v_cvt_pk_bf16_f32 v85, v90, v91
    v_cvt_pk_bf16_f32 v86, v92, v93
    v_cvt_pk_bf16_f32 v87, v94, v95
    s_cmp_ge_i32 s63, 0
    s_cbranch_scc1 pk_kernel_fx_48
    v_mov_b32 v96, v234
    v_mov_b32 v97, v234
    v_mov_b32 v98, v234
    v_mov_b32 v99, v234
    v_mov_b32 v100, v234
    v_mov_b32 v101, v234
    v_mov_b32 v102, v234
    v_mov_b32 v103, v234
    v_mov_b32 v104, v234
    v_mov_b32 v105, v234
    v_mov_b32 v106, v234
    v_mov_b32 v107, v234
    v_mov_b32 v108, v234
    v_mov_b32 v109, v234
    v_mov_b32 v110, v234
    v_mov_b32 v111, v234
pk_kernel_fx_48:
    v_exp_f32 v96, v96
    v_exp_f32 v97, v97
    v_mfma_f32_32x32x16_bf16 v[208:223], a[96:99], v[80:83], v[208:223]
    v_exp_f32 v98, v98
    v_exp_f32 v99, v99
    v_exp_f32 v100, v100
    v_exp_f32 v101, v101
    v_exp_f32 v102, v102
    v_mfma_f32_32x32x16_bf16 v[208:223], a[100:103], v[84:87], v[208:223]
    v_exp_f32 v103, v103
    v_exp_f32 v104, v104
    v_exp_f32 v105, v105
    v_exp_f32 v106, v106
    v_exp_f32 v107, v107
    v_exp_f32 v108, v108
    v_exp_f32 v109, v109
    v_exp_f32 v110, v110
    v_exp_f32 v111, v111
    v_cvt_pk_bf16_f32 v96, v96, v97
    v_cvt_pk_bf16_f32 v97, v98, v99
    v_cvt_pk_bf16_f32 v98, v100, v101
    v_cvt_pk_bf16_f32 v99, v102, v103
    v_cvt_pk_bf16_f32 v100, v104, v105
    v_cvt_pk_bf16_f32 v101, v106, v107
    v_cvt_pk_bf16_f32 v102, v108, v109
    v_cvt_pk_bf16_f32 v103, v110, v111
    v_exp_f32 v48, v48
    v_exp_f32 v49, v49
    v_mfma_f32_32x32x16_bf16 v[208:223], a[104:107], v[96:99], v[208:223]
    v_exp_f32 v50, v50
    v_exp_f32 v51, v51
    v_exp_f32 v52, v52
    v_exp_f32 v53, v53
    v_exp_f32 v54, v54
    v_mfma_f32_32x32x16_bf16 v[208:223], a[108:111], v[100:103], v[208:223]
    v_exp_f32 v55, v55
    v_exp_f32 v56, v56
    v_exp_f32 v57, v57
    v_exp_f32 v58, v58
    v_exp_f32 v59, v59
    v_exp_f32 v60, v60
    v_exp_f32 v61, v61
    v_exp_f32 v62, v62
    v_exp_f32 v63, v63
    v_cvt_pk_bf16_f32 v48, v48, v49
    v_cvt_pk_bf16_f32 v49, v50, v51
    v_cvt_pk_bf16_f32 v50, v52, v53
    v_cvt_pk_bf16_f32 v51, v54, v55
    v_cvt_pk_bf16_f32 v52, v56, v57
    v_cvt_pk_bf16_f32 v53, v58, v59
    v_cvt_pk_bf16_f32 v54, v60, v61
    v_cvt_pk_bf16_f32 v55, v62, v63
    s_add_u32 s40, s63, 1
    s_waitcnt vmcnt(26)
    v_mfma_f32_32x32x16_bf16 v[208:223], a[112:115], v[48:51], v[208:223]
    s_lshl_b32 s40, s40, 15
    s_lshl_b32 s41, s62, 10
    s_waitcnt vmcnt(25)
    v_mfma_f32_32x32x16_bf16 v[208:223], a[116:119], v[52:55], v[208:223]
    s_add_u32 s40, s40, s41
    s_add_u32 s40, s40, s30
    s_add_u32 s40, s40, 8388608
    s_nop 7
    s_nop 1
    v_rcp_f32 v7, v216
    s_nop 0
    v_mul_f32 v208, v208, v7
    v_mul_f32 v209, v209, v7
    v_mul_f32 v210, v210, v7
    v_mul_f32 v211, v211, v7
    v_mul_f32 v212, v212, v7
    v_mul_f32 v213, v213, v7
    v_mul_f32 v214, v214, v7
    v_mul_f32 v215, v215, v7
    v_cvt_pk_bf16_f32 v16, v208, v209
    v_cvt_pk_bf16_f32 v17, v210, v211
    v_cvt_pk_bf16_f32 v18, v212, v213
    v_cvt_pk_bf16_f32 v19, v214, v215
    s_nop 1
    v_permlane32_swap_b32 v16, v18
    v_permlane32_swap_b32 v17, v19
    buffer_store_dwordx4 v[16:19], v2, s[24:27], s40 offen sc1
    s_branch pk_kernel_ajoin_8
pk_kernel_sp_3:
    s_mov_b64 exec, 7
    s_mov_b32 s50, 100000
    s_add_u32 s41, s95, 49987584
    buffer_load_dword v11, v10, s[24:27], s41 offen sc1
    s_nop 15
    s_nop 15
    s_nop 15
    buffer_load_dword v244, v10, s[24:27], s41 offen sc1
    s_nop 15
    s_nop 15
    s_nop 15
    buffer_load_dword v245, v10, s[24:27], s41 offen sc1
pk_kernel_pl_5:
    s_waitcnt vmcnt(2)
    v_cmp_gt_u32 vcc, s98, v11
    s_cmp_eq_u32 vcc_lo, 0
    s_cbranch_scc1 pk_kernel_px_6
    buffer_load_dword v11, v10, s[24:27], s41 offen sc1
    s_waitcnt vmcnt(2)
    v_cmp_gt_u32 vcc, s98, v244
    s_cmp_eq_u32 vcc_lo, 0
    s_cbranch_scc1 pk_kernel_px_6
    buffer_load_dword v244, v10, s[24:27], s41 offen sc1
    s_waitcnt vmcnt(2)
    v_cmp_gt_u32 vcc, s98, v245
    s_cmp_eq_u32 vcc_lo, 0
    s_cbranch_scc1 pk_kernel_px_6
    buffer_load_dword v245, v10, s[24:27], s41 offen sc1
    s_sub_u32 s50, s50, 1
    s_cmp_lg_u32 s50, 0
    s_cbranch_scc1 pk_kernel_pl_5
pk_kernel_px_6:
    s_mov_b64 exec, -1
    s_branch pk_kernel_pr_4
pk_kernel_sp_9:
    s_mov_b64 exec, 7
    s_mov_b32 s50, 100000
    s_add_u32 s41, s95, 50003968
    buffer_load_dword v11, v10, s[24:27], s41 offen sc1
    s_nop 15
    s_nop 15
    s_nop 15
    buffer_load_dword v244, v10, s[24:27], s41 offen sc1
    s_nop 15
    s_nop 15
    s_nop 15
    buffer_load_dword v245, v10, s[24:27], s41 offen sc1
pk_kernel_pl_11:
    s_waitcnt vmcnt(2)
    v_cmp_gt_u32 vcc, s98, v11
    s_cmp_eq_u32 vcc_lo, 0
    s_cbranch_scc1 pk_kernel_px_12
    buffer_load_dword v11, v10, s[24:27], s41 offen sc1
    s_waitcnt vmcnt(2)
    v_cmp_gt_u32 vcc, s98, v244
    s_cmp_eq_u32 vcc_lo, 0
    s_cbranch_scc1 pk_kernel_px_12
    buffer_load_dword v244, v10, s[24:27], s41 offen sc1
    s_waitcnt vmcnt(2)
    v_cmp_gt_u32 vcc, s98, v245
    s_cmp_eq_u32 vcc_lo, 0
    s_cbranch_scc1 pk_kernel_px_12
    buffer_load_dword v245, v10, s[24:27], s41 offen sc1
    s_sub_u32 s50, s50, 1
    s_cmp_lg_u32 s50, 0
    s_cbranch_scc1 pk_kernel_pl_11
pk_kernel_px_12:
    s_mov_b64 exec, -1
    s_branch pk_kernel_pr_10
pk_kernel_sp_21:
    s_mov_b64 exec, 7
    s_mov_b32 s50, 100000
    s_add_u32 s41, s95, 50003968
    buffer_load_dword v11, v10, s[24:27], s41 offen sc1
    s_nop 15
    s_nop 15
    s_nop 15
    buffer_load_dword v244, v10, s[24:27], s41 offen sc1
    s_nop 15
    s_nop 15
    s_nop 15
    buffer_load_dword v245, v10, s[24:27], s41 offen sc1
pk_kernel_pl_23:
    s_waitcnt vmcnt(2)
    v_cmp_gt_u32 vcc, s98, v11
    s_cmp_eq_u32 vcc_lo, 0
    s_cbranch_scc1 pk_kernel_px_24
    buffer_load_dword v11, v10, s[24:27], s41 offen sc1
    s_waitcnt vmcnt(2)
    v_cmp_gt_u32 vcc, s98, v244
    s_cmp_eq_u32 vcc_lo, 0
    s_cbranch_scc1 pk_kernel_px_24
    buffer_load_dword v244, v10, s[24:27], s41 offen sc1
    s_waitcnt vmcnt(2)
    v_cmp_gt_u32 vcc, s98, v245
    s_cmp_eq_u32 vcc_lo, 0
    s_cbranch_scc1 pk_kernel_px_24
    buffer_load_dword v245, v10, s[24:27], s41 offen sc1
    s_sub_u32 s50, s50, 1
    s_cmp_lg_u32 s50, 0
    s_cbranch_scc1 pk_kernel_pl_23
pk_kernel_px_24:
    s_mov_b64 exec, -1
    s_branch pk_kernel_pr_22
pk_kernel_sp_50:
    s_mov_b64 exec, 1
    s_mov_b32 s50, 100000
    s_add_u32 s41, s93, 50020352
    buffer_load_dword v11, v10, s[24:27], s41 offen sc1
    s_nop 15
    s_nop 15
    s_nop 15
    buffer_load_dword v244, v10, s[24:27], s41 offen sc1
    s_nop 15
    s_nop 15
    s_nop 15
    buffer_load_dword v245, v10, s[24:27], s41 offen sc1
pk_kernel_pl_52:
    s_waitcnt vmcnt(2)
    v_cmp_gt_u32 vcc, s100, v11
    s_cmp_eq_u32 vcc_lo, 0
    s_cbranch_scc1 pk_kernel_px_53
    buffer_load_dword v11, v10, s[24:27], s41 offen sc1
    s_waitcnt vmcnt(2)
    v_cmp_gt_u32 vcc, s100, v244
    s_cmp_eq_u32 vcc_lo, 0
    s_cbranch_scc1 pk_kernel_px_53
    buffer_load_dword v244, v10, s[24:27], s41 offen sc1
    s_waitcnt vmcnt(2)
    v_cmp_gt_u32 vcc, s100, v245
    s_cmp_eq_u32 vcc_lo, 0
    s_cbranch_scc1 pk_kernel_px_53
    buffer_load_dword v245, v10, s[24:27], s41 offen sc1
    s_sub_u32 s50, s50, 1
    s_cmp_lg_u32 s50, 0
    s_cbranch_scc1 pk_kernel_pl_52
pk_kernel_px_53:
    s_mov_b64 exec, -1
    s_branch pk_kernel_pr_51
pk_kernel_sp_55:
    s_mov_b64 exec, 1
    s_mov_b32 s50, 100000
    s_add_u32 s41, s96, 50036736
    buffer_load_dword v11, v10, s[24:27], s41 offen sc1
    s_nop 15
    s_nop 15
    s_nop 15
    buffer_load_dword v244, v10, s[24:27], s41 offen sc1
    s_nop 15
    s_nop 15
    s_nop 15
    buffer_load_dword v245, v10, s[24:27], s41 offen sc1
pk_kernel_pl_57:
    s_waitcnt vmcnt(2)
    v_cmp_gt_u32 vcc, s100, v11
    s_cmp_eq_u32 vcc_lo, 0
    s_cbranch_scc1 pk_kernel_px_58
    buffer_load_dword v11, v10, s[24:27], s41 offen sc1
    s_waitcnt vmcnt(2)
    v_cmp_gt_u32 vcc, s100, v244
    s_cmp_eq_u32 vcc_lo, 0
    s_cbranch_scc1 pk_kernel_px_58
    buffer_load_dword v244, v10, s[24:27], s41 offen sc1
    s_waitcnt vmcnt(2)
    v_cmp_gt_u32 vcc, s100, v245
    s_cmp_eq_u32 vcc_lo, 0
    s_cbranch_scc1 pk_kernel_px_58
    buffer_load_dword v245, v10, s[24:27], s41 offen sc1
    s_sub_u32 s50, s50, 1
    s_cmp_lg_u32 s50, 0
    s_cbranch_scc1 pk_kernel_pl_57
pk_kernel_px_58:
    s_mov_b64 exec, -1
    s_branch pk_kernel_pr_56
pk_kernel_sp_61:
    s_mov_b64 exec, 1
    s_mov_b32 s50, 100000
    s_add_u32 s41, s97, 50053120
    buffer_load_dword v11, v10, s[24:27], s41 offen sc1
    s_nop 15
    s_nop 15
    s_nop 15
    buffer_load_dword v244, v10, s[24:27], s41 offen sc1
    s_nop 15
    s_nop 15
    s_nop 15
    buffer_load_dword v245, v10, s[24:27], s41 offen sc1
pk_kernel_pl_63:
    s_waitcnt vmcnt(2)
    v_cmp_gt_u32 vcc, s99, v11
    s_cmp_eq_u32 vcc_lo, 0
    s_cbranch_scc1 pk_kernel_px_64
    buffer_load_dword v11, v10, s[24:27], s41 offen sc1
    s_waitcnt vmcnt(2)
    v_cmp_gt_u32 vcc, s99, v244
    s_cmp_eq_u32 vcc_lo, 0
    s_cbranch_scc1 pk_kernel_px_64
    buffer_load_dword v244, v10, s[24:27], s41 offen sc1
    s_waitcnt vmcnt(2)
    v_cmp_gt_u32 vcc, s99, v245
    s_cmp_eq_u32 vcc_lo, 0
    s_cbranch_scc1 pk_kernel_px_64
    buffer_load_dword v245, v10, s[24:27], s41 offen sc1
    s_sub_u32 s50, s50, 1
    s_cmp_lg_u32 s50, 0
    s_cbranch_scc1 pk_kernel_pl_63
pk_kernel_px_64:
    s_mov_b64 exec, -1
    s_branch pk_kernel_pr_62
pk_kernel_sp_65:
    s_mov_b64 exec, 1
    s_mov_b32 s50, 100000
    s_add_u32 s41, s97, 50069504
    buffer_load_dword v11, v10, s[24:27], s41 offen sc1
    s_nop 15
    s_nop 15
    s_nop 15
    buffer_load_dword v244, v10, s[24:27], s41 offen sc1
    s_nop 15
    s_nop 15
    s_nop 15
    buffer_load_dword v245, v10, s[24:27], s41 offen sc1
pk_kernel_pl_67:
    s_waitcnt vmcnt(2)
    v_cmp_gt_u32 vcc, s99, v11
    s_cmp_eq_u32 vcc_lo, 0
    s_cbranch_scc1 pk_kernel_px_68
    buffer_load_dword v11, v10, s[24:27], s41 offen sc1
    s_waitcnt vmcnt(2)
    v_cmp_gt_u32 vcc, s99, v244
    s_cmp_eq_u32 vcc_lo, 0
    s_cbranch_scc1 pk_kernel_px_68
    buffer_load_dword v244, v10, s[24:27], s41 offen sc1
    s_waitcnt vmcnt(2)
    v_cmp_gt_u32 vcc, s99, v245
    s_cmp_eq_u32 vcc_lo, 0
    s_cbranch_scc1 pk_kernel_px_68
    buffer_load_dword v245, v10, s[24:27], s41 offen sc1
    s_sub_u32 s50, s50, 1
    s_cmp_lg_u32 s50, 0
    s_cbranch_scc1 pk_kernel_pl_67
pk_kernel_px_68:
    s_mov_b64 exec, -1
    s_branch pk_kernel_pr_66
pk_kernel_sp_71:
    s_mov_b64 exec, 1
    s_mov_b32 s50, 100000
    s_add_u32 s41, s96, 50085888
    buffer_load_dword v11, v10, s[24:27], s41 offen sc1
    s_nop 15
    s_nop 15
    s_nop 15
    buffer_load_dword v244, v10, s[24:27], s41 offen sc1
    s_nop 15
    s_nop 15
    s_nop 15
    buffer_load_dword v245, v10, s[24:27], s41 offen sc1
pk_kernel_pl_73:
    s_waitcnt vmcnt(2)
    v_cmp_gt_u32 vcc, s42, v11
    s_cmp_eq_u32 vcc_lo, 0
    s_cbranch_scc1 pk_kernel_px_74
    buffer_load_dword v11, v10, s[24:27], s41 offen sc1
    s_waitcnt vmcnt(2)
    v_cmp_gt_u32 vcc, s42, v244
    s_cmp_eq_u32 vcc_lo, 0
    s_cbranch_scc1 pk_kernel_px_74
    buffer_load_dword v244, v10, s[24:27], s41 offen sc1
    s_waitcnt vmcnt(2)
    v_cmp_gt_u32 vcc, s42, v245
    s_cmp_eq_u32 vcc_lo, 0
    s_cbranch_scc1 pk_kernel_px_74
    buffer_load_dword v245, v10, s[24:27], s41 offen sc1
    s_sub_u32 s50, s50, 1
    s_cmp_lg_u32 s50, 0
    s_cbranch_scc1 pk_kernel_pl_73
pk_kernel_px_74:
    s_mov_b64 exec, -1
    s_branch pk_kernel_pr_72
pk_kernel_codeend:
.section .rodata,"a"
.p2align 6
.amdhsa_kernel k0_kernel
  .amdhsa_next_free_vgpr 88
  .amdhsa_next_free_sgpr 64
  .amdhsa_accum_offset 88
  .amdhsa_group_segment_fixed_size 0
  .amdhsa_kernarg_size 80
  .amdhsa_user_sgpr_count 2
  .amdhsa_user_sgpr_kernarg_segment_ptr 1
  .amdhsa_system_sgpr_workgroup_id_x 1
.end_amdhsa_kernel
.p2align 6
.amdhsa_kernel pk_kernel
  .amdhsa_next_free_vgpr 512
  .amdhsa_next_free_sgpr 102
  .amdhsa_accum_offset 256
  .amdhsa_group_segment_fixed_size 0
  .amdhsa_kernarg_size 80
  .amdhsa_user_sgpr_count 2
  .amdhsa_user_sgpr_kernarg_segment_ptr 1
  .amdhsa_system_sgpr_workgroup_id_x 1
.end_amdhsa_kernel
```
